```python
import torch

def _softmax(x, axis=-1):
    return torch.softmax(x, dim=axis)
def _gelu(x):
    return torch.nn.functional.gelu(x, approximate="tanh")
def _silu(x):
    return torch.nn.functional.silu(x)
def _sigmoid(x):
    return torch.sigmoid(x)
def _layernorm(x, axis=-1, eps=1e-5):
    m = x.mean(dim=axis, keepdim=True)
    v = x.var(dim=axis, keepdim=True, unbiased=False)
    return (x - m) / torch.sqrt(v + eps)
def _scatter_add(tgt, idx, src, axis=0):
    return tgt.clone().index_add_(axis, idx, src)
def _segment_sum(src, seg, n):
    out = torch.zeros((n,) + src.shape[1:], dtype=src.dtype)
    return out.index_add_(0, seg, src)
def _pad(x, pw):
    flat = tuple(v for pair in reversed(pw) for v in pair)
    return torch.nn.functional.pad(x, flat)

kernel_name = 'recurrent_scan__linear_attn_block__mixer_s_mlp__prompt'

def setup_inputs():

    _w = (lambda a: (lambda t: t.to(torch.bfloat16) if t.is_floating_point() else t)(torch.as_tensor(a)))
    def _A_setup():
        B, S, D = 1, 2048, 512
        return {
            "x": _w((lambda *s: torch.randn(*s, dtype=torch.bfloat16) * 0.05)(B, S, D)),
            "wqkv": _w((lambda *s: torch.randn(*s, dtype=torch.bfloat16) * 0.05)(D, 3 * D)),
            "wo": _w((lambda *s: torch.randn(*s, dtype=torch.bfloat16) * 0.05)(D, D)),
        }
    _A_in = _A_setup()

    def _B_setup():
        B, S, D, F = 1, 2048, 512, 1792
        return {
            "x":  _w((lambda *s: torch.randn(*s, dtype=torch.bfloat16) * 0.05)(B, S, D)),
            "w1": _w((lambda *s: torch.randn(*s, dtype=torch.bfloat16) * 3.2)(D, D) * (D ** -0.5)),
            "w2": _w((lambda *s: torch.randn(*s, dtype=torch.bfloat16) * 3.2)(D, D) * (D ** -0.5)),
            "w3": _w((lambda *s: torch.randn(*s, dtype=torch.bfloat16) * 3.2)(D, F) * (D ** -0.5)),
            "w4": _w((lambda *s: torch.randn(*s, dtype=torch.bfloat16) * 1.6)(F, D) * (F ** -0.5)),
        }
    _B_in = _B_setup()

    return {
        "A_x": _A_in["x"],
        "A_wqkv": _A_in["wqkv"],
        "A_wo": _A_in["wo"],
        "B_x": _B_in["x"],
        "B_w1": _B_in["w1"],
        "B_w2": _B_in["w2"],
        "B_w3": _B_in["w3"],
        "B_w4": _B_in["w4"],
    }

def reference(A_x, A_wqkv, A_wo, B_x, B_w1, B_w2, B_w3, B_w4):
    def _A_ref(x, wqkv, wo):
        B, S, D = x.shape
        H = 32; Dh = D // H
        qkv = (lambda x, *d: x.permute(*d))((x @ wqkv).reshape(B, S, 3, H, Dh), 2, 0, 3, 1, 4)
        q, k, v = qkv[0], qkv[1], qkv[2]
        phi = lambda t: torch.where(t > 0, t + 1, torch.exp(t)) + 1e-6
        pq, pk = phi(q), phi(k)
        kv = torch.einsum("bhsd,bhse->bhde", pk, v)
        z = torch.einsum("bhsd->bhd", pk)
        num = torch.einsum("bhqd,bhde->bhqe", pq, kv)
        den = torch.einsum("bhqd,bhd->bhq", pq, z)[..., None] + 1e-6
        o = num / den
        return (lambda x, *d: x.permute(*d))(o, 0, 2, 1, 3).reshape(B, S, D) @ wo

    def _B_ref(x, w1, w2, w3, w4):
        B, S, D = x.shape
        h = _gelu(_layernorm(x, axis=-1) @ w1)
        c = D // 4
        g0 = _pad(h[:, :, 0*c:1*c], ((0, 0), (1, 0), (0, 0)))[:, :S, :]
        g1 = _pad(h[:, :, 1*c:2*c], ((0, 0), (0, 1), (0, 0)))[:, 1:, :]
        g2 = _pad(h[:, :, 2*c:3*c], ((0, 0), (2, 0), (0, 0)))[:, :S, :]
        g3 = _pad(h[:, :, 3*c:   ], ((0, 0), (0, 2), (0, 0)))[:, 2:, :]
        hs = torch.concatenate([g0, g1, g2, g3], axis=-1) @ w2
        x1 = x + hs
        h2 = _gelu(_layernorm(x1, axis=-1) @ w3) @ w4
        return x1 + h2

    x = A_x
    xn = _layernorm(x, axis=-1)
    s = _A_ref(xn, A_wqkv, A_wo)
    g = _silu(_B_ref(xn, B_w1, B_w2, B_w3, B_w4))
    return x + s * g
```

```asm
; @launch grid=(256,1,1) block=(512,1,1) lds=163840
.amdgcn_target "amdgcn-amd-amdhsa--gfx950"
.text
.globl recurrent_scan__linear_attn_block__mixer_s_mlp__prompt_kernel
.p2align 8
.type recurrent_scan__linear_attn_block__mixer_s_mlp__prompt_kernel,@function
recurrent_scan__linear_attn_block__mixer_s_mlp__prompt_kernel:
    s_cmp_ge_u32 s2, 256
    s_cbranch_scc1 L_END
    s_load_dwordx16 s[4:19], s[0:1], 0
    s_load_dwordx2 s[20:21], s[0:1], 64
    s_load_dwordx2 s[22:23], s[0:1], 80
    v_lshrrev_b32 v1, 6, v0
    s_nop 0
    v_readfirstlane_b32 s24, v1
    v_and_b32 v1, 63, v0
    s_and_b32 s25, s2, 7
    s_lshr_b32 s26, s2, 3
    s_lshr_b32 s36, s26, 3
    s_lshl_b32 s27, s25, 2
    s_add_u32 s27, s27, s36
    s_and_b32 s28, s26, 7
    s_lshr_b32 s29, s27, 1
    s_and_b32 s30, s26, 15
    s_cmp_ge_u32 s26, 14
    s_cselect_b32 s36, 1, 0
    s_lshl_b32 s31, s25, 1
    s_add_u32 s31, s31, s36
    s_mul_i32 s36, s36, 14
    s_sub_u32 s32, s26, s36
    s_cmp_ge_u32 s26, 28
    s_cselect_b32 s33, 1, 0
    s_waitcnt lgkmcnt(0)
    s_load_dwordx2 s[34:35], s[22:23], 0x3000
    s_getreg_b32 s10, hwreg(HW_REG_XCC_ID, 0, 4)
    s_add_u32 s10, s10, 1
    s_lshl_b32 s10, s10, 24
    s_cmp_eq_u32 s24, 6
    s_cbranch_scc1 L_RX
    s_cmp_eq_u32 s24, 7
    s_cbranch_scc1 L_RS
    s_cmp_ge_u32 s24, 4
    s_cbranch_scc1 L_RW
    s_mov_b32 s36, s4
    s_mov_b32 s37, s5
    s_mov_b32 s38, 0x200000
    s_mov_b32 s39, 0x20000
    s_mov_b32 s40, s22
    s_mov_b32 s41, s23
    s_mov_b32 s42, 0xfe0000
    s_mov_b32 s43, 0x20000
    s_mov_b32 s44, s20
    s_mov_b32 s45, s21
    s_mov_b32 s46, 0x200000
    s_mov_b32 s47, 0x20000
    s_lshr_b32 s50, s24, 1
    s_and_b32 s51, s24, 1
    v_lshrrev_b32 v16, 5, v1
    v_and_b32 v17, 31, v1
    s_lshl_b32 s48, s29, 7
    s_lshl_b32 s49, s30, 3
    s_add_u32 s48, s48, s49
    s_lshl_b32 s49, s24, 1
    s_add_u32 s48, s48, s49
    v_add_u32 v68, s48, v16
    v_lshlrev_b32 v12, 10, v68
    v_lshl_add_u32 v12, v17, 5, v12
    buffer_load_dwordx4 v[4:7], v12, s[36:39], 0 offen
    buffer_load_dwordx4 v[8:11], v12, s[36:39], 0 offen offset:16
    s_lshl_b32 s48, s27, 6
    s_lshl_b32 s49, s50, 5
    s_add_u32 s48, s48, s49
    v_add_u32 v12, s48, v17
    v_lshlrev_b32 v242, 10, v12
    v_lshl_add_u32 v242, v16, 5, v242
    s_lshl_b32 s48, s28, 7
    s_lshl_b32 s49, s51, 6
    s_add_u32 s48, s48, s49
    v_add_u32 v242, s48, v242
    buffer_load_dwordx4 v[196:199], v242, s[36:39], 0 offen
    buffer_load_dwordx4 v[200:203], v242, s[36:39], 0 offen offset:16
    s_cmp_eq_u32 s24, 3
    s_cselect_b32 s68, 1, 0
    s_and_b32 s48, s26, 12
    s_cmp_eq_u32 s48, 12
    s_cselect_b32 s68, s68, 0
    s_lshr_b32 s48, s26, 4
    s_lshl_b32 s48, s48, 2
    s_and_b32 s69, s26, 3
    s_add_u32 s69, s69, s48
    s_lshl_b32 s69, s69, 3
    s_add_u32 s69, s69, s25
    s_cmp_eq_u32 s68, 0
    s_cbranch_scc1 L_C_wq0_1
    s_mov_b32 s64, s6
    s_mov_b32 s65, s7
    s_mov_b32 s66, 0x180000
    s_mov_b32 s67, 0x20000
    v_lshrrev_b32 v48, 3, v1
    s_lshl_b32 s48, s69, 3
    v_add_u32 v48, s48, v48
    v_and_b32 v49, 7, v1
    v_lshlrev_b32 v49, 4, v49
    v_mul_u32_u24 v50, 3072, v48
    v_add_u32 v50, v50, v49
    buffer_load_dwordx4 v[36:39], v50, s[64:67], 0 offen offset:384
    buffer_load_dwordx4 v[40:43], v50, s[64:67], 0 offen offset:1408
    buffer_load_dwordx4 v[44:47], v50, s[64:67], 0 offen offset:2432
L_C_wq0_1:
    v_lshlrev_b32 v244, 4, v1
    v_bfe_u32 v18, v1, 2, 2
    v_and_b32 v19, 1, v1
    v_lshlrev_b32 v19, 3, v19
    v_bfe_u32 v20, v1, 4, 1
    v_lshlrev_b32 v20, 1, v20
    v_bfe_u32 v12, v1, 1, 1
    v_add_u32 v20, v20, v12
    s_lshl_b32 s48, s50, 5
    v_add_u32 v12, s48, v17
    v_and_b32 v13, 15, v12
    v_xor_b32 v13, v13, v16
    v_lshlrev_b32 v13, 4, v13
    v_lshl_add_u32 v13, v12, 8, v13
    s_lshl_b32 s48, s50, 7
    v_xor_b32 v13, s48, v13
    v_xor_b32 v212, 0, v13
    v_xor_b32 v213, 32, v13
    v_xor_b32 v214, 64, v13
    v_xor_b32 v215, 96, v13
    v_xor_b32 v216, 128, v13
    v_xor_b32 v217, 160, v13
    v_xor_b32 v218, 192, v13
    v_xor_b32 v219, 224, v13
    s_lshl_b32 s48, s51, 2
    v_add_u32 v12, s48, v20
    v_lshrrev_b32 v13, 1, v18
    v_lshlrev_b32 v13, 2, v13
    v_xor_b32 v12, v12, v13
    v_lshl_add_u32 v14, v12, 4, v19
    v_add_u32 v14, 65536, v14
    v_lshl_add_u32 v12, v16, 2, v18
    v_lshl_add_u32 v231, v12, 7, v14
    v_lshl_add_u32 v12, v16, 3, v18
    v_lshl_add_u32 v15, v12, 7, v14
    s_lshl_b32 s48, s50, 13
    v_add_u32 v220, s48, v15
    v_subrev_u32 v221, s48, v15
    v_add_u32 v230, s48, v244
    s_lshl_b32 s48, s24, 5
    v_add_u32 v12, s48, v17
    v_bfe_u32 v13, v12, 1, 3
    v_xor_b32 v13, v13, v16
    v_lshlrev_b32 v13, 4, v13
    v_lshl_add_u32 v13, v12, 7, v13
    v_xor_b32 v13, s48, v13
    v_xor_b32 v222, 0, v13
    v_xor_b32 v223, 32, v13
    v_xor_b32 v224, 64, v13
    v_xor_b32 v225, 96, v13
    v_lshl_add_u32 v12, v16, 3, v18
    v_lshlrev_b32 v12, 6, v12
    v_lshl_add_u32 v12, v20, 4, v12
    v_add_u32 v12, v12, v19
    v_add_u32 v12, 65536, v12
    s_xor_b32 s48, s24, 0
    s_lshl_b32 s48, s48, 10
    v_add_u32 v226, s48, v12
    s_xor_b32 s48, s24, 1
    s_lshl_b32 s48, s48, 10
    v_add_u32 v227, s48, v12
    s_xor_b32 s48, s24, 2
    s_lshl_b32 s48, s48, 10
    v_add_u32 v228, s48, v12
    s_xor_b32 s48, s24, 3
    s_lshl_b32 s48, s48, 10
    v_add_u32 v229, s48, v12
    v_lshl_add_u32 v12, v16, 2, v18
    v_lshlrev_b32 v12, 8, v12
    v_add_u32 v12, v12, v19
    v_add_u32 v12, 65536, v12
    v_lshlrev_b32 v13, 2, v18
    s_xor_b32 s48, s50, 0
    s_lshl_b32 s48, s48, 2
    s_lshl_b32 s49, s51, 3
    s_add_u32 s48, s48, s49
    v_add_u32 v14, s48, v20
    v_xor_b32 v14, v14, v13
    v_lshl_add_u32 v232, v14, 4, v12
    s_xor_b32 s48, s50, 1
    s_lshl_b32 s48, s48, 2
    s_lshl_b32 s49, s51, 3
    s_add_u32 s48, s48, s49
    v_add_u32 v14, s48, v20
    v_xor_b32 v14, v14, v13
    v_lshl_add_u32 v233, v14, 4, v12
    s_and_b32 s48, s27, 1
    s_lshl_b32 s48, s48, 6
    s_lshl_b32 s49, s50, 5
    s_add_u32 s48, s48, s49
    v_add_u32 v12, s48, v17
    v_lshlrev_b32 v243, 2, v12
    v_add_u32 v243, 0x20000, v243
    v_mov_b32 v234, 0x3f803f80
    v_mov_b32 v236, 0
    v_mov_b32 v237, 0
    s_mov_b32 s70, 0xffff0000
    s_mov_b32 s54, 0x3fb8aa3b
    s_mov_b32 s56, 0x358637bd
    s_mov_b32 s58, 0xbfb8aa3b
    s_mov_b32 s60, 1.0
    s_mov_b32 s55, s54
    s_mov_b32 s57, s56
    s_mov_b32 s59, s58
    s_mov_b32 s61, s60
    v_mov_b32 v132, 0
    v_mov_b32 v133, 0
    v_mov_b32 v134, 0
    v_mov_b32 v135, 0
    v_mov_b32 v136, 0
    v_mov_b32 v137, 0
    v_mov_b32 v138, 0
    v_mov_b32 v139, 0
    v_mov_b32 v140, 0
    v_mov_b32 v141, 0
    v_mov_b32 v142, 0
    v_mov_b32 v143, 0
    v_mov_b32 v144, 0
    v_mov_b32 v145, 0
    v_mov_b32 v146, 0
    v_mov_b32 v147, 0
    v_mov_b32 v148, 0
    v_mov_b32 v149, 0
    v_mov_b32 v150, 0
    v_mov_b32 v151, 0
    v_mov_b32 v152, 0
    v_mov_b32 v153, 0
    v_mov_b32 v154, 0
    v_mov_b32 v155, 0
    v_mov_b32 v156, 0
    v_mov_b32 v157, 0
    v_mov_b32 v158, 0
    v_mov_b32 v159, 0
    v_mov_b32 v160, 0
    v_mov_b32 v161, 0
    v_mov_b32 v162, 0
    v_mov_b32 v163, 0
    v_mov_b32 v164, 0
    v_mov_b32 v165, 0
    v_mov_b32 v166, 0
    v_mov_b32 v167, 0
    v_mov_b32 v168, 0
    v_mov_b32 v169, 0
    v_mov_b32 v170, 0
    v_mov_b32 v171, 0
    v_mov_b32 v172, 0
    v_mov_b32 v173, 0
    v_mov_b32 v174, 0
    v_mov_b32 v175, 0
    v_mov_b32 v176, 0
    v_mov_b32 v177, 0
    v_mov_b32 v178, 0
    v_mov_b32 v179, 0
    v_mov_b32 v180, 0
    v_mov_b32 v181, 0
    v_mov_b32 v182, 0
    v_mov_b32 v183, 0
    v_mov_b32 v184, 0
    v_mov_b32 v185, 0
    v_mov_b32 v186, 0
    v_mov_b32 v187, 0
    v_mov_b32 v188, 0
    v_mov_b32 v189, 0
    v_mov_b32 v190, 0
    v_mov_b32 v191, 0
    v_mov_b32 v192, 0
    v_mov_b32 v193, 0
    v_mov_b32 v194, 0
    v_mov_b32 v195, 0
    s_waitcnt lgkmcnt(0)
    s_add_u32 s34, s34, 1
    s_addc_u32 s35, s35, 0
    v_mov_b32 v24, 0
    v_mov_b32 v25, 0
    s_cmp_eq_u32 s68, 0
    s_cbranch_scc1 L_C_wq2_3
    s_waitcnt vmcnt(5)
    s_branch L_C_wq5_2
L_C_wq2_3:
    s_waitcnt vmcnt(2)
L_C_wq5_2:
    v_dot2_f32_bf16 v24, v4, v234, v24
    v_dot2_f32_bf16 v25, v4, v4, v25
    v_dot2_f32_bf16 v24, v5, v234, v24
    v_dot2_f32_bf16 v25, v5, v5, v25
    v_dot2_f32_bf16 v24, v6, v234, v24
    v_dot2_f32_bf16 v25, v6, v6, v25
    v_dot2_f32_bf16 v24, v7, v234, v24
    v_dot2_f32_bf16 v25, v7, v7, v25
    v_dot2_f32_bf16 v24, v8, v234, v24
    v_dot2_f32_bf16 v25, v8, v8, v25
    v_dot2_f32_bf16 v24, v9, v234, v24
    v_dot2_f32_bf16 v25, v9, v9, v25
    v_dot2_f32_bf16 v24, v10, v234, v24
    v_dot2_f32_bf16 v25, v10, v10, v25
    v_dot2_f32_bf16 v24, v11, v234, v24
    v_dot2_f32_bf16 v25, v11, v11, v25
    s_nop 1
    v_add_f32_dpp v24, v24, v24 row_ror:8 row_mask:0xf bank_mask:0xf
    v_add_f32_dpp v25, v25, v25 row_ror:8 row_mask:0xf bank_mask:0xf
    s_nop 0
    v_add_f32_dpp v24, v24, v24 row_ror:4 row_mask:0xf bank_mask:0xf
    v_add_f32_dpp v25, v25, v25 row_ror:4 row_mask:0xf bank_mask:0xf
    s_nop 0
    v_add_f32_dpp v24, v24, v24 row_ror:2 row_mask:0xf bank_mask:0xf
    v_add_f32_dpp v25, v25, v25 row_ror:2 row_mask:0xf bank_mask:0xf
    s_nop 0
    v_add_f32_dpp v24, v24, v24 row_ror:1 row_mask:0xf bank_mask:0xf
    v_add_f32_dpp v25, v25, v25 row_ror:1 row_mask:0xf bank_mask:0xf
    v_mov_b32 v26, v24
    s_nop 1
    v_permlane16_swap_b32 v24, v26
    v_add_f32 v24, v24, v26
    v_mov_b32 v26, v25
    s_nop 1
    v_permlane16_swap_b32 v25, v26
    v_add_f32 v25, v25, v26
    v_mul_f32 v28, 0x3b000000, v24
    v_mul_f32 v29, 0x3b000000, v25
    v_fma_f32 v29, -v28, v28, v29
    v_max_f32 v29, 0, v29
    v_mov_b32 v30, s34
    v_mov_b32 v31, s35
    v_lshlrev_b32 v68, 4, v68
    v_add_u32 v68, 0xf00000, v68
    s_mov_b32 exec_lo, 1
    s_mov_b32 exec_hi, 1
    buffer_store_dwordx4 v[28:31], v68, s[40:43], 0 offen sc1
    s_mov_b64 exec, -1
    s_cmp_eq_u32 s68, 0
    s_cbranch_scc1 L_C_wqp_4
    v_lshrrev_b32 v48, 3, v1
    s_lshl_b32 s48, s69, 3
    v_add_u32 v48, s48, v48
    v_and_b32 v49, 7, v1
    v_lshlrev_b32 v49, 4, v49
    v_mul_u32_u24 v51, 384, v48
    v_add_u32 v51, v51, v49
    v_add_u32 v51, 0x140000, v51
    s_waitcnt vmcnt(1)
    buffer_store_dwordx4 v[36:39], v51, s[40:43], 0 offen offset:0 sc1
    buffer_store_dwordx4 v[40:43], v51, s[40:43], 0 offen offset:128 sc1
    buffer_store_dwordx4 v[44:47], v51, s[40:43], 0 offen offset:256 sc1
    v_mov_b32 v246, s34
    v_mov_b32 v247, s35
    s_lshl_b32 s48, s69, 3
    s_add_u32 s48, s48, 0x9000
    v_mov_b32 v12, s48
    s_waitcnt vmcnt(0)
    s_mov_b64 exec, 1
    buffer_store_dwordx2 v[246:247], v12, s[40:43], 0 offen sc1
    s_mov_b64 exec, -1
L_C_wqp_4:
    s_lshr_b32 s48, s30, 1
    s_cmp_eq_u32 s48, 3
    s_cselect_b32 s71, 1, 0
    s_cmp_eq_u32 s24, 0
    s_cselect_b32 s71, s71, 0
    s_branch L_C_wqc_5
    s_cmp_eq_u32 s71, 0
    s_cbranch_scc1 L_C_wqc_5
    v_lshlrev_b32 v12, 3, v1
    v_add_u32 v12, 0x9000, v12
    s_mov_b32 s49, 4
L_C_wql_6:
    buffer_load_dwordx2 v[246:247], v12, s[40:43], 0 offen sc1
    s_waitcnt vmcnt(0)
    v_cmp_eq_u64_e64 vcc, v[246:247], s[34:35]
    s_cmp_eq_u64 vcc, -1
    s_cbranch_scc1 L_C_wqd_7
    s_sub_u32 s49, s49, 1
    s_cbranch_scc0 L_C_wql_6
L_C_wqd_7:
    v_mov_b32 v246, vcc_lo
    v_mov_b32 v247, vcc_hi
    v_mov_b32 v12, 0x20f00
    ds_write_b64 v12, v[246:247]
    s_waitcnt lgkmcnt(0)
L_C_wqc_5:
    s_barrier
    ds_read_b128 v[4:7], v212 offset:0
    ds_read_b64_tr_b16 v[8:9], v220 offset:0
    ds_read_b64_tr_b16 v[10:11], v220 offset:512
    ds_read_b128 v[12:15], v213 offset:0
    ds_read_b64_tr_b16 v[16:17], v220 offset:2048
    ds_read_b64_tr_b16 v[18:19], v220 offset:2560
    ds_read_b128 v[20:23], v214 offset:0
    ds_read_b64_tr_b16 v[24:25], v220 offset:4096
    ds_read_b64_tr_b16 v[26:27], v220 offset:4608
    ds_read_b128 v[28:31], v215 offset:0
    ds_read_b64_tr_b16 v[32:33], v220 offset:6144
    ds_read_b64_tr_b16 v[34:35], v220 offset:6656
    ds_read_b128 v[36:39], v216 offset:0
    ds_read_b64_tr_b16 v[40:41], v221 offset:8192
    ds_read_b64_tr_b16 v[42:43], v221 offset:8704
    ds_read_b128 v[44:47], v217 offset:0
    ds_read_b64_tr_b16 v[48:49], v221 offset:10240
    ds_read_b64_tr_b16 v[50:51], v221 offset:10752
    ds_read_b128 v[52:55], v218 offset:0
    ds_read_b64_tr_b16 v[56:57], v221 offset:12288
    ds_read_b64_tr_b16 v[58:59], v221 offset:12800
    ds_read_b128 v[60:63], v219 offset:0
    ds_read_b64_tr_b16 v[64:65], v221 offset:14336
    ds_read_b64_tr_b16 v[66:67], v221 offset:14848
    s_waitcnt lgkmcnt(0)
    s_cmp_eq_u32 s71, 0
    s_cbranch_scc1 L_C_wqb0_8
    v_lshlrev_b32 v246, 3, v1
    v_add_u32 v246, 0x9000, v246
    buffer_load_dwordx2 v[248:249], v246, s[40:43], 0 offen sc1
L_C_wqb0_8:
    s_barrier
    v_mfma_f32_32x32x16_bf16 v[132:147], v[8:11], v[4:7], v[132:147]
    v_lshlrev_b32 v238, 16, v8
    v_and_b32 v239, s70, v8
    v_pk_add_f32 v[236:237], v[236:237], v[238:239]
    v_lshlrev_b32 v240, 16, v9
    v_and_b32 v241, s70, v9
    v_pk_add_f32 v[236:237], v[236:237], v[240:241]
    ds_read_b128 v[68:71], v212 offset:16384
    ds_read_b64_tr_b16 v[72:73], v220 offset:16384
    ds_read_b64_tr_b16 v[74:75], v220 offset:16896
    ds_read_b128 v[76:79], v213 offset:16384
    v_mfma_f32_32x32x16_bf16 v[148:163], v[16:19], v[12:15], v[148:163]
    v_lshlrev_b32 v238, 16, v10
    v_and_b32 v239, s70, v10
    v_pk_add_f32 v[236:237], v[236:237], v[238:239]
    v_lshlrev_b32 v240, 16, v11
    v_and_b32 v241, s70, v11
    v_pk_add_f32 v[236:237], v[236:237], v[240:241]
    ds_read_b64_tr_b16 v[80:81], v220 offset:18432
    ds_read_b64_tr_b16 v[82:83], v220 offset:18944
    ds_read_b128 v[84:87], v214 offset:16384
    ds_read_b64_tr_b16 v[88:89], v220 offset:20480
    v_mfma_f32_32x32x16_bf16 v[132:147], v[24:27], v[20:23], v[132:147]
    v_lshlrev_b32 v238, 16, v16
    v_and_b32 v239, s70, v16
    v_pk_add_f32 v[236:237], v[236:237], v[238:239]
    v_lshlrev_b32 v240, 16, v17
    v_and_b32 v241, s70, v17
    v_pk_add_f32 v[236:237], v[236:237], v[240:241]
    ds_read_b64_tr_b16 v[90:91], v220 offset:20992
    ds_read_b128 v[92:95], v215 offset:16384
    ds_read_b64_tr_b16 v[96:97], v220 offset:22528
    ds_read_b64_tr_b16 v[98:99], v220 offset:23040
    v_mfma_f32_32x32x16_bf16 v[148:163], v[32:35], v[28:31], v[148:163]
    v_lshlrev_b32 v238, 16, v18
    v_and_b32 v239, s70, v18
    v_pk_add_f32 v[236:237], v[236:237], v[238:239]
    v_lshlrev_b32 v240, 16, v19
    v_and_b32 v241, s70, v19
    v_pk_add_f32 v[236:237], v[236:237], v[240:241]
    ds_read_b128 v[100:103], v216 offset:16384
    ds_read_b64_tr_b16 v[104:105], v221 offset:24576
    ds_read_b64_tr_b16 v[106:107], v221 offset:25088
    ds_read_b128 v[108:111], v217 offset:16384
    v_mfma_f32_32x32x16_bf16 v[132:147], v[40:43], v[36:39], v[132:147]
    v_lshlrev_b32 v238, 16, v24
    v_and_b32 v239, s70, v24
    v_pk_add_f32 v[236:237], v[236:237], v[238:239]
    v_lshlrev_b32 v240, 16, v25
    v_and_b32 v241, s70, v25
    v_pk_add_f32 v[236:237], v[236:237], v[240:241]
    ds_read_b64_tr_b16 v[112:113], v221 offset:26624
    ds_read_b64_tr_b16 v[114:115], v221 offset:27136
    ds_read_b128 v[116:119], v218 offset:16384
    ds_read_b64_tr_b16 v[120:121], v221 offset:28672
    v_mfma_f32_32x32x16_bf16 v[148:163], v[48:51], v[44:47], v[148:163]
    v_lshlrev_b32 v238, 16, v26
    v_and_b32 v239, s70, v26
    v_pk_add_f32 v[236:237], v[236:237], v[238:239]
    v_lshlrev_b32 v240, 16, v27
    v_and_b32 v241, s70, v27
    v_pk_add_f32 v[236:237], v[236:237], v[240:241]
    ds_read_b64_tr_b16 v[122:123], v221 offset:29184
    ds_read_b128 v[124:127], v219 offset:16384
    ds_read_b64_tr_b16 v[128:129], v221 offset:30720
    ds_read_b64_tr_b16 v[130:131], v221 offset:31232
    v_mfma_f32_32x32x16_bf16 v[132:147], v[56:59], v[52:55], v[132:147]
    v_lshlrev_b32 v238, 16, v32
    v_and_b32 v239, s70, v32
    v_pk_add_f32 v[236:237], v[236:237], v[238:239]
    v_lshlrev_b32 v240, 16, v33
    v_and_b32 v241, s70, v33
    v_pk_add_f32 v[236:237], v[236:237], v[240:241]
    v_mfma_f32_32x32x16_bf16 v[148:163], v[64:67], v[60:63], v[148:163]
    v_lshlrev_b32 v238, 16, v34
    v_and_b32 v239, s70, v34
    v_pk_add_f32 v[236:237], v[236:237], v[238:239]
    v_lshlrev_b32 v240, 16, v35
    v_and_b32 v241, s70, v35
    v_pk_add_f32 v[236:237], v[236:237], v[240:241]
    s_waitcnt lgkmcnt(0)
    s_cmp_eq_u32 s71, 0
    s_cbranch_scc1 L_C_wqb1_9
    s_waitcnt vmcnt(0)
    v_cmp_eq_u64_e64 vcc, v[248:249], s[34:35]
    v_mov_b32 v246, 0x20f00
    s_nop 1
    v_mov_b32 v248, vcc_lo
    v_mov_b32 v249, vcc_hi
    ds_write_b64 v246, v[248:249]
    s_waitcnt lgkmcnt(0)
L_C_wqb1_9:
    s_barrier
    v_mfma_f32_32x32x16_bf16 v[132:147], v[72:75], v[68:71], v[132:147]
    v_lshlrev_b32 v238, 16, v72
    v_and_b32 v239, s70, v72
    v_pk_add_f32 v[236:237], v[236:237], v[238:239]
    v_lshlrev_b32 v240, 16, v73
    v_and_b32 v241, s70, v73
    v_pk_add_f32 v[236:237], v[236:237], v[240:241]
    ds_read_b128 v[4:7], v212 offset:32768
    ds_read_b64_tr_b16 v[8:9], v220 offset:32768
    ds_read_b64_tr_b16 v[10:11], v220 offset:33280
    ds_read_b128 v[12:15], v213 offset:32768
    v_mfma_f32_32x32x16_bf16 v[148:163], v[80:83], v[76:79], v[148:163]
    v_lshlrev_b32 v238, 16, v74
    v_and_b32 v239, s70, v74
    v_pk_add_f32 v[236:237], v[236:237], v[238:239]
    v_lshlrev_b32 v240, 16, v75
    v_and_b32 v241, s70, v75
    v_pk_add_f32 v[236:237], v[236:237], v[240:241]
    ds_read_b64_tr_b16 v[16:17], v220 offset:34816
    ds_read_b64_tr_b16 v[18:19], v220 offset:35328
    ds_read_b128 v[20:23], v214 offset:32768
    ds_read_b64_tr_b16 v[24:25], v220 offset:36864
    v_mfma_f32_32x32x16_bf16 v[132:147], v[88:91], v[84:87], v[132:147]
    v_lshlrev_b32 v238, 16, v80
    v_and_b32 v239, s70, v80
    v_pk_add_f32 v[236:237], v[236:237], v[238:239]
    v_lshlrev_b32 v240, 16, v81
    v_and_b32 v241, s70, v81
    v_pk_add_f32 v[236:237], v[236:237], v[240:241]
    ds_read_b64_tr_b16 v[26:27], v220 offset:37376
    ds_read_b128 v[28:31], v215 offset:32768
    ds_read_b64_tr_b16 v[32:33], v220 offset:38912
    ds_read_b64_tr_b16 v[34:35], v220 offset:39424
    v_mfma_f32_32x32x16_bf16 v[148:163], v[96:99], v[92:95], v[148:163]
    v_lshlrev_b32 v238, 16, v82
    v_and_b32 v239, s70, v82
    v_pk_add_f32 v[236:237], v[236:237], v[238:239]
    v_lshlrev_b32 v240, 16, v83
    v_and_b32 v241, s70, v83
    v_pk_add_f32 v[236:237], v[236:237], v[240:241]
    ds_read_b128 v[36:39], v216 offset:32768
    ds_read_b64_tr_b16 v[40:41], v221 offset:40960
    ds_read_b64_tr_b16 v[42:43], v221 offset:41472
    ds_read_b128 v[44:47], v217 offset:32768
    v_mfma_f32_32x32x16_bf16 v[132:147], v[104:107], v[100:103], v[132:147]
    v_lshlrev_b32 v238, 16, v88
    v_and_b32 v239, s70, v88
    v_pk_add_f32 v[236:237], v[236:237], v[238:239]
    v_lshlrev_b32 v240, 16, v89
    v_and_b32 v241, s70, v89
    v_pk_add_f32 v[236:237], v[236:237], v[240:241]
    ds_read_b64_tr_b16 v[48:49], v221 offset:43008
    ds_read_b64_tr_b16 v[50:51], v221 offset:43520
    ds_read_b128 v[52:55], v218 offset:32768
    ds_read_b64_tr_b16 v[56:57], v221 offset:45056
    v_mfma_f32_32x32x16_bf16 v[148:163], v[112:115], v[108:111], v[148:163]
    v_lshlrev_b32 v238, 16, v90
    v_and_b32 v239, s70, v90
    v_pk_add_f32 v[236:237], v[236:237], v[238:239]
    v_lshlrev_b32 v240, 16, v91
    v_and_b32 v241, s70, v91
    v_pk_add_f32 v[236:237], v[236:237], v[240:241]
    ds_read_b64_tr_b16 v[58:59], v221 offset:45568
    ds_read_b128 v[60:63], v219 offset:32768
    ds_read_b64_tr_b16 v[64:65], v221 offset:47104
    ds_read_b64_tr_b16 v[66:67], v221 offset:47616
    v_mfma_f32_32x32x16_bf16 v[132:147], v[120:123], v[116:119], v[132:147]
    v_lshlrev_b32 v238, 16, v96
    v_and_b32 v239, s70, v96
    v_pk_add_f32 v[236:237], v[236:237], v[238:239]
    v_lshlrev_b32 v240, 16, v97
    v_and_b32 v241, s70, v97
    v_pk_add_f32 v[236:237], v[236:237], v[240:241]
    v_mfma_f32_32x32x16_bf16 v[148:163], v[128:131], v[124:127], v[148:163]
    v_lshlrev_b32 v238, 16, v98
    v_and_b32 v239, s70, v98
    v_pk_add_f32 v[236:237], v[236:237], v[238:239]
    v_lshlrev_b32 v240, 16, v99
    v_and_b32 v241, s70, v99
    v_pk_add_f32 v[236:237], v[236:237], v[240:241]
    s_waitcnt lgkmcnt(0)
    s_barrier
    v_mfma_f32_32x32x16_bf16 v[132:147], v[8:11], v[4:7], v[132:147]
    v_lshlrev_b32 v238, 16, v8
    v_and_b32 v239, s70, v8
    v_pk_add_f32 v[236:237], v[236:237], v[238:239]
    v_lshlrev_b32 v240, 16, v9
    v_and_b32 v241, s70, v9
    v_pk_add_f32 v[236:237], v[236:237], v[240:241]
    ds_read_b128 v[68:71], v212 offset:49152
    ds_read_b64_tr_b16 v[72:73], v220 offset:49152
    ds_read_b64_tr_b16 v[74:75], v220 offset:49664
    ds_read_b128 v[76:79], v213 offset:49152
    v_mfma_f32_32x32x16_bf16 v[148:163], v[16:19], v[12:15], v[148:163]
    v_lshlrev_b32 v238, 16, v10
    v_and_b32 v239, s70, v10
    v_pk_add_f32 v[236:237], v[236:237], v[238:239]
    v_lshlrev_b32 v240, 16, v11
    v_and_b32 v241, s70, v11
    v_pk_add_f32 v[236:237], v[236:237], v[240:241]
    ds_read_b64_tr_b16 v[80:81], v220 offset:51200
    ds_read_b64_tr_b16 v[82:83], v220 offset:51712
    ds_read_b128 v[84:87], v214 offset:49152
    ds_read_b64_tr_b16 v[88:89], v220 offset:53248
    v_mfma_f32_32x32x16_bf16 v[132:147], v[24:27], v[20:23], v[132:147]
    v_lshlrev_b32 v238, 16, v16
    v_and_b32 v239, s70, v16
    v_pk_add_f32 v[236:237], v[236:237], v[238:239]
    v_lshlrev_b32 v240, 16, v17
    v_and_b32 v241, s70, v17
    v_pk_add_f32 v[236:237], v[236:237], v[240:241]
    ds_read_b64_tr_b16 v[90:91], v220 offset:53760
    ds_read_b128 v[92:95], v215 offset:49152
    ds_read_b64_tr_b16 v[96:97], v220 offset:55296
    ds_read_b64_tr_b16 v[98:99], v220 offset:55808
    v_mfma_f32_32x32x16_bf16 v[148:163], v[32:35], v[28:31], v[148:163]
    v_lshlrev_b32 v238, 16, v18
    v_and_b32 v239, s70, v18
    v_pk_add_f32 v[236:237], v[236:237], v[238:239]
    v_lshlrev_b32 v240, 16, v19
    v_and_b32 v241, s70, v19
    v_pk_add_f32 v[236:237], v[236:237], v[240:241]
    ds_read_b128 v[100:103], v216 offset:49152
    ds_read_b64_tr_b16 v[104:105], v221 offset:57344
    ds_read_b64_tr_b16 v[106:107], v221 offset:57856
    ds_read_b128 v[108:111], v217 offset:49152
    v_mfma_f32_32x32x16_bf16 v[132:147], v[40:43], v[36:39], v[132:147]
    v_lshlrev_b32 v238, 16, v24
    v_and_b32 v239, s70, v24
    v_pk_add_f32 v[236:237], v[236:237], v[238:239]
    v_lshlrev_b32 v240, 16, v25
    v_and_b32 v241, s70, v25
    v_pk_add_f32 v[236:237], v[236:237], v[240:241]
    ds_read_b64_tr_b16 v[112:113], v221 offset:59392
    ds_read_b64_tr_b16 v[114:115], v221 offset:59904
    ds_read_b128 v[116:119], v218 offset:49152
    ds_read_b64_tr_b16 v[120:121], v221 offset:61440
    v_mfma_f32_32x32x16_bf16 v[148:163], v[48:51], v[44:47], v[148:163]
    v_lshlrev_b32 v238, 16, v26
    v_and_b32 v239, s70, v26
    v_pk_add_f32 v[236:237], v[236:237], v[238:239]
    v_lshlrev_b32 v240, 16, v27
    v_and_b32 v241, s70, v27
    v_pk_add_f32 v[236:237], v[236:237], v[240:241]
    ds_read_b64_tr_b16 v[122:123], v221 offset:61952
    ds_read_b128 v[124:127], v219 offset:49152
    ds_read_b64_tr_b16 v[128:129], v221 offset:63488
    ds_read_b64_tr_b16 v[130:131], v221 offset:64000
    v_mfma_f32_32x32x16_bf16 v[132:147], v[56:59], v[52:55], v[132:147]
    v_lshlrev_b32 v238, 16, v32
    v_and_b32 v239, s70, v32
    v_pk_add_f32 v[236:237], v[236:237], v[238:239]
    v_lshlrev_b32 v240, 16, v33
    v_and_b32 v241, s70, v33
    v_pk_add_f32 v[236:237], v[236:237], v[240:241]
    v_mfma_f32_32x32x16_bf16 v[148:163], v[64:67], v[60:63], v[148:163]
    v_lshlrev_b32 v238, 16, v34
    v_and_b32 v239, s70, v34
    v_pk_add_f32 v[236:237], v[236:237], v[238:239]
    v_lshlrev_b32 v240, 16, v35
    v_and_b32 v241, s70, v35
    v_pk_add_f32 v[236:237], v[236:237], v[240:241]
    s_waitcnt lgkmcnt(0)
    v_mfma_f32_32x32x16_bf16 v[132:147], v[72:75], v[68:71], v[132:147]
    v_lshlrev_b32 v238, 16, v72
    v_and_b32 v239, s70, v72
    v_pk_add_f32 v[236:237], v[236:237], v[238:239]
    v_lshlrev_b32 v240, 16, v73
    v_and_b32 v241, s70, v73
    v_pk_add_f32 v[236:237], v[236:237], v[240:241]
    v_mfma_f32_32x32x16_bf16 v[148:163], v[80:83], v[76:79], v[148:163]
    v_lshlrev_b32 v238, 16, v74
    v_and_b32 v239, s70, v74
    v_pk_add_f32 v[236:237], v[236:237], v[238:239]
    v_lshlrev_b32 v240, 16, v75
    v_and_b32 v241, s70, v75
    v_pk_add_f32 v[236:237], v[236:237], v[240:241]
    v_mfma_f32_32x32x16_bf16 v[132:147], v[88:91], v[84:87], v[132:147]
    v_lshlrev_b32 v238, 16, v80
    v_and_b32 v239, s70, v80
    v_pk_add_f32 v[236:237], v[236:237], v[238:239]
    v_lshlrev_b32 v240, 16, v81
    v_and_b32 v241, s70, v81
    v_pk_add_f32 v[236:237], v[236:237], v[240:241]
    v_mfma_f32_32x32x16_bf16 v[148:163], v[96:99], v[92:95], v[148:163]
    v_lshlrev_b32 v238, 16, v82
    v_and_b32 v239, s70, v82
    v_pk_add_f32 v[236:237], v[236:237], v[238:239]
    v_lshlrev_b32 v240, 16, v83
    v_and_b32 v241, s70, v83
    v_pk_add_f32 v[236:237], v[236:237], v[240:241]
    v_mfma_f32_32x32x16_bf16 v[132:147], v[104:107], v[100:103], v[132:147]
    v_lshlrev_b32 v238, 16, v88
    v_and_b32 v239, s70, v88
    v_pk_add_f32 v[236:237], v[236:237], v[238:239]
    v_lshlrev_b32 v240, 16, v89
    v_and_b32 v241, s70, v89
    v_pk_add_f32 v[236:237], v[236:237], v[240:241]
    v_mfma_f32_32x32x16_bf16 v[148:163], v[112:115], v[108:111], v[148:163]
    v_lshlrev_b32 v238, 16, v90
    v_and_b32 v239, s70, v90
    v_pk_add_f32 v[236:237], v[236:237], v[238:239]
    v_lshlrev_b32 v240, 16, v91
    v_and_b32 v241, s70, v91
    v_pk_add_f32 v[236:237], v[236:237], v[240:241]
    v_mfma_f32_32x32x16_bf16 v[132:147], v[120:123], v[116:119], v[132:147]
    v_lshlrev_b32 v238, 16, v96
    v_and_b32 v239, s70, v96
    v_pk_add_f32 v[236:237], v[236:237], v[238:239]
    v_lshlrev_b32 v240, 16, v97
    v_and_b32 v241, s70, v97
    v_pk_add_f32 v[236:237], v[236:237], v[240:241]
    v_mfma_f32_32x32x16_bf16 v[148:163], v[128:131], v[124:127], v[148:163]
    v_lshlrev_b32 v238, 16, v98
    v_and_b32 v239, s70, v98
    v_pk_add_f32 v[236:237], v[236:237], v[238:239]
    v_lshlrev_b32 v240, 16, v99
    v_and_b32 v241, s70, v99
    v_pk_add_f32 v[236:237], v[236:237], v[240:241]
    v_add_f32 v236, v236, v237
    v_and_b32 v4, 31, v1
    s_lshl_b32 s48, s51, 5
    s_lshl_b32 s49, s50, 6
    v_mov_b32 v5, v236
    s_nop 1
    v_permlane32_swap_b32 v236, v5
    s_add_u32 s48, s48, s49
    v_add_u32 v4, s48, v4
    v_add_f32 v236, v236, v5
    v_lshlrev_b32 v4, 2, v4
    v_add_u32 v4, 0x20800, v4
    ds_write_b32 v4, v236
    v_pk_add_f32 v[132:133], v[132:133], v[148:149]
    v_pk_add_f32 v[134:135], v[134:135], v[150:151]
    v_pk_add_f32 v[136:137], v[136:137], v[152:153]
    v_pk_add_f32 v[138:139], v[138:139], v[154:155]
    v_pk_add_f32 v[140:141], v[140:141], v[156:157]
    v_pk_add_f32 v[142:143], v[142:143], v[158:159]
    v_pk_add_f32 v[144:145], v[144:145], v[160:161]
    v_pk_add_f32 v[146:147], v[146:147], v[162:163]
    s_waitcnt lgkmcnt(0)
    s_barrier
    ds_read_b32 v6, v243 offset:1024
    ds_read_b32 v7, v243 offset:1536
    v_lshrrev_b32 v4, 5, v1
    v_lshlrev_b32 v4, 4, v4
    s_lshl_b32 s48, s51, 7
    v_add_u32 v4, s48, v4
    v_add_u32 v4, 0x20800, v4
    ds_read_b128 v[20:23], v4 offset:0
    ds_read_b128 v[84:87], v4 offset:256
    ds_read_b128 v[24:27], v4 offset:32
    ds_read_b128 v[88:91], v4 offset:288
    ds_read_b128 v[28:31], v4 offset:64
    ds_read_b128 v[92:95], v4 offset:320
    ds_read_b128 v[32:35], v4 offset:96
    ds_read_b128 v[96:99], v4 offset:352
    s_waitcnt lgkmcnt(0)
    v_pk_add_f32 v[20:21], v[20:21], v[84:85]
    v_pk_add_f32 v[22:23], v[22:23], v[86:87]
    v_pk_add_f32 v[24:25], v[24:25], v[88:89]
    v_pk_add_f32 v[26:27], v[26:27], v[90:91]
    v_pk_add_f32 v[28:29], v[28:29], v[92:93]
    v_pk_add_f32 v[30:31], v[30:31], v[94:95]
    v_pk_add_f32 v[32:33], v[32:33], v[96:97]
    v_pk_add_f32 v[34:35], v[34:35], v[98:99]
    v_rcp_f32 v8, v7
    v_mul_f32 v246, -1.0, v6
    v_mov_b32 v247, v7
    v_mul_f32 v248, 0xc0135761, v8
    v_mul_f32 v249, v8, v8
    v_mul_f32 v249, v249, v8
    v_mul_f32 v249, 0xbdd2d3e8, v249
    v_pk_fma_f32 v[132:133], v[20:21], v[246:247], v[132:133] op_sel_hi:[1,0,1]
    v_pk_fma_f32 v[134:135], v[22:23], v[246:247], v[134:135] op_sel_hi:[1,0,1]
    v_pk_fma_f32 v[136:137], v[24:25], v[246:247], v[136:137] op_sel_hi:[1,0,1]
    v_pk_fma_f32 v[138:139], v[26:27], v[246:247], v[138:139] op_sel_hi:[1,0,1]
    v_pk_fma_f32 v[140:141], v[28:29], v[246:247], v[140:141] op_sel_hi:[1,0,1]
    v_pk_fma_f32 v[142:143], v[30:31], v[246:247], v[142:143] op_sel_hi:[1,0,1]
    v_pk_fma_f32 v[144:145], v[32:33], v[246:247], v[144:145] op_sel_hi:[1,0,1]
    v_pk_fma_f32 v[146:147], v[34:35], v[246:247], v[146:147] op_sel_hi:[1,0,1]
    v_pk_mul_f32 v[36:37], v[132:133], v[132:133]
    v_pk_mul_f32 v[38:39], v[134:135], v[134:135]
    v_pk_mul_f32 v[40:41], v[136:137], v[136:137]
    v_pk_mul_f32 v[42:43], v[138:139], v[138:139]
    v_pk_mul_f32 v[44:45], v[140:141], v[140:141]
    v_pk_mul_f32 v[46:47], v[142:143], v[142:143]
    v_pk_mul_f32 v[48:49], v[144:145], v[144:145]
    v_pk_mul_f32 v[50:51], v[146:147], v[146:147]
    v_pk_fma_f32 v[36:37], v[36:37], v[248:249], v[248:249] op_sel:[0,1,0] op_sel_hi:[1,1,0]
    v_pk_fma_f32 v[38:39], v[38:39], v[248:249], v[248:249] op_sel:[0,1,0] op_sel_hi:[1,1,0]
    v_pk_fma_f32 v[40:41], v[40:41], v[248:249], v[248:249] op_sel:[0,1,0] op_sel_hi:[1,1,0]
    v_pk_fma_f32 v[42:43], v[42:43], v[248:249], v[248:249] op_sel:[0,1,0] op_sel_hi:[1,1,0]
    v_pk_fma_f32 v[44:45], v[44:45], v[248:249], v[248:249] op_sel:[0,1,0] op_sel_hi:[1,1,0]
    v_pk_fma_f32 v[46:47], v[46:47], v[248:249], v[248:249] op_sel:[0,1,0] op_sel_hi:[1,1,0]
    v_pk_fma_f32 v[48:49], v[48:49], v[248:249], v[248:249] op_sel:[0,1,0] op_sel_hi:[1,1,0]
    v_pk_fma_f32 v[50:51], v[50:51], v[248:249], v[248:249] op_sel:[0,1,0] op_sel_hi:[1,1,0]
    v_pk_mul_f32 v[36:37], v[36:37], v[132:133]
    v_pk_mul_f32 v[38:39], v[38:39], v[134:135]
    v_pk_mul_f32 v[40:41], v[40:41], v[136:137]
    v_pk_mul_f32 v[42:43], v[42:43], v[138:139]
    v_pk_mul_f32 v[44:45], v[44:45], v[140:141]
    v_pk_mul_f32 v[46:47], v[46:47], v[142:143]
    v_pk_mul_f32 v[48:49], v[48:49], v[144:145]
    v_pk_mul_f32 v[50:51], v[50:51], v[146:147]
    v_exp_f32 v36, v36
    v_exp_f32 v37, v37
    v_exp_f32 v38, v38
    v_exp_f32 v39, v39
    v_exp_f32 v40, v40
    v_exp_f32 v41, v41
    v_exp_f32 v42, v42
    v_exp_f32 v43, v43
    v_exp_f32 v44, v44
    v_exp_f32 v45, v45
    v_exp_f32 v46, v46
    v_exp_f32 v47, v47
    v_exp_f32 v48, v48
    v_exp_f32 v49, v49
    v_exp_f32 v50, v50
    v_exp_f32 v51, v51
    v_pk_fma_f32 v[36:37], v[36:37], v[246:247], v[246:247] op_sel:[0,1,1] op_sel_hi:[1,1,1]
    v_pk_fma_f32 v[38:39], v[38:39], v[246:247], v[246:247] op_sel:[0,1,1] op_sel_hi:[1,1,1]
    v_pk_fma_f32 v[40:41], v[40:41], v[246:247], v[246:247] op_sel:[0,1,1] op_sel_hi:[1,1,1]
    v_pk_fma_f32 v[42:43], v[42:43], v[246:247], v[246:247] op_sel:[0,1,1] op_sel_hi:[1,1,1]
    v_pk_fma_f32 v[44:45], v[44:45], v[246:247], v[246:247] op_sel:[0,1,1] op_sel_hi:[1,1,1]
    v_pk_fma_f32 v[46:47], v[46:47], v[246:247], v[246:247] op_sel:[0,1,1] op_sel_hi:[1,1,1]
    v_pk_fma_f32 v[48:49], v[48:49], v[246:247], v[246:247] op_sel:[0,1,1] op_sel_hi:[1,1,1]
    v_pk_fma_f32 v[50:51], v[50:51], v[246:247], v[246:247] op_sel:[0,1,1] op_sel_hi:[1,1,1]
    v_rcp_f32 v36, v36
    v_rcp_f32 v37, v37
    v_rcp_f32 v38, v38
    v_rcp_f32 v39, v39
    v_rcp_f32 v40, v40
    v_rcp_f32 v41, v41
    v_rcp_f32 v42, v42
    v_rcp_f32 v43, v43
    v_rcp_f32 v44, v44
    v_rcp_f32 v45, v45
    v_rcp_f32 v46, v46
    v_rcp_f32 v47, v47
    v_rcp_f32 v48, v48
    v_rcp_f32 v49, v49
    v_rcp_f32 v50, v50
    v_rcp_f32 v51, v51
    v_pk_mul_f32 v[132:133], v[132:133], v[36:37]
    v_pk_mul_f32 v[134:135], v[134:135], v[38:39]
    v_pk_mul_f32 v[136:137], v[136:137], v[40:41]
    v_pk_mul_f32 v[138:139], v[138:139], v[42:43]
    v_pk_mul_f32 v[140:141], v[140:141], v[44:45]
    v_pk_mul_f32 v[142:143], v[142:143], v[46:47]
    v_pk_mul_f32 v[144:145], v[144:145], v[48:49]
    v_pk_mul_f32 v[146:147], v[146:147], v[50:51]
    v_cvt_pk_bf16_f32 v52, v132, v133
    v_cvt_pk_bf16_f32 v53, v134, v135
    v_cvt_pk_bf16_f32 v54, v136, v137
    v_cvt_pk_bf16_f32 v55, v138, v139
    v_cvt_pk_bf16_f32 v56, v140, v141
    v_cvt_pk_bf16_f32 v57, v142, v143
    v_cvt_pk_bf16_f32 v58, v144, v145
    v_cvt_pk_bf16_f32 v59, v146, v147
    s_lshl_b32 s48, s27, 1
    s_add_u32 s48, s48, s50
    s_lshl_b32 s48, s48, 5
    s_lshl_b32 s49, s28, 2
    s_add_u32 s48, s48, s49
    s_lshl_b32 s49, s51, 1
    s_add_u32 s48, s48, s49
    s_lshl_b32 s48, s48, 10
    s_mov_b32 s72, s48
    s_add_u32 s48, s72, 0x200000
    buffer_store_dwordx4 v[52:55], v244, s[40:43], s48 offen sc1
    buffer_store_dwordx4 v[56:59], v244, s[40:43], s48 offen offset:1024 sc1
    v_mov_b32 v132, 0
    v_mov_b32 v133, 0
    v_mov_b32 v134, 0
    v_mov_b32 v135, 0
    v_mov_b32 v136, 0
    v_mov_b32 v137, 0
    v_mov_b32 v138, 0
    v_mov_b32 v139, 0
    v_mov_b32 v140, 0
    v_mov_b32 v141, 0
    v_mov_b32 v142, 0
    v_mov_b32 v143, 0
    v_mov_b32 v144, 0
    v_mov_b32 v145, 0
    v_mov_b32 v146, 0
    v_mov_b32 v147, 0
    v_mov_b32 v148, 0
    v_mov_b32 v149, 0
    v_mov_b32 v150, 0
    v_mov_b32 v151, 0
    v_mov_b32 v152, 0
    v_mov_b32 v153, 0
    v_mov_b32 v154, 0
    v_mov_b32 v155, 0
    v_mov_b32 v156, 0
    v_mov_b32 v157, 0
    v_mov_b32 v158, 0
    v_mov_b32 v159, 0
    v_mov_b32 v160, 0
    v_mov_b32 v161, 0
    v_mov_b32 v162, 0
    v_mov_b32 v163, 0
    s_barrier
    ds_read_b128 v[4:7], v222 offset:0
    ds_read_b64_tr_b16 v[8:9], v226 offset:0
    ds_read_b64_tr_b16 v[10:11], v226 offset:256
    ds_read_b64_tr_b16 v[12:13], v226 offset:4096
    ds_read_b64_tr_b16 v[14:15], v226 offset:4352
    ds_read_b64_tr_b16 v[16:17], v226 offset:8192
    ds_read_b64_tr_b16 v[18:19], v226 offset:8448
    ds_read_b128 v[20:23], v223 offset:0
    ds_read_b64_tr_b16 v[24:25], v227 offset:0
    ds_read_b64_tr_b16 v[26:27], v227 offset:256
    ds_read_b64_tr_b16 v[28:29], v227 offset:4096
    ds_read_b64_tr_b16 v[30:31], v227 offset:4352
    ds_read_b64_tr_b16 v[32:33], v227 offset:8192
    ds_read_b64_tr_b16 v[34:35], v227 offset:8448
    ds_read_b128 v[36:39], v224 offset:0
    ds_read_b64_tr_b16 v[40:41], v228 offset:0
    ds_read_b64_tr_b16 v[42:43], v228 offset:256
    ds_read_b64_tr_b16 v[44:45], v228 offset:4096
    ds_read_b64_tr_b16 v[46:47], v228 offset:4352
    ds_read_b64_tr_b16 v[48:49], v228 offset:8192
    ds_read_b64_tr_b16 v[50:51], v228 offset:8448
    ds_read_b128 v[52:55], v225 offset:0
    ds_read_b64_tr_b16 v[56:57], v229 offset:0
    ds_read_b64_tr_b16 v[58:59], v229 offset:256
    ds_read_b64_tr_b16 v[60:61], v229 offset:4096
    ds_read_b64_tr_b16 v[62:63], v229 offset:4352
    ds_read_b64_tr_b16 v[64:65], v229 offset:8192
    ds_read_b64_tr_b16 v[66:67], v229 offset:8448
    s_waitcnt lgkmcnt(0)
    s_barrier
    v_mfma_f32_32x32x16_bf16 v[132:147], v[8:11], v[4:7], v[132:147]
    ds_read_b128 v[68:71], v222 offset:16384
    ds_read_b64_tr_b16 v[72:73], v226 offset:16384
    ds_read_b64_tr_b16 v[74:75], v226 offset:16640
    v_mfma_f32_32x32x16_bf16 v[148:163], v[4:7], v[12:15], v[148:163]
    ds_read_b64_tr_b16 v[76:77], v226 offset:20480
    ds_read_b64_tr_b16 v[78:79], v226 offset:20736
    ds_read_b64_tr_b16 v[80:81], v226 offset:24576
    v_mfma_f32_32x32x16_bf16 v[164:179], v[4:7], v[16:19], v[164:179]
    ds_read_b64_tr_b16 v[82:83], v226 offset:24832
    ds_read_b128 v[84:87], v223 offset:16384
    ds_read_b64_tr_b16 v[88:89], v227 offset:16384
    v_mfma_f32_32x32x16_bf16 v[132:147], v[24:27], v[20:23], v[132:147]
    ds_read_b64_tr_b16 v[90:91], v227 offset:16640
    ds_read_b64_tr_b16 v[92:93], v227 offset:20480
    ds_read_b64_tr_b16 v[94:95], v227 offset:20736
    v_mfma_f32_32x32x16_bf16 v[148:163], v[20:23], v[28:31], v[148:163]
    ds_read_b64_tr_b16 v[96:97], v227 offset:24576
    ds_read_b64_tr_b16 v[98:99], v227 offset:24832
    ds_read_b128 v[100:103], v224 offset:16384
    v_mfma_f32_32x32x16_bf16 v[164:179], v[20:23], v[32:35], v[164:179]
    ds_read_b64_tr_b16 v[104:105], v228 offset:16384
    ds_read_b64_tr_b16 v[106:107], v228 offset:16640
    ds_read_b64_tr_b16 v[108:109], v228 offset:20480
    v_mfma_f32_32x32x16_bf16 v[132:147], v[40:43], v[36:39], v[132:147]
    ds_read_b64_tr_b16 v[110:111], v228 offset:20736
    ds_read_b64_tr_b16 v[112:113], v228 offset:24576
    ds_read_b64_tr_b16 v[114:115], v228 offset:24832
    v_mfma_f32_32x32x16_bf16 v[148:163], v[36:39], v[44:47], v[148:163]
    ds_read_b128 v[116:119], v225 offset:16384
    ds_read_b64_tr_b16 v[120:121], v229 offset:16384
    ds_read_b64_tr_b16 v[122:123], v229 offset:16640
    v_mfma_f32_32x32x16_bf16 v[164:179], v[36:39], v[48:51], v[164:179]
    ds_read_b64_tr_b16 v[124:125], v229 offset:20480
    ds_read_b64_tr_b16 v[126:127], v229 offset:20736
    ds_read_b64_tr_b16 v[128:129], v229 offset:24576
    v_mfma_f32_32x32x16_bf16 v[132:147], v[56:59], v[52:55], v[132:147]
    ds_read_b64_tr_b16 v[130:131], v229 offset:24832
    v_mfma_f32_32x32x16_bf16 v[148:163], v[52:55], v[60:63], v[148:163]
    v_mfma_f32_32x32x16_bf16 v[164:179], v[52:55], v[64:67], v[164:179]
    s_waitcnt lgkmcnt(0)
    s_barrier
    v_mfma_f32_32x32x16_bf16 v[132:147], v[72:75], v[68:71], v[132:147]
    ds_read_b128 v[4:7], v222 offset:32768
    ds_read_b64_tr_b16 v[8:9], v226 offset:32768
    ds_read_b64_tr_b16 v[10:11], v226 offset:33024
    v_mfma_f32_32x32x16_bf16 v[148:163], v[68:71], v[76:79], v[148:163]
    ds_read_b64_tr_b16 v[12:13], v226 offset:36864
    ds_read_b64_tr_b16 v[14:15], v226 offset:37120
    ds_read_b64_tr_b16 v[16:17], v226 offset:40960
    v_mfma_f32_32x32x16_bf16 v[164:179], v[68:71], v[80:83], v[164:179]
    ds_read_b64_tr_b16 v[18:19], v226 offset:41216
    ds_read_b128 v[20:23], v223 offset:32768
    ds_read_b64_tr_b16 v[24:25], v227 offset:32768
    v_mfma_f32_32x32x16_bf16 v[132:147], v[88:91], v[84:87], v[132:147]
    ds_read_b64_tr_b16 v[26:27], v227 offset:33024
    ds_read_b64_tr_b16 v[28:29], v227 offset:36864
    ds_read_b64_tr_b16 v[30:31], v227 offset:37120
    v_mfma_f32_32x32x16_bf16 v[148:163], v[84:87], v[92:95], v[148:163]
    ds_read_b64_tr_b16 v[32:33], v227 offset:40960
    ds_read_b64_tr_b16 v[34:35], v227 offset:41216
    ds_read_b128 v[36:39], v224 offset:32768
    v_mfma_f32_32x32x16_bf16 v[164:179], v[84:87], v[96:99], v[164:179]
    ds_read_b64_tr_b16 v[40:41], v228 offset:32768
    ds_read_b64_tr_b16 v[42:43], v228 offset:33024
    ds_read_b64_tr_b16 v[44:45], v228 offset:36864
    v_mfma_f32_32x32x16_bf16 v[132:147], v[104:107], v[100:103], v[132:147]
    ds_read_b64_tr_b16 v[46:47], v228 offset:37120
    ds_read_b64_tr_b16 v[48:49], v228 offset:40960
    ds_read_b64_tr_b16 v[50:51], v228 offset:41216
    v_mfma_f32_32x32x16_bf16 v[148:163], v[100:103], v[108:111], v[148:163]
    ds_read_b128 v[52:55], v225 offset:32768
    ds_read_b64_tr_b16 v[56:57], v229 offset:32768
    ds_read_b64_tr_b16 v[58:59], v229 offset:33024
    v_mfma_f32_32x32x16_bf16 v[164:179], v[100:103], v[112:115], v[164:179]
    ds_read_b64_tr_b16 v[60:61], v229 offset:36864
    ds_read_b64_tr_b16 v[62:63], v229 offset:37120
    ds_read_b64_tr_b16 v[64:65], v229 offset:40960
    v_mfma_f32_32x32x16_bf16 v[132:147], v[120:123], v[116:119], v[132:147]
    ds_read_b64_tr_b16 v[66:67], v229 offset:41216
    v_mfma_f32_32x32x16_bf16 v[148:163], v[116:119], v[124:127], v[148:163]
    v_mfma_f32_32x32x16_bf16 v[164:179], v[116:119], v[128:131], v[164:179]
    s_waitcnt lgkmcnt(0)
    s_waitcnt vmcnt(0)
    s_mov_b64 exec, 1
    v_mov_b32 v246, 0x20e00
    v_mov_b32 v247, 1
    ds_add_rtn_u32 v248, v246, v247
    s_lshl_b32 s52, s27, 3
    s_add_u32 s52, s52, s28
    s_lshl_b32 s52, s52, 3
    s_add_u32 s52, s52, 0x0
    s_waitcnt lgkmcnt(0)
    v_readfirstlane_b32 s48, v248
    s_cmp_eq_u32 s48, 3
    s_cbranch_scc0 L_C_sig_10
    v_mov_b32 v246, s34
    v_mov_b32 v247, s35
    v_mov_b32 v248, s52
    buffer_store_dwordx2 v[246:247], v248, s[40:43], 0 offen sc1
L_C_sig_10:
    s_mov_b64 exec, -1
    s_barrier
    v_mfma_f32_32x32x16_bf16 v[132:147], v[8:11], v[4:7], v[132:147]
    ds_read_b128 v[68:71], v222 offset:49152
    ds_read_b64_tr_b16 v[72:73], v226 offset:49152
    ds_read_b64_tr_b16 v[74:75], v226 offset:49408
    v_mfma_f32_32x32x16_bf16 v[148:163], v[4:7], v[12:15], v[148:163]
    ds_read_b64_tr_b16 v[76:77], v226 offset:53248
    ds_read_b64_tr_b16 v[78:79], v226 offset:53504
    ds_read_b64_tr_b16 v[80:81], v226 offset:57344
    v_mfma_f32_32x32x16_bf16 v[164:179], v[4:7], v[16:19], v[164:179]
    ds_read_b64_tr_b16 v[82:83], v226 offset:57600
    ds_read_b128 v[84:87], v223 offset:49152
    ds_read_b64_tr_b16 v[88:89], v227 offset:49152
    v_mfma_f32_32x32x16_bf16 v[132:147], v[24:27], v[20:23], v[132:147]
    ds_read_b64_tr_b16 v[90:91], v227 offset:49408
    ds_read_b64_tr_b16 v[92:93], v227 offset:53248
    ds_read_b64_tr_b16 v[94:95], v227 offset:53504
    v_mfma_f32_32x32x16_bf16 v[148:163], v[20:23], v[28:31], v[148:163]
    ds_read_b64_tr_b16 v[96:97], v227 offset:57344
    ds_read_b64_tr_b16 v[98:99], v227 offset:57600
    ds_read_b128 v[100:103], v224 offset:49152
    v_mfma_f32_32x32x16_bf16 v[164:179], v[20:23], v[32:35], v[164:179]
    ds_read_b64_tr_b16 v[104:105], v228 offset:49152
    ds_read_b64_tr_b16 v[106:107], v228 offset:49408
    ds_read_b64_tr_b16 v[108:109], v228 offset:53248
    v_mfma_f32_32x32x16_bf16 v[132:147], v[40:43], v[36:39], v[132:147]
    ds_read_b64_tr_b16 v[110:111], v228 offset:53504
    ds_read_b64_tr_b16 v[112:113], v228 offset:57344
    ds_read_b64_tr_b16 v[114:115], v228 offset:57600
    v_mfma_f32_32x32x16_bf16 v[148:163], v[36:39], v[44:47], v[148:163]
    ds_read_b128 v[116:119], v225 offset:49152
    ds_read_b64_tr_b16 v[120:121], v229 offset:49152
    ds_read_b64_tr_b16 v[122:123], v229 offset:49408
    v_mfma_f32_32x32x16_bf16 v[164:179], v[36:39], v[48:51], v[164:179]
    ds_read_b64_tr_b16 v[124:125], v229 offset:53248
    ds_read_b64_tr_b16 v[126:127], v229 offset:53504
    ds_read_b64_tr_b16 v[128:129], v229 offset:57344
    v_mfma_f32_32x32x16_bf16 v[132:147], v[56:59], v[52:55], v[132:147]
    ds_read_b64_tr_b16 v[130:131], v229 offset:57600
    v_mfma_f32_32x32x16_bf16 v[148:163], v[52:55], v[60:63], v[148:163]
    v_mfma_f32_32x32x16_bf16 v[164:179], v[52:55], v[64:67], v[164:179]
    s_waitcnt lgkmcnt(0)
    s_barrier
    v_mfma_f32_32x32x16_bf16 v[132:147], v[72:75], v[68:71], v[132:147]
    ds_read_b128 v[4:7], v222 offset:0
    ds_read_b64_tr_b16 v[8:9], v226 offset:0
    ds_read_b64_tr_b16 v[10:11], v226 offset:256
    v_mfma_f32_32x32x16_bf16 v[148:163], v[68:71], v[76:79], v[148:163]
    ds_read_b64_tr_b16 v[12:13], v226 offset:4096
    ds_read_b64_tr_b16 v[14:15], v226 offset:4352
    ds_read_b64_tr_b16 v[16:17], v226 offset:8192
    v_mfma_f32_32x32x16_bf16 v[164:179], v[68:71], v[80:83], v[164:179]
    ds_read_b64_tr_b16 v[18:19], v226 offset:8448
    ds_read_b128 v[20:23], v223 offset:0
    ds_read_b64_tr_b16 v[24:25], v227 offset:0
    v_mfma_f32_32x32x16_bf16 v[132:147], v[88:91], v[84:87], v[132:147]
    ds_read_b64_tr_b16 v[26:27], v227 offset:256
    ds_read_b64_tr_b16 v[28:29], v227 offset:4096
    ds_read_b64_tr_b16 v[30:31], v227 offset:4352
    v_mfma_f32_32x32x16_bf16 v[148:163], v[84:87], v[92:95], v[148:163]
    ds_read_b64_tr_b16 v[32:33], v227 offset:8192
    ds_read_b64_tr_b16 v[34:35], v227 offset:8448
    ds_read_b128 v[36:39], v224 offset:0
    v_mfma_f32_32x32x16_bf16 v[164:179], v[84:87], v[96:99], v[164:179]
    ds_read_b64_tr_b16 v[40:41], v228 offset:0
    ds_read_b64_tr_b16 v[42:43], v228 offset:256
    ds_read_b64_tr_b16 v[44:45], v228 offset:4096
    v_mfma_f32_32x32x16_bf16 v[132:147], v[104:107], v[100:103], v[132:147]
    ds_read_b64_tr_b16 v[46:47], v228 offset:4352
    ds_read_b64_tr_b16 v[48:49], v228 offset:8192
    ds_read_b64_tr_b16 v[50:51], v228 offset:8448
    v_mfma_f32_32x32x16_bf16 v[148:163], v[100:103], v[108:111], v[148:163]
    ds_read_b128 v[52:55], v225 offset:0
    ds_read_b64_tr_b16 v[56:57], v229 offset:0
    ds_read_b64_tr_b16 v[58:59], v229 offset:256
    v_mfma_f32_32x32x16_bf16 v[164:179], v[100:103], v[112:115], v[164:179]
    ds_read_b64_tr_b16 v[60:61], v229 offset:4096
    ds_read_b64_tr_b16 v[62:63], v229 offset:4352
    ds_read_b64_tr_b16 v[64:65], v229 offset:8192
    v_mfma_f32_32x32x16_bf16 v[132:147], v[120:123], v[116:119], v[132:147]
    ds_read_b64_tr_b16 v[66:67], v229 offset:8448
    v_mfma_f32_32x32x16_bf16 v[148:163], v[116:119], v[124:127], v[148:163]
    v_mfma_f32_32x32x16_bf16 v[164:179], v[116:119], v[128:131], v[164:179]
    s_waitcnt lgkmcnt(0)
    s_barrier
    v_mfma_f32_32x32x16_bf16 v[132:147], v[8:11], v[4:7], v[132:147]
    ds_read_b128 v[68:71], v222 offset:16384
    ds_read_b64_tr_b16 v[72:73], v226 offset:16384
    ds_read_b64_tr_b16 v[74:75], v226 offset:16640
    v_mfma_f32_32x32x16_bf16 v[148:163], v[4:7], v[12:15], v[148:163]
    ds_read_b64_tr_b16 v[76:77], v226 offset:20480
    ds_read_b64_tr_b16 v[78:79], v226 offset:20736
    ds_read_b64_tr_b16 v[80:81], v226 offset:24576
    v_mfma_f32_32x32x16_bf16 v[164:179], v[4:7], v[16:19], v[164:179]
    ds_read_b64_tr_b16 v[82:83], v226 offset:24832
    ds_read_b128 v[84:87], v223 offset:16384
    ds_read_b64_tr_b16 v[88:89], v227 offset:16384
    v_mfma_f32_32x32x16_bf16 v[132:147], v[24:27], v[20:23], v[132:147]
    ds_read_b64_tr_b16 v[90:91], v227 offset:16640
    ds_read_b64_tr_b16 v[92:93], v227 offset:20480
    ds_read_b64_tr_b16 v[94:95], v227 offset:20736
    v_mfma_f32_32x32x16_bf16 v[148:163], v[20:23], v[28:31], v[148:163]
    ds_read_b64_tr_b16 v[96:97], v227 offset:24576
    ds_read_b64_tr_b16 v[98:99], v227 offset:24832
    ds_read_b128 v[100:103], v224 offset:16384
    v_mfma_f32_32x32x16_bf16 v[164:179], v[20:23], v[32:35], v[164:179]
    ds_read_b64_tr_b16 v[104:105], v228 offset:16384
    ds_read_b64_tr_b16 v[106:107], v228 offset:16640
    ds_read_b64_tr_b16 v[108:109], v228 offset:20480
    v_mfma_f32_32x32x16_bf16 v[132:147], v[40:43], v[36:39], v[132:147]
    ds_read_b64_tr_b16 v[110:111], v228 offset:20736
    ds_read_b64_tr_b16 v[112:113], v228 offset:24576
    ds_read_b64_tr_b16 v[114:115], v228 offset:24832
    v_mfma_f32_32x32x16_bf16 v[148:163], v[36:39], v[44:47], v[148:163]
    ds_read_b128 v[116:119], v225 offset:16384
    ds_read_b64_tr_b16 v[120:121], v229 offset:16384
    ds_read_b64_tr_b16 v[122:123], v229 offset:16640
    v_mfma_f32_32x32x16_bf16 v[164:179], v[36:39], v[48:51], v[164:179]
    ds_read_b64_tr_b16 v[124:125], v229 offset:20480
    ds_read_b64_tr_b16 v[126:127], v229 offset:20736
    ds_read_b64_tr_b16 v[128:129], v229 offset:24576
    v_mfma_f32_32x32x16_bf16 v[132:147], v[56:59], v[52:55], v[132:147]
    ds_read_b64_tr_b16 v[130:131], v229 offset:24832
    v_mfma_f32_32x32x16_bf16 v[148:163], v[52:55], v[60:63], v[148:163]
    v_mfma_f32_32x32x16_bf16 v[164:179], v[52:55], v[64:67], v[164:179]
    s_waitcnt lgkmcnt(0)
    s_barrier
    v_mfma_f32_32x32x16_bf16 v[132:147], v[72:75], v[68:71], v[132:147]
    ds_read_b128 v[4:7], v222 offset:32768
    ds_read_b64_tr_b16 v[8:9], v226 offset:32768
    ds_read_b64_tr_b16 v[10:11], v226 offset:33024
    v_mfma_f32_32x32x16_bf16 v[148:163], v[68:71], v[76:79], v[148:163]
    ds_read_b64_tr_b16 v[12:13], v226 offset:36864
    ds_read_b64_tr_b16 v[14:15], v226 offset:37120
    ds_read_b64_tr_b16 v[16:17], v226 offset:40960
    v_mfma_f32_32x32x16_bf16 v[164:179], v[68:71], v[80:83], v[164:179]
    ds_read_b64_tr_b16 v[18:19], v226 offset:41216
    ds_read_b128 v[20:23], v223 offset:32768
    ds_read_b64_tr_b16 v[24:25], v227 offset:32768
    v_mfma_f32_32x32x16_bf16 v[132:147], v[88:91], v[84:87], v[132:147]
    ds_read_b64_tr_b16 v[26:27], v227 offset:33024
    ds_read_b64_tr_b16 v[28:29], v227 offset:36864
    ds_read_b64_tr_b16 v[30:31], v227 offset:37120
    v_mfma_f32_32x32x16_bf16 v[148:163], v[84:87], v[92:95], v[148:163]
    ds_read_b64_tr_b16 v[32:33], v227 offset:40960
    ds_read_b64_tr_b16 v[34:35], v227 offset:41216
    ds_read_b128 v[36:39], v224 offset:32768
    v_mfma_f32_32x32x16_bf16 v[164:179], v[84:87], v[96:99], v[164:179]
    ds_read_b64_tr_b16 v[40:41], v228 offset:32768
    ds_read_b64_tr_b16 v[42:43], v228 offset:33024
    ds_read_b64_tr_b16 v[44:45], v228 offset:36864
    v_mfma_f32_32x32x16_bf16 v[132:147], v[104:107], v[100:103], v[132:147]
    ds_read_b64_tr_b16 v[46:47], v228 offset:37120
    ds_read_b64_tr_b16 v[48:49], v228 offset:40960
    ds_read_b64_tr_b16 v[50:51], v228 offset:41216
    v_mfma_f32_32x32x16_bf16 v[148:163], v[100:103], v[108:111], v[148:163]
    ds_read_b128 v[52:55], v225 offset:32768
    ds_read_b64_tr_b16 v[56:57], v229 offset:32768
    ds_read_b64_tr_b16 v[58:59], v229 offset:33024
    v_mfma_f32_32x32x16_bf16 v[164:179], v[100:103], v[112:115], v[164:179]
    ds_read_b64_tr_b16 v[60:61], v229 offset:36864
    ds_read_b64_tr_b16 v[62:63], v229 offset:37120
    ds_read_b64_tr_b16 v[64:65], v229 offset:40960
    v_mfma_f32_32x32x16_bf16 v[132:147], v[120:123], v[116:119], v[132:147]
    ds_read_b64_tr_b16 v[66:67], v229 offset:41216
    v_mfma_f32_32x32x16_bf16 v[148:163], v[116:119], v[124:127], v[148:163]
    v_mfma_f32_32x32x16_bf16 v[164:179], v[116:119], v[128:131], v[164:179]
    s_waitcnt lgkmcnt(0)
    s_barrier
    v_mfma_f32_32x32x16_bf16 v[132:147], v[8:11], v[4:7], v[132:147]
    ds_read_b128 v[68:71], v222 offset:49152
    ds_read_b64_tr_b16 v[72:73], v226 offset:49152
    ds_read_b64_tr_b16 v[74:75], v226 offset:49408
    v_mfma_f32_32x32x16_bf16 v[148:163], v[4:7], v[12:15], v[148:163]
    ds_read_b64_tr_b16 v[76:77], v226 offset:53248
    ds_read_b64_tr_b16 v[78:79], v226 offset:53504
    ds_read_b64_tr_b16 v[80:81], v226 offset:57344
    v_mfma_f32_32x32x16_bf16 v[164:179], v[4:7], v[16:19], v[164:179]
    ds_read_b64_tr_b16 v[82:83], v226 offset:57600
    ds_read_b128 v[84:87], v223 offset:49152
    ds_read_b64_tr_b16 v[88:89], v227 offset:49152
    v_mfma_f32_32x32x16_bf16 v[132:147], v[24:27], v[20:23], v[132:147]
    ds_read_b64_tr_b16 v[90:91], v227 offset:49408
    ds_read_b64_tr_b16 v[92:93], v227 offset:53248
    ds_read_b64_tr_b16 v[94:95], v227 offset:53504
    v_mfma_f32_32x32x16_bf16 v[148:163], v[20:23], v[28:31], v[148:163]
    ds_read_b64_tr_b16 v[96:97], v227 offset:57344
    ds_read_b64_tr_b16 v[98:99], v227 offset:57600
    ds_read_b128 v[100:103], v224 offset:49152
    v_mfma_f32_32x32x16_bf16 v[164:179], v[20:23], v[32:35], v[164:179]
    ds_read_b64_tr_b16 v[104:105], v228 offset:49152
    ds_read_b64_tr_b16 v[106:107], v228 offset:49408
    ds_read_b64_tr_b16 v[108:109], v228 offset:53248
    v_mfma_f32_32x32x16_bf16 v[132:147], v[40:43], v[36:39], v[132:147]
    ds_read_b64_tr_b16 v[110:111], v228 offset:53504
    ds_read_b64_tr_b16 v[112:113], v228 offset:57344
    ds_read_b64_tr_b16 v[114:115], v228 offset:57600
    v_mfma_f32_32x32x16_bf16 v[148:163], v[36:39], v[44:47], v[148:163]
    ds_read_b128 v[116:119], v225 offset:49152
    ds_read_b64_tr_b16 v[120:121], v229 offset:49152
    ds_read_b64_tr_b16 v[122:123], v229 offset:49408
    v_mfma_f32_32x32x16_bf16 v[164:179], v[36:39], v[48:51], v[164:179]
    ds_read_b64_tr_b16 v[124:125], v229 offset:53248
    ds_read_b64_tr_b16 v[126:127], v229 offset:53504
    ds_read_b64_tr_b16 v[128:129], v229 offset:57344
    v_mfma_f32_32x32x16_bf16 v[132:147], v[56:59], v[52:55], v[132:147]
    ds_read_b64_tr_b16 v[130:131], v229 offset:57600
    v_mfma_f32_32x32x16_bf16 v[148:163], v[52:55], v[60:63], v[148:163]
    v_mfma_f32_32x32x16_bf16 v[164:179], v[52:55], v[64:67], v[164:179]
    s_waitcnt lgkmcnt(0)
    v_mfma_f32_32x32x16_bf16 v[132:147], v[72:75], v[68:71], v[132:147]
    v_mfma_f32_32x32x16_bf16 v[148:163], v[68:71], v[76:79], v[148:163]
    v_mfma_f32_32x32x16_bf16 v[164:179], v[68:71], v[80:83], v[164:179]
    v_mfma_f32_32x32x16_bf16 v[132:147], v[88:91], v[84:87], v[132:147]
    v_mfma_f32_32x32x16_bf16 v[148:163], v[84:87], v[92:95], v[148:163]
    v_mfma_f32_32x32x16_bf16 v[164:179], v[84:87], v[96:99], v[164:179]
    v_mfma_f32_32x32x16_bf16 v[132:147], v[104:107], v[100:103], v[132:147]
    v_mfma_f32_32x32x16_bf16 v[148:163], v[100:103], v[108:111], v[148:163]
    v_mfma_f32_32x32x16_bf16 v[164:179], v[100:103], v[112:115], v[164:179]
    v_mfma_f32_32x32x16_bf16 v[132:147], v[120:123], v[116:119], v[132:147]
    v_mfma_f32_32x32x16_bf16 v[148:163], v[116:119], v[124:127], v[148:163]
    v_mfma_f32_32x32x16_bf16 v[164:179], v[116:119], v[128:131], v[164:179]
    v_and_b32 v4, 31, v1
    v_lshlrev_b32 v4, 2, v4
    v_add_u32 v4, 0x20a00, v4
    s_barrier
    ds_read_b32 v6, v4 offset:128
    ds_read_b32 v7, v4 offset:256
    v_mov_b32 v68, 0x20e20
    ds_read_b32 v68, v68
    v_and_b32 v10, 31, v1
    s_lshl_b32 s48, s24, 5
    v_add_u32 v10, s48, v10
    v_lshlrev_b32 v10, 2, v10
    v_add_u32 v10, 0x20000, v10
    ds_read_b32 v8, v10 offset:0
    ds_read_b32 v9, v10 offset:512
    v_lshrrev_b32 v11, 5, v1
    v_lshlrev_b32 v11, 4, v11
    v_add_u32 v10, 0x20a00, v11
    ds_read_b128 v[20:23], v10 offset:0
    ds_read_b128 v[24:27], v10 offset:32
    ds_read_b128 v[28:31], v10 offset:64
    ds_read_b128 v[32:35], v10 offset:96
    s_lshl_b32 s48, s24, 7
    s_add_u32 s48, s48, 0x20000
    v_add_u32 v10, s48, v11
    ds_read_b128 v[36:39], v10 offset:0
    ds_read_b128 v[52:55], v10 offset:512
    ds_read_b128 v[40:43], v10 offset:32
    ds_read_b128 v[56:59], v10 offset:544
    ds_read_b128 v[44:47], v10 offset:64
    ds_read_b128 v[60:63], v10 offset:576
    ds_read_b128 v[48:51], v10 offset:96
    ds_read_b128 v[64:67], v10 offset:608
    s_waitcnt lgkmcnt(0)
    v_readfirstlane_b32 s53, v68
    v_mul_f32 v246, -1.0, v6
    v_mul_f32 v247, -1.0, v7
    v_pk_fma_f32 v[148:149], v[36:37], v[246:247], v[148:149] op_sel_hi:[1,0,1]
    v_pk_fma_f32 v[150:151], v[38:39], v[246:247], v[150:151] op_sel_hi:[1,0,1]
    v_pk_fma_f32 v[152:153], v[40:41], v[246:247], v[152:153] op_sel_hi:[1,0,1]
    v_pk_fma_f32 v[154:155], v[42:43], v[246:247], v[154:155] op_sel_hi:[1,0,1]
    v_pk_fma_f32 v[156:157], v[44:45], v[246:247], v[156:157] op_sel_hi:[1,0,1]
    v_pk_fma_f32 v[158:159], v[46:47], v[246:247], v[158:159] op_sel_hi:[1,0,1]
    v_pk_fma_f32 v[160:161], v[48:49], v[246:247], v[160:161] op_sel_hi:[1,0,1]
    v_pk_fma_f32 v[162:163], v[50:51], v[246:247], v[162:163] op_sel_hi:[1,0,1]
    v_pk_mul_f32 v[148:149], v[148:149], v[52:53]
    v_pk_mul_f32 v[150:151], v[150:151], v[54:55]
    v_pk_mul_f32 v[152:153], v[152:153], v[56:57]
    v_pk_mul_f32 v[154:155], v[154:155], v[58:59]
    v_pk_mul_f32 v[156:157], v[156:157], v[60:61]
    v_pk_mul_f32 v[158:159], v[158:159], v[62:63]
    v_pk_mul_f32 v[160:161], v[160:161], v[64:65]
    v_pk_mul_f32 v[162:163], v[162:163], v[66:67]
    v_pk_mul_f32 v[68:69], v[148:149], s[54:55]
    v_pk_mul_f32 v[70:71], v[150:151], s[54:55]
    v_pk_mul_f32 v[72:73], v[152:153], s[54:55]
    v_pk_mul_f32 v[74:75], v[154:155], s[54:55]
    v_pk_mul_f32 v[76:77], v[156:157], s[54:55]
    v_pk_mul_f32 v[78:79], v[158:159], s[54:55]
    v_pk_mul_f32 v[80:81], v[160:161], s[54:55]
    v_pk_mul_f32 v[82:83], v[162:163], s[54:55]
    v_exp_f32_e64 v68, v68 clamp
    v_exp_f32_e64 v69, v69 clamp
    v_exp_f32_e64 v70, v70 clamp
    v_exp_f32_e64 v71, v71 clamp
    v_exp_f32_e64 v72, v72 clamp
    v_exp_f32_e64 v73, v73 clamp
    v_exp_f32_e64 v74, v74 clamp
    v_exp_f32_e64 v75, v75 clamp
    v_exp_f32_e64 v76, v76 clamp
    v_exp_f32_e64 v77, v77 clamp
    v_exp_f32_e64 v78, v78 clamp
    v_exp_f32_e64 v79, v79 clamp
    v_exp_f32_e64 v80, v80 clamp
    v_exp_f32_e64 v81, v81 clamp
    v_exp_f32_e64 v82, v82 clamp
    v_exp_f32_e64 v83, v83 clamp
    v_max_f32 v148, 0, v148
    v_max_f32 v149, 0, v149
    v_max_f32 v150, 0, v150
    v_max_f32 v151, 0, v151
    v_max_f32 v152, 0, v152
    v_max_f32 v153, 0, v153
    v_max_f32 v154, 0, v154
    v_max_f32 v155, 0, v155
    v_max_f32 v156, 0, v156
    v_max_f32 v157, 0, v157
    v_max_f32 v158, 0, v158
    v_max_f32 v159, 0, v159
    v_max_f32 v160, 0, v160
    v_max_f32 v161, 0, v161
    v_max_f32 v162, 0, v162
    v_max_f32 v163, 0, v163
    v_pk_add_f32 v[148:149], v[148:149], v[68:69]
    v_pk_add_f32 v[150:151], v[150:151], v[70:71]
    v_pk_add_f32 v[152:153], v[152:153], v[72:73]
    v_pk_add_f32 v[154:155], v[154:155], v[74:75]
    v_pk_add_f32 v[156:157], v[156:157], v[76:77]
    v_pk_add_f32 v[158:159], v[158:159], v[78:79]
    v_pk_add_f32 v[160:161], v[160:161], v[80:81]
    v_pk_add_f32 v[162:163], v[162:163], v[82:83]
    v_pk_add_f32 v[148:149], v[148:149], s[56:57]
    v_pk_add_f32 v[150:151], v[150:151], s[56:57]
    v_pk_add_f32 v[152:153], v[152:153], s[56:57]
    v_pk_add_f32 v[154:155], v[154:155], s[56:57]
    v_pk_add_f32 v[156:157], v[156:157], s[56:57]
    v_pk_add_f32 v[158:159], v[158:159], s[56:57]
    v_pk_add_f32 v[160:161], v[160:161], s[56:57]
    v_pk_add_f32 v[162:163], v[162:163], s[56:57]
    v_cvt_pk_bf16_f32 v100, v148, v149
    v_cvt_pk_bf16_f32 v101, v150, v151
    v_cvt_pk_bf16_f32 v102, v152, v153
    v_cvt_pk_bf16_f32 v103, v154, v155
    v_cvt_pk_bf16_f32 v104, v156, v157
    v_cvt_pk_bf16_f32 v105, v158, v159
    v_cvt_pk_bf16_f32 v106, v160, v161
    v_cvt_pk_bf16_f32 v107, v162, v163
    v_pk_fma_f32 v[164:165], v[36:37], v[246:247], v[164:165] op_sel:[0,1,0] op_sel_hi:[1,1,1]
    v_pk_fma_f32 v[166:167], v[38:39], v[246:247], v[166:167] op_sel:[0,1,0] op_sel_hi:[1,1,1]
    v_pk_fma_f32 v[168:169], v[40:41], v[246:247], v[168:169] op_sel:[0,1,0] op_sel_hi:[1,1,1]
    v_pk_fma_f32 v[170:171], v[42:43], v[246:247], v[170:171] op_sel:[0,1,0] op_sel_hi:[1,1,1]
    v_pk_fma_f32 v[172:173], v[44:45], v[246:247], v[172:173] op_sel:[0,1,0] op_sel_hi:[1,1,1]
    v_pk_fma_f32 v[174:175], v[46:47], v[246:247], v[174:175] op_sel:[0,1,0] op_sel_hi:[1,1,1]
    v_pk_fma_f32 v[176:177], v[48:49], v[246:247], v[176:177] op_sel:[0,1,0] op_sel_hi:[1,1,1]
    v_pk_fma_f32 v[178:179], v[50:51], v[246:247], v[178:179] op_sel:[0,1,0] op_sel_hi:[1,1,1]
    v_pk_mul_f32 v[164:165], v[164:165], v[52:53]
    v_pk_mul_f32 v[166:167], v[166:167], v[54:55]
    v_pk_mul_f32 v[168:169], v[168:169], v[56:57]
    v_pk_mul_f32 v[170:171], v[170:171], v[58:59]
    v_pk_mul_f32 v[172:173], v[172:173], v[60:61]
    v_pk_mul_f32 v[174:175], v[174:175], v[62:63]
    v_pk_mul_f32 v[176:177], v[176:177], v[64:65]
    v_pk_mul_f32 v[178:179], v[178:179], v[66:67]
    v_cvt_pk_bf16_f32 v108, v164, v165
    v_cvt_pk_bf16_f32 v109, v166, v167
    v_cvt_pk_bf16_f32 v110, v168, v169
    v_cvt_pk_bf16_f32 v111, v170, v171
    v_cvt_pk_bf16_f32 v112, v172, v173
    v_cvt_pk_bf16_f32 v113, v174, v175
    v_cvt_pk_bf16_f32 v114, v176, v177
    v_cvt_pk_bf16_f32 v115, v178, v179
    v_mfma_f32_32x32x16_bf16 v[68:83], v[100:103], v[108:111], 0
    s_nop 0
    v_mfma_f32_32x32x16_bf16 v[68:83], v[104:107], v[112:115], v[68:83]
    v_mov_b32 v116, 0
    v_dot2_f32_bf16 v116, v100, v234, v116
    v_dot2_f32_bf16 v116, v101, v234, v116
    v_dot2_f32_bf16 v116, v102, v234, v116
    v_dot2_f32_bf16 v116, v103, v234, v116
    v_dot2_f32_bf16 v116, v104, v234, v116
    v_dot2_f32_bf16 v116, v105, v234, v116
    v_dot2_f32_bf16 v116, v106, v234, v116
    v_dot2_f32_bf16 v116, v107, v234, v116
    v_and_b32 v117, 16, v1
    v_cmp_eq_u32 vcc, 0, v117
    s_nop 1
    v_cndmask_b32 v68, v76, v68, vcc
    v_cndmask_b32 v69, v77, v69, vcc
    v_cndmask_b32 v70, v78, v70, vcc
    v_cndmask_b32 v71, v79, v71, vcc
    v_cndmask_b32 v72, v80, v72, vcc
    v_cndmask_b32 v73, v81, v73, vcc
    v_cndmask_b32 v74, v82, v74, vcc
    v_cndmask_b32 v75, v83, v75, vcc
    s_lshl_b32 s48, s24, 11
    s_add_u32 s48, s48, 0x21000
    v_add_u32 v117, s48, v244
    ds_write_b128 v117, v[68:71]
    ds_write_b128 v117, v[72:75] offset:1024
    s_lshl_b32 s48, s24, 8
    s_add_u32 s48, s48, 0x23000
    v_lshlrev_b32 v118, 2, v1
    v_add_u32 v118, s48, v118
    ds_write_b32 v118, v116
    s_waitcnt lgkmcnt(0)
    s_mov_b64 exec, 1
    v_mov_b32 v246, 0x20e10
    v_mov_b32 v247, 1
    ds_add_u32 v246, v247
    s_mov_b64 exec, -1
    v_mul_f32 v246, -1.0, v8
    v_mov_b32 v247, v9
    v_mul_f32 v248, 0x3fb8aa3b, v9
    v_pk_fma_f32 v[132:133], v[20:21], v[246:247], v[132:133] op_sel_hi:[1,0,1]
    v_pk_fma_f32 v[134:135], v[22:23], v[246:247], v[134:135] op_sel_hi:[1,0,1]
    v_pk_fma_f32 v[136:137], v[24:25], v[246:247], v[136:137] op_sel_hi:[1,0,1]
    v_pk_fma_f32 v[138:139], v[26:27], v[246:247], v[138:139] op_sel_hi:[1,0,1]
    v_pk_fma_f32 v[140:141], v[28:29], v[246:247], v[140:141] op_sel_hi:[1,0,1]
    v_pk_fma_f32 v[142:143], v[30:31], v[246:247], v[142:143] op_sel_hi:[1,0,1]
    v_pk_fma_f32 v[144:145], v[32:33], v[246:247], v[144:145] op_sel_hi:[1,0,1]
    v_pk_fma_f32 v[146:147], v[34:35], v[246:247], v[146:147] op_sel_hi:[1,0,1]
    v_pk_mul_f32 v[68:69], v[132:133], v[248:249] op_sel_hi:[1,0]
    v_pk_mul_f32 v[70:71], v[134:135], v[248:249] op_sel_hi:[1,0]
    v_pk_mul_f32 v[72:73], v[136:137], v[248:249] op_sel_hi:[1,0]
    v_pk_mul_f32 v[74:75], v[138:139], v[248:249] op_sel_hi:[1,0]
    v_pk_mul_f32 v[76:77], v[140:141], v[248:249] op_sel_hi:[1,0]
    v_pk_mul_f32 v[78:79], v[142:143], v[248:249] op_sel_hi:[1,0]
    v_pk_mul_f32 v[80:81], v[144:145], v[248:249] op_sel_hi:[1,0]
    v_pk_mul_f32 v[82:83], v[146:147], v[248:249] op_sel_hi:[1,0]
    v_exp_f32_e64 v68, v68 clamp
    v_exp_f32_e64 v69, v69 clamp
    v_exp_f32_e64 v70, v70 clamp
    v_exp_f32_e64 v71, v71 clamp
    v_exp_f32_e64 v72, v72 clamp
    v_exp_f32_e64 v73, v73 clamp
    v_exp_f32_e64 v74, v74 clamp
    v_exp_f32_e64 v75, v75 clamp
    v_exp_f32_e64 v76, v76 clamp
    v_exp_f32_e64 v77, v77 clamp
    v_exp_f32_e64 v78, v78 clamp
    v_exp_f32_e64 v79, v79 clamp
    v_exp_f32_e64 v80, v80 clamp
    v_exp_f32_e64 v81, v81 clamp
    v_exp_f32_e64 v82, v82 clamp
    v_exp_f32_e64 v83, v83 clamp
    v_max_f32 v132, 0, v132
    v_max_f32 v133, 0, v133
    v_max_f32 v134, 0, v134
    v_max_f32 v135, 0, v135
    v_max_f32 v136, 0, v136
    v_max_f32 v137, 0, v137
    v_max_f32 v138, 0, v138
    v_max_f32 v139, 0, v139
    v_max_f32 v140, 0, v140
    v_max_f32 v141, 0, v141
    v_max_f32 v142, 0, v142
    v_max_f32 v143, 0, v143
    v_max_f32 v144, 0, v144
    v_max_f32 v145, 0, v145
    v_max_f32 v146, 0, v146
    v_max_f32 v147, 0, v147
    v_pk_fma_f32 v[132:133], v[132:133], v[246:247], v[68:69] op_sel:[0,1,0] op_sel_hi:[1,1,1]
    v_pk_fma_f32 v[134:135], v[134:135], v[246:247], v[70:71] op_sel:[0,1,0] op_sel_hi:[1,1,1]
    v_pk_fma_f32 v[136:137], v[136:137], v[246:247], v[72:73] op_sel:[0,1,0] op_sel_hi:[1,1,1]
    v_pk_fma_f32 v[138:139], v[138:139], v[246:247], v[74:75] op_sel:[0,1,0] op_sel_hi:[1,1,1]
    v_pk_fma_f32 v[140:141], v[140:141], v[246:247], v[76:77] op_sel:[0,1,0] op_sel_hi:[1,1,1]
    v_pk_fma_f32 v[142:143], v[142:143], v[246:247], v[78:79] op_sel:[0,1,0] op_sel_hi:[1,1,1]
    v_pk_fma_f32 v[144:145], v[144:145], v[246:247], v[80:81] op_sel:[0,1,0] op_sel_hi:[1,1,1]
    v_pk_fma_f32 v[146:147], v[146:147], v[246:247], v[82:83] op_sel:[0,1,0] op_sel_hi:[1,1,1]
    v_pk_add_f32 v[132:133], v[132:133], s[56:57]
    v_pk_add_f32 v[134:135], v[134:135], s[56:57]
    v_pk_add_f32 v[136:137], v[136:137], s[56:57]
    v_pk_add_f32 v[138:139], v[138:139], s[56:57]
    v_pk_add_f32 v[140:141], v[140:141], s[56:57]
    v_pk_add_f32 v[142:143], v[142:143], s[56:57]
    v_pk_add_f32 v[144:145], v[144:145], s[56:57]
    v_pk_add_f32 v[146:147], v[146:147], s[56:57]
    v_cvt_pk_bf16_f32 v204, v132, v133
    v_cvt_pk_bf16_f32 v205, v134, v135
    v_cvt_pk_bf16_f32 v206, v136, v137
    v_cvt_pk_bf16_f32 v207, v138, v139
    v_cvt_pk_bf16_f32 v208, v140, v141
    v_cvt_pk_bf16_f32 v209, v142, v143
    v_cvt_pk_bf16_f32 v210, v144, v145
    v_cvt_pk_bf16_f32 v211, v146, v147
    ds_read_b32 v8, v243 offset:0
    ds_read_b32 v9, v243 offset:512
    v_permlane32_swap_b32 v196, v198
    v_permlane32_swap_b32 v200, v202
    v_permlane32_swap_b32 v197, v199
    v_permlane32_swap_b32 v201, v203
    v_lshlrev_b32 v164, 16, v196
    v_and_b32 v165, 0xffff0000, v196
    v_lshlrev_b32 v166, 16, v197
    v_and_b32 v167, 0xffff0000, v197
    v_lshlrev_b32 v168, 16, v200
    v_and_b32 v169, 0xffff0000, v200
    v_lshlrev_b32 v170, 16, v201
    v_and_b32 v171, 0xffff0000, v201
    v_lshlrev_b32 v172, 16, v198
    v_and_b32 v173, 0xffff0000, v198
    v_lshlrev_b32 v174, 16, v199
    v_and_b32 v175, 0xffff0000, v199
    v_lshlrev_b32 v176, 16, v202
    v_and_b32 v177, 0xffff0000, v202
    v_lshlrev_b32 v178, 16, v203
    v_and_b32 v179, 0xffff0000, v203
    s_waitcnt lgkmcnt(0)
    v_mul_f32 v246, -1.0, v8
    v_mov_b32 v247, v9
    v_pk_add_f32 v[164:165], v[164:165], v[246:247] op_sel_hi:[1,0]
    v_pk_add_f32 v[166:167], v[166:167], v[246:247] op_sel_hi:[1,0]
    v_pk_add_f32 v[168:169], v[168:169], v[246:247] op_sel_hi:[1,0]
    v_pk_add_f32 v[170:171], v[170:171], v[246:247] op_sel_hi:[1,0]
    v_pk_add_f32 v[172:173], v[172:173], v[246:247] op_sel_hi:[1,0]
    v_pk_add_f32 v[174:175], v[174:175], v[246:247] op_sel_hi:[1,0]
    v_pk_add_f32 v[176:177], v[176:177], v[246:247] op_sel_hi:[1,0]
    v_pk_add_f32 v[178:179], v[178:179], v[246:247] op_sel_hi:[1,0]
    v_cvt_pk_bf16_f32 v20, v164, v165
    v_cvt_pk_bf16_f32 v21, v166, v167
    v_cvt_pk_bf16_f32 v22, v168, v169
    v_cvt_pk_bf16_f32 v23, v170, v171
    v_cvt_pk_bf16_f32 v24, v172, v173
    v_cvt_pk_bf16_f32 v25, v174, v175
    v_cvt_pk_bf16_f32 v26, v176, v177
    v_cvt_pk_bf16_f32 v27, v178, v179
    v_lshlrev_b32 v164, 16, v20
    v_and_b32 v165, 0xffff0000, v20
    v_lshlrev_b32 v166, 16, v21
    v_and_b32 v167, 0xffff0000, v21
    v_lshlrev_b32 v168, 16, v22
    v_and_b32 v169, 0xffff0000, v22
    v_lshlrev_b32 v170, 16, v23
    v_and_b32 v171, 0xffff0000, v23
    v_lshlrev_b32 v172, 16, v24
    v_and_b32 v173, 0xffff0000, v24
    v_lshlrev_b32 v174, 16, v25
    v_and_b32 v175, 0xffff0000, v25
    v_lshlrev_b32 v176, 16, v26
    v_and_b32 v177, 0xffff0000, v26
    v_lshlrev_b32 v178, 16, v27
    v_and_b32 v179, 0xffff0000, v27
    v_pk_mul_f32 v[164:165], v[164:165], v[246:247] op_sel:[0,1] op_sel_hi:[1,1]
    v_pk_mul_f32 v[166:167], v[166:167], v[246:247] op_sel:[0,1] op_sel_hi:[1,1]
    v_pk_mul_f32 v[168:169], v[168:169], v[246:247] op_sel:[0,1] op_sel_hi:[1,1]
    v_pk_mul_f32 v[170:171], v[170:171], v[246:247] op_sel:[0,1] op_sel_hi:[1,1]
    v_pk_mul_f32 v[172:173], v[172:173], v[246:247] op_sel:[0,1] op_sel_hi:[1,1]
    v_pk_mul_f32 v[174:175], v[174:175], v[246:247] op_sel:[0,1] op_sel_hi:[1,1]
    v_pk_mul_f32 v[176:177], v[176:177], v[246:247] op_sel:[0,1] op_sel_hi:[1,1]
    v_pk_mul_f32 v[178:179], v[178:179], v[246:247] op_sel:[0,1] op_sel_hi:[1,1]
    v_cvt_pk_bf16_f32 v20, v164, v165
    v_cvt_pk_bf16_f32 v21, v166, v167
    v_cvt_pk_bf16_f32 v22, v168, v169
    v_cvt_pk_bf16_f32 v23, v170, v171
    v_cvt_pk_bf16_f32 v24, v172, v173
    v_cvt_pk_bf16_f32 v25, v174, v175
    v_cvt_pk_bf16_f32 v26, v176, v177
    v_cvt_pk_bf16_f32 v27, v178, v179
    v_lshlrev_b32 v164, 16, v20
    v_and_b32 v165, 0xffff0000, v20
    v_lshlrev_b32 v166, 16, v21
    v_and_b32 v167, 0xffff0000, v21
    v_lshlrev_b32 v168, 16, v22
    v_and_b32 v169, 0xffff0000, v22
    v_lshlrev_b32 v170, 16, v23
    v_and_b32 v171, 0xffff0000, v23
    v_lshlrev_b32 v172, 16, v24
    v_and_b32 v173, 0xffff0000, v24
    v_lshlrev_b32 v174, 16, v25
    v_and_b32 v175, 0xffff0000, v25
    v_lshlrev_b32 v176, 16, v26
    v_and_b32 v177, 0xffff0000, v26
    v_lshlrev_b32 v178, 16, v27
    v_and_b32 v179, 0xffff0000, v27
    v_mov_b32 v132, 0
    v_mov_b32 v133, 0
    v_mov_b32 v134, 0
    v_mov_b32 v135, 0
    v_mov_b32 v136, 0
    v_mov_b32 v137, 0
    v_mov_b32 v138, 0
    v_mov_b32 v139, 0
    v_mov_b32 v140, 0
    v_mov_b32 v141, 0
    v_mov_b32 v142, 0
    v_mov_b32 v143, 0
    v_mov_b32 v144, 0
    v_mov_b32 v145, 0
    v_mov_b32 v146, 0
    v_mov_b32 v147, 0
    v_mov_b32 v148, 0
    v_mov_b32 v149, 0
    v_mov_b32 v150, 0
    v_mov_b32 v151, 0
    v_mov_b32 v152, 0
    v_mov_b32 v153, 0
    v_mov_b32 v154, 0
    v_mov_b32 v155, 0
    v_mov_b32 v156, 0
    v_mov_b32 v157, 0
    v_mov_b32 v158, 0
    v_mov_b32 v159, 0
    v_mov_b32 v160, 0
    v_mov_b32 v161, 0
    v_mov_b32 v162, 0
    v_mov_b32 v163, 0
    s_barrier
    ds_read_b128 v[4:7], v230 offset:0
    ds_read_b64_tr_b16 v[8:9], v231 offset:0
    ds_read_b64_tr_b16 v[10:11], v231 offset:1024
    ds_read_b128 v[12:15], v230 offset:1024
    ds_read_b64_tr_b16 v[16:17], v231 offset:2048
    ds_read_b64_tr_b16 v[18:19], v231 offset:3072
    ds_read_b128 v[20:23], v230 offset:2048
    ds_read_b64_tr_b16 v[24:25], v231 offset:4096
    ds_read_b64_tr_b16 v[26:27], v231 offset:5120
    ds_read_b128 v[28:31], v230 offset:3072
    ds_read_b64_tr_b16 v[32:33], v231 offset:6144
    ds_read_b64_tr_b16 v[34:35], v231 offset:7168
    ds_read_b128 v[36:39], v230 offset:4096
    ds_read_b64_tr_b16 v[40:41], v231 offset:8192
    ds_read_b64_tr_b16 v[42:43], v231 offset:9216
    ds_read_b128 v[44:47], v230 offset:5120
    ds_read_b64_tr_b16 v[48:49], v231 offset:10240
    ds_read_b64_tr_b16 v[50:51], v231 offset:11264
    ds_read_b128 v[52:55], v230 offset:6144
    ds_read_b64_tr_b16 v[56:57], v231 offset:12288
    ds_read_b64_tr_b16 v[58:59], v231 offset:13312
    ds_read_b128 v[60:63], v230 offset:7168
    ds_read_b64_tr_b16 v[64:65], v231 offset:14336
    ds_read_b64_tr_b16 v[66:67], v231 offset:15360
    s_waitcnt lgkmcnt(0)
    s_barrier
    v_mfma_f32_32x32x16_bf16 v[132:147], v[8:11], v[4:7], v[132:147]
    ds_read_b128 v[68:71], v230 offset:16384
    ds_read_b64_tr_b16 v[72:73], v231 offset:16384
    ds_read_b64_tr_b16 v[74:75], v231 offset:17408
    ds_read_b128 v[76:79], v230 offset:17408
    v_mfma_f32_32x32x16_bf16 v[148:163], v[16:19], v[12:15], v[148:163]
    ds_read_b64_tr_b16 v[80:81], v231 offset:18432
    ds_read_b64_tr_b16 v[82:83], v231 offset:19456
    ds_read_b128 v[84:87], v230 offset:18432
    ds_read_b64_tr_b16 v[88:89], v231 offset:20480
    v_mfma_f32_32x32x16_bf16 v[132:147], v[24:27], v[20:23], v[132:147]
    ds_read_b64_tr_b16 v[90:91], v231 offset:21504
    ds_read_b128 v[92:95], v230 offset:19456
    ds_read_b64_tr_b16 v[96:97], v231 offset:22528
    ds_read_b64_tr_b16 v[98:99], v231 offset:23552
    v_mfma_f32_32x32x16_bf16 v[148:163], v[32:35], v[28:31], v[148:163]
    ds_read_b128 v[100:103], v230 offset:20480
    ds_read_b64_tr_b16 v[104:105], v231 offset:24576
    ds_read_b64_tr_b16 v[106:107], v231 offset:25600
    ds_read_b128 v[108:111], v230 offset:21504
    v_mfma_f32_32x32x16_bf16 v[132:147], v[40:43], v[36:39], v[132:147]
    ds_read_b64_tr_b16 v[112:113], v231 offset:26624
    ds_read_b64_tr_b16 v[114:115], v231 offset:27648
    ds_read_b128 v[116:119], v230 offset:22528
    ds_read_b64_tr_b16 v[120:121], v231 offset:28672
    v_mfma_f32_32x32x16_bf16 v[148:163], v[48:51], v[44:47], v[148:163]
    ds_read_b64_tr_b16 v[122:123], v231 offset:29696
    ds_read_b128 v[124:127], v230 offset:23552
    ds_read_b64_tr_b16 v[128:129], v231 offset:30720
    ds_read_b64_tr_b16 v[130:131], v231 offset:31744
    v_mfma_f32_32x32x16_bf16 v[132:147], v[56:59], v[52:55], v[132:147]
    v_mfma_f32_32x32x16_bf16 v[148:163], v[64:67], v[60:63], v[148:163]
    s_waitcnt lgkmcnt(0)
    s_barrier
    v_mfma_f32_32x32x16_bf16 v[132:147], v[72:75], v[68:71], v[132:147]
    ds_read_b128 v[4:7], v230 offset:32768
    ds_read_b64_tr_b16 v[8:9], v231 offset:32768
    ds_read_b64_tr_b16 v[10:11], v231 offset:33792
    ds_read_b128 v[12:15], v230 offset:33792
    v_mfma_f32_32x32x16_bf16 v[148:163], v[80:83], v[76:79], v[148:163]
    ds_read_b64_tr_b16 v[16:17], v231 offset:34816
    ds_read_b64_tr_b16 v[18:19], v231 offset:35840
    ds_read_b128 v[20:23], v230 offset:34816
    ds_read_b64_tr_b16 v[24:25], v231 offset:36864
    v_mfma_f32_32x32x16_bf16 v[132:147], v[88:91], v[84:87], v[132:147]
    ds_read_b64_tr_b16 v[26:27], v231 offset:37888
    ds_read_b128 v[28:31], v230 offset:35840
    ds_read_b64_tr_b16 v[32:33], v231 offset:38912
    ds_read_b64_tr_b16 v[34:35], v231 offset:39936
    v_mfma_f32_32x32x16_bf16 v[148:163], v[96:99], v[92:95], v[148:163]
    ds_read_b128 v[36:39], v230 offset:36864
    ds_read_b64_tr_b16 v[40:41], v231 offset:40960
    ds_read_b64_tr_b16 v[42:43], v231 offset:41984
    ds_read_b128 v[44:47], v230 offset:37888
    v_mfma_f32_32x32x16_bf16 v[132:147], v[104:107], v[100:103], v[132:147]
    ds_read_b64_tr_b16 v[48:49], v231 offset:43008
    ds_read_b64_tr_b16 v[50:51], v231 offset:44032
    ds_read_b128 v[52:55], v230 offset:38912
    ds_read_b64_tr_b16 v[56:57], v231 offset:45056
    v_mfma_f32_32x32x16_bf16 v[148:163], v[112:115], v[108:111], v[148:163]
    ds_read_b64_tr_b16 v[58:59], v231 offset:46080
    ds_read_b128 v[60:63], v230 offset:39936
    ds_read_b64_tr_b16 v[64:65], v231 offset:47104
    ds_read_b64_tr_b16 v[66:67], v231 offset:48128
    v_mfma_f32_32x32x16_bf16 v[132:147], v[120:123], v[116:119], v[132:147]
    v_mfma_f32_32x32x16_bf16 v[148:163], v[128:131], v[124:127], v[148:163]
    s_waitcnt lgkmcnt(0)
    s_barrier
    v_mfma_f32_32x32x16_bf16 v[132:147], v[8:11], v[4:7], v[132:147]
    ds_read_b128 v[68:71], v230 offset:49152
    ds_read_b64_tr_b16 v[72:73], v231 offset:49152
    ds_read_b64_tr_b16 v[74:75], v231 offset:50176
    ds_read_b128 v[76:79], v230 offset:50176
    v_mfma_f32_32x32x16_bf16 v[148:163], v[16:19], v[12:15], v[148:163]
    ds_read_b64_tr_b16 v[80:81], v231 offset:51200
    ds_read_b64_tr_b16 v[82:83], v231 offset:52224
    ds_read_b128 v[84:87], v230 offset:51200
    ds_read_b64_tr_b16 v[88:89], v231 offset:53248
    v_mfma_f32_32x32x16_bf16 v[132:147], v[24:27], v[20:23], v[132:147]
    ds_read_b64_tr_b16 v[90:91], v231 offset:54272
    ds_read_b128 v[92:95], v230 offset:52224
    ds_read_b64_tr_b16 v[96:97], v231 offset:55296
    ds_read_b64_tr_b16 v[98:99], v231 offset:56320
    v_mfma_f32_32x32x16_bf16 v[148:163], v[32:35], v[28:31], v[148:163]
    ds_read_b128 v[100:103], v230 offset:53248
    ds_read_b64_tr_b16 v[104:105], v231 offset:57344
    ds_read_b64_tr_b16 v[106:107], v231 offset:58368
    ds_read_b128 v[108:111], v230 offset:54272
    v_mfma_f32_32x32x16_bf16 v[132:147], v[40:43], v[36:39], v[132:147]
    ds_read_b64_tr_b16 v[112:113], v231 offset:59392
    ds_read_b64_tr_b16 v[114:115], v231 offset:60416
    ds_read_b128 v[116:119], v230 offset:55296
    ds_read_b64_tr_b16 v[120:121], v231 offset:61440
    v_mfma_f32_32x32x16_bf16 v[148:163], v[48:51], v[44:47], v[148:163]
    ds_read_b64_tr_b16 v[122:123], v231 offset:62464
    ds_read_b128 v[124:127], v230 offset:56320
    ds_read_b64_tr_b16 v[128:129], v231 offset:63488
    ds_read_b64_tr_b16 v[130:131], v231 offset:64512
    v_mfma_f32_32x32x16_bf16 v[132:147], v[56:59], v[52:55], v[132:147]
    v_mfma_f32_32x32x16_bf16 v[148:163], v[64:67], v[60:63], v[148:163]
    s_waitcnt lgkmcnt(0)
    v_mfma_f32_32x32x16_bf16 v[132:147], v[72:75], v[68:71], v[132:147]
    v_mfma_f32_32x32x16_bf16 v[148:163], v[80:83], v[76:79], v[148:163]
    v_mfma_f32_32x32x16_bf16 v[132:147], v[88:91], v[84:87], v[132:147]
    v_mfma_f32_32x32x16_bf16 v[148:163], v[96:99], v[92:95], v[148:163]
    v_mfma_f32_32x32x16_bf16 v[132:147], v[104:107], v[100:103], v[132:147]
    v_mfma_f32_32x32x16_bf16 v[148:163], v[112:115], v[108:111], v[148:163]
    v_mfma_f32_32x32x16_bf16 v[132:147], v[120:123], v[116:119], v[132:147]
    v_mfma_f32_32x32x16_bf16 v[148:163], v[128:131], v[124:127], v[148:163]
    s_nop 7
    s_nop 3
    v_pk_add_f32 v[132:133], v[132:133], v[148:149]
    v_pk_add_f32 v[134:135], v[134:135], v[150:151]
    v_pk_add_f32 v[136:137], v[136:137], v[152:153]
    v_pk_add_f32 v[138:139], v[138:139], v[154:155]
    v_pk_add_f32 v[140:141], v[140:141], v[156:157]
    v_pk_add_f32 v[142:143], v[142:143], v[158:159]
    v_pk_add_f32 v[144:145], v[144:145], v[160:161]
    v_pk_add_f32 v[146:147], v[146:147], v[162:163]
    v_cvt_pk_bf16_f32 v4, v132, v133
    v_cvt_pk_bf16_f32 v5, v134, v135
    v_cvt_pk_bf16_f32 v6, v136, v137
    v_cvt_pk_bf16_f32 v7, v138, v139
    v_cvt_pk_bf16_f32 v8, v140, v141
    v_cvt_pk_bf16_f32 v9, v142, v143
    v_cvt_pk_bf16_f32 v10, v144, v145
    v_cvt_pk_bf16_f32 v11, v146, v147
    v_lshlrev_b32 v132, 16, v4
    v_and_b32 v133, 0xffff0000, v4
    v_lshlrev_b32 v134, 16, v5
    v_and_b32 v135, 0xffff0000, v5
    v_lshlrev_b32 v136, 16, v6
    v_and_b32 v137, 0xffff0000, v6
    v_lshlrev_b32 v138, 16, v7
    v_and_b32 v139, 0xffff0000, v7
    v_lshlrev_b32 v140, 16, v8
    v_and_b32 v141, 0xffff0000, v8
    v_lshlrev_b32 v142, 16, v9
    v_and_b32 v143, 0xffff0000, v9
    v_lshlrev_b32 v144, 16, v10
    v_and_b32 v145, 0xffff0000, v10
    v_lshlrev_b32 v146, 16, v11
    v_and_b32 v147, 0xffff0000, v11
    v_pk_add_f32 v[132:133], v[132:133], v[164:165]
    v_pk_add_f32 v[134:135], v[134:135], v[166:167]
    v_pk_add_f32 v[136:137], v[136:137], v[168:169]
    v_pk_add_f32 v[138:139], v[138:139], v[170:171]
    v_pk_add_f32 v[140:141], v[140:141], v[172:173]
    v_pk_add_f32 v[142:143], v[142:143], v[174:175]
    v_pk_add_f32 v[144:145], v[144:145], v[176:177]
    v_pk_add_f32 v[146:147], v[146:147], v[178:179]
    v_cvt_pk_bf16_f32 v212, v132, v133
    v_cvt_pk_bf16_f32 v213, v134, v135
    v_cvt_pk_bf16_f32 v214, v136, v137
    v_cvt_pk_bf16_f32 v215, v138, v139
    v_cvt_pk_bf16_f32 v216, v140, v141
    v_cvt_pk_bf16_f32 v217, v142, v143
    v_cvt_pk_bf16_f32 v218, v144, v145
    v_cvt_pk_bf16_f32 v219, v146, v147
    s_add_u32 s48, s72, 0x400000
    buffer_store_dwordx4 v[212:215], v244, s[40:43], s48 offen sc1
    buffer_store_dwordx4 v[216:219], v244, s[40:43], s48 offen offset:1024 sc1
    v_mov_b32 v12, 0
    v_mov_b32 v13, 0
    v_dot2_f32_bf16 v12, v212, v234, v12
    v_dot2_f32_bf16 v13, v212, v212, v13
    v_dot2_f32_bf16 v12, v213, v234, v12
    v_dot2_f32_bf16 v13, v213, v213, v13
    v_dot2_f32_bf16 v12, v214, v234, v12
    v_dot2_f32_bf16 v13, v214, v214, v13
    v_dot2_f32_bf16 v12, v215, v234, v12
    v_dot2_f32_bf16 v13, v215, v215, v13
    v_dot2_f32_bf16 v12, v216, v234, v12
    v_dot2_f32_bf16 v13, v216, v216, v13
    v_dot2_f32_bf16 v12, v217, v234, v12
    v_dot2_f32_bf16 v13, v217, v217, v13
    v_dot2_f32_bf16 v12, v218, v234, v12
    v_dot2_f32_bf16 v13, v218, v218, v13
    v_dot2_f32_bf16 v12, v219, v234, v12
    v_dot2_f32_bf16 v13, v219, v219, v13
    s_nop 1
    v_mov_b32 v14, v12
    s_nop 1
    v_permlane32_swap_b32 v12, v14
    v_add_f32 v12, v12, v14
    v_mov_b32 v14, v13
    s_nop 1
    v_permlane32_swap_b32 v13, v14
    v_add_f32 v13, v13, v14
    s_lshl_b32 s48, s27, 4
    s_lshl_b32 s49, s28, 1
    s_add_u32 s48, s48, s49
    s_add_u32 s48, s48, s51
    s_lshl_b32 s48, s48, 9
    s_lshl_b32 s49, s50, 8
    s_add_u32 s48, s48, s49
    s_add_u32 s48, s48, 0xfa0000
    v_lshlrev_b32 v16, 3, v1
    s_mov_b32 exec_hi, 0
    buffer_store_dwordx2 v[12:13], v16, s[40:43], s48 offen sc1
    s_mov_b32 exec_hi, -1
    s_waitcnt vmcnt(0)
    s_mov_b64 exec, 1
    v_mov_b32 v246, 0x20e04
    v_mov_b32 v247, 1
    ds_add_rtn_u32 v248, v246, v247
    s_lshl_b32 s52, s27, 3
    s_add_u32 s52, s52, s28
    s_lshl_b32 s52, s52, 3
    s_add_u32 s52, s52, 0x1000
    s_waitcnt lgkmcnt(0)
    v_readfirstlane_b32 s48, v248
    s_cmp_eq_u32 s48, 3
    s_cbranch_scc0 L_C_sig_11
    v_mov_b32 v246, s34
    v_mov_b32 v247, s35
    v_mov_b32 v248, s52
    s_cmp_lg_u32 s53, 0
    s_cbranch_scc1 L_C_sigp_12
    buffer_store_dwordx2 v[246:247], v248, s[40:43], 0 offen sc1
    s_branch L_C_sig_11
L_C_sigp_12:
    v_xor_b32 v247, s10, v247
    v_add_u32 v248, 0x4000, v248
    buffer_store_dwordx2 v[246:247], v248, s[40:43], 0 offen
L_C_sig_11:
    s_mov_b64 exec, -1
    s_barrier
    v_add_u32 v68, 0x23400, v244
    ds_read_b128 v[20:23], v68 offset:0
    ds_read_b128 v[24:27], v68 offset:1024
    s_waitcnt lgkmcnt(0)
    v_mfma_f32_32x32x16_bf16 v[84:99], v[20:23], v[204:207], 0
    v_mfma_f32_32x32x16_bf16 v[100:115], v[24:27], v[208:211], 0
    s_lshl_b32 s48, s29, 2
    s_add_u32 s48, s48, s24
    s_lshl_b32 s48, s48, 5
    s_lshl_b32 s49, s30, 1
    s_add_u32 s48, s48, s49
    s_lshl_b32 s48, s48, 10
    s_add_u32 s48, s48, 0xd00000
    s_nop 3
    v_cvt_pk_bf16_f32 v30, v92, v92
    v_lshlrev_b32 v28, 16, v30
    v_add_f32 v28, 0x358637bd, v28
    v_cvt_pk_bf16_f32 v30, v28, v28
    v_lshlrev_b32 v28, 16, v30
    v_rcp_f32 v28, v28
    v_cvt_pk_bf16_f32 v32, v84, v85
    v_cvt_pk_bf16_f32 v33, v86, v87
    v_cvt_pk_bf16_f32 v34, v88, v89
    v_cvt_pk_bf16_f32 v35, v90, v91
    v_lshlrev_b32 v84, 16, v32
    v_and_b32 v85, 0xffff0000, v32
    v_lshlrev_b32 v86, 16, v33
    v_and_b32 v87, 0xffff0000, v33
    v_lshlrev_b32 v88, 16, v34
    v_and_b32 v89, 0xffff0000, v34
    v_lshlrev_b32 v90, 16, v35
    v_and_b32 v91, 0xffff0000, v35
    v_mul_f32 v84, v84, v28
    v_mul_f32 v85, v85, v28
    v_mul_f32 v86, v86, v28
    v_mul_f32 v87, v87, v28
    v_mul_f32 v88, v88, v28
    v_mul_f32 v89, v89, v28
    v_mul_f32 v90, v90, v28
    v_mul_f32 v91, v91, v28
    v_cvt_pk_bf16_f32 v32, v84, v85
    v_cvt_pk_bf16_f32 v33, v86, v87
    v_cvt_pk_bf16_f32 v34, v88, v89
    v_cvt_pk_bf16_f32 v35, v90, v91
    buffer_store_dwordx4 v[32:35], v244, s[40:43], s48 offen offset:0 sc1
    v_cvt_pk_bf16_f32 v30, v108, v108
    v_lshlrev_b32 v29, 16, v30
    v_add_f32 v29, 0x358637bd, v29
    v_cvt_pk_bf16_f32 v30, v29, v29
    v_lshlrev_b32 v29, 16, v30
    v_rcp_f32 v29, v29
    v_cvt_pk_bf16_f32 v36, v100, v101
    v_cvt_pk_bf16_f32 v37, v102, v103
    v_cvt_pk_bf16_f32 v38, v104, v105
    v_cvt_pk_bf16_f32 v39, v106, v107
    v_lshlrev_b32 v100, 16, v36
    v_and_b32 v101, 0xffff0000, v36
    v_lshlrev_b32 v102, 16, v37
    v_and_b32 v103, 0xffff0000, v37
    v_lshlrev_b32 v104, 16, v38
    v_and_b32 v105, 0xffff0000, v38
    v_lshlrev_b32 v106, 16, v39
    v_and_b32 v107, 0xffff0000, v39
    v_mul_f32 v100, v100, v29
    v_mul_f32 v101, v101, v29
    v_mul_f32 v102, v102, v29
    v_mul_f32 v103, v103, v29
    v_mul_f32 v104, v104, v29
    v_mul_f32 v105, v105, v29
    v_mul_f32 v106, v106, v29
    v_mul_f32 v107, v107, v29
    v_cvt_pk_bf16_f32 v36, v100, v101
    v_cvt_pk_bf16_f32 v37, v102, v103
    v_cvt_pk_bf16_f32 v38, v104, v105
    v_cvt_pk_bf16_f32 v39, v106, v107
    buffer_store_dwordx4 v[36:39], v244, s[40:43], s48 offen offset:1024 sc1
    v_mov_b32 v132, 0
    v_mov_b32 v133, 0
    v_mov_b32 v134, 0
    v_mov_b32 v135, 0
    v_mov_b32 v136, 0
    v_mov_b32 v137, 0
    v_mov_b32 v138, 0
    v_mov_b32 v139, 0
    v_mov_b32 v140, 0
    v_mov_b32 v141, 0
    v_mov_b32 v142, 0
    v_mov_b32 v143, 0
    v_mov_b32 v144, 0
    v_mov_b32 v145, 0
    v_mov_b32 v146, 0
    v_mov_b32 v147, 0
    v_mov_b32 v148, 0
    v_mov_b32 v149, 0
    v_mov_b32 v150, 0
    v_mov_b32 v151, 0
    v_mov_b32 v152, 0
    v_mov_b32 v153, 0
    v_mov_b32 v154, 0
    v_mov_b32 v155, 0
    v_mov_b32 v156, 0
    v_mov_b32 v157, 0
    v_mov_b32 v158, 0
    v_mov_b32 v159, 0
    v_mov_b32 v160, 0
    v_mov_b32 v161, 0
    v_mov_b32 v162, 0
    v_mov_b32 v163, 0
    v_mov_b32 v164, 0
    v_mov_b32 v165, 0
    v_mov_b32 v166, 0
    v_mov_b32 v167, 0
    v_mov_b32 v168, 0
    v_mov_b32 v169, 0
    v_mov_b32 v170, 0
    v_mov_b32 v171, 0
    v_mov_b32 v172, 0
    v_mov_b32 v173, 0
    v_mov_b32 v174, 0
    v_mov_b32 v175, 0
    v_mov_b32 v176, 0
    v_mov_b32 v177, 0
    v_mov_b32 v178, 0
    v_mov_b32 v179, 0
    v_mov_b32 v180, 0
    v_mov_b32 v181, 0
    v_mov_b32 v182, 0
    v_mov_b32 v183, 0
    v_mov_b32 v184, 0
    v_mov_b32 v185, 0
    v_mov_b32 v186, 0
    v_mov_b32 v187, 0
    v_mov_b32 v188, 0
    v_mov_b32 v189, 0
    v_mov_b32 v190, 0
    v_mov_b32 v191, 0
    v_mov_b32 v192, 0
    v_mov_b32 v193, 0
    v_mov_b32 v194, 0
    v_mov_b32 v195, 0
    s_cmp_lg_u32 s33, 0
    s_cbranch_scc1 L_C_sp_13
    s_barrier
    ds_read_b128 v[4:7], v230 offset:0
    ds_read_b128 v[8:11], v230 offset:4096
    ds_read_b64_tr_b16 v[12:13], v232 offset:0
    ds_read_b64_tr_b16 v[14:15], v232 offset:2048
    ds_read_b64_tr_b16 v[16:17], v233 offset:0
    ds_read_b64_tr_b16 v[18:19], v233 offset:2048
    ds_read_b128 v[20:23], v230 offset:1024
    ds_read_b128 v[24:27], v230 offset:5120
    ds_read_b64_tr_b16 v[28:29], v232 offset:4096
    ds_read_b64_tr_b16 v[30:31], v232 offset:6144
    ds_read_b64_tr_b16 v[32:33], v233 offset:4096
    ds_read_b64_tr_b16 v[34:35], v233 offset:6144
    ds_read_b128 v[36:39], v230 offset:2048
    ds_read_b128 v[40:43], v230 offset:6144
    ds_read_b64_tr_b16 v[44:45], v232 offset:8192
    ds_read_b64_tr_b16 v[46:47], v232 offset:10240
    ds_read_b64_tr_b16 v[48:49], v233 offset:8192
    ds_read_b64_tr_b16 v[50:51], v233 offset:10240
    ds_read_b128 v[52:55], v230 offset:3072
    ds_read_b128 v[56:59], v230 offset:7168
    ds_read_b64_tr_b16 v[60:61], v232 offset:12288
    ds_read_b64_tr_b16 v[62:63], v232 offset:14336
    ds_read_b64_tr_b16 v[64:65], v233 offset:12288
    ds_read_b64_tr_b16 v[66:67], v233 offset:14336
    s_waitcnt lgkmcnt(0)
    s_barrier
    v_mfma_f32_32x32x16_bf16 v[132:147], v[12:15], v[4:7], v[132:147]
    ds_read_b128 v[68:71], v230 offset:16384
    ds_read_b128 v[72:75], v230 offset:20480
    v_mfma_f32_32x32x16_bf16 v[148:163], v[16:19], v[4:7], v[148:163]
    ds_read_b64_tr_b16 v[76:77], v232 offset:16384
    ds_read_b64_tr_b16 v[78:79], v232 offset:18432
    v_mfma_f32_32x32x16_bf16 v[164:179], v[12:15], v[8:11], v[164:179]
    ds_read_b64_tr_b16 v[80:81], v233 offset:16384
    ds_read_b64_tr_b16 v[82:83], v233 offset:18432
    v_mfma_f32_32x32x16_bf16 v[180:195], v[16:19], v[8:11], v[180:195]
    ds_read_b128 v[84:87], v230 offset:17408
    ds_read_b128 v[88:91], v230 offset:21504
    v_mfma_f32_32x32x16_bf16 v[132:147], v[28:31], v[20:23], v[132:147]
    ds_read_b64_tr_b16 v[92:93], v232 offset:20480
    ds_read_b64_tr_b16 v[94:95], v232 offset:22528
    v_mfma_f32_32x32x16_bf16 v[148:163], v[32:35], v[20:23], v[148:163]
    ds_read_b64_tr_b16 v[96:97], v233 offset:20480
    ds_read_b64_tr_b16 v[98:99], v233 offset:22528
    v_mfma_f32_32x32x16_bf16 v[164:179], v[28:31], v[24:27], v[164:179]
    ds_read_b128 v[100:103], v230 offset:18432
    ds_read_b128 v[104:107], v230 offset:22528
    v_mfma_f32_32x32x16_bf16 v[180:195], v[32:35], v[24:27], v[180:195]
    ds_read_b64_tr_b16 v[108:109], v232 offset:24576
    ds_read_b64_tr_b16 v[110:111], v232 offset:26624
    v_mfma_f32_32x32x16_bf16 v[132:147], v[44:47], v[36:39], v[132:147]
    ds_read_b64_tr_b16 v[112:113], v233 offset:24576
    ds_read_b64_tr_b16 v[114:115], v233 offset:26624
    v_mfma_f32_32x32x16_bf16 v[148:163], v[48:51], v[36:39], v[148:163]
    ds_read_b128 v[116:119], v230 offset:19456
    ds_read_b128 v[120:123], v230 offset:23552
    v_mfma_f32_32x32x16_bf16 v[164:179], v[44:47], v[40:43], v[164:179]
    ds_read_b64_tr_b16 v[124:125], v232 offset:28672
    ds_read_b64_tr_b16 v[126:127], v232 offset:30720
    v_mfma_f32_32x32x16_bf16 v[180:195], v[48:51], v[40:43], v[180:195]
    ds_read_b64_tr_b16 v[128:129], v233 offset:28672
    ds_read_b64_tr_b16 v[130:131], v233 offset:30720
    v_mfma_f32_32x32x16_bf16 v[132:147], v[60:63], v[52:55], v[132:147]
    v_mfma_f32_32x32x16_bf16 v[148:163], v[64:67], v[52:55], v[148:163]
    v_mfma_f32_32x32x16_bf16 v[164:179], v[60:63], v[56:59], v[164:179]
    v_mfma_f32_32x32x16_bf16 v[180:195], v[64:67], v[56:59], v[180:195]
    s_waitcnt lgkmcnt(0)
    s_waitcnt vmcnt(0)
    s_mov_b64 exec, 1
    v_mov_b32 v246, 0x20e08
    v_mov_b32 v247, 1
    ds_add_rtn_u32 v248, v246, v247
    s_lshl_b32 s52, s29, 4
    s_add_u32 s52, s52, s30
    s_lshl_b32 s52, s52, 3
    s_add_u32 s52, s52, 0x2000
    s_waitcnt lgkmcnt(0)
    v_readfirstlane_b32 s48, v248
    s_cmp_eq_u32 s48, 3
    s_cbranch_scc0 L_C_sig_15
    v_mov_b32 v246, s34
    v_mov_b32 v247, s35
    v_mov_b32 v248, s52
    s_cmp_lg_u32 s53, 0
    s_cbranch_scc1 L_C_sigp_16
    buffer_store_dwordx2 v[246:247], v248, s[40:43], 0 offen sc1
    s_branch L_C_sig_15
L_C_sigp_16:
    v_xor_b32 v247, s10, v247
    v_add_u32 v248, 0x4000, v248
    buffer_store_dwordx2 v[246:247], v248, s[40:43], 0 offen
L_C_sig_15:
    s_mov_b64 exec, -1
    s_barrier
    v_mfma_f32_32x32x16_bf16 v[132:147], v[76:79], v[68:71], v[132:147]
    ds_read_b128 v[4:7], v230 offset:32768
    ds_read_b128 v[8:11], v230 offset:36864
    v_mfma_f32_32x32x16_bf16 v[148:163], v[80:83], v[68:71], v[148:163]
    ds_read_b64_tr_b16 v[12:13], v232 offset:32768
    ds_read_b64_tr_b16 v[14:15], v232 offset:34816
    v_mfma_f32_32x32x16_bf16 v[164:179], v[76:79], v[72:75], v[164:179]
    ds_read_b64_tr_b16 v[16:17], v233 offset:32768
    ds_read_b64_tr_b16 v[18:19], v233 offset:34816
    v_mfma_f32_32x32x16_bf16 v[180:195], v[80:83], v[72:75], v[180:195]
    ds_read_b128 v[20:23], v230 offset:33792
    ds_read_b128 v[24:27], v230 offset:37888
    v_mfma_f32_32x32x16_bf16 v[132:147], v[92:95], v[84:87], v[132:147]
    ds_read_b64_tr_b16 v[28:29], v232 offset:36864
    ds_read_b64_tr_b16 v[30:31], v232 offset:38912
    v_mfma_f32_32x32x16_bf16 v[148:163], v[96:99], v[84:87], v[148:163]
    ds_read_b64_tr_b16 v[32:33], v233 offset:36864
    ds_read_b64_tr_b16 v[34:35], v233 offset:38912
    v_mfma_f32_32x32x16_bf16 v[164:179], v[92:95], v[88:91], v[164:179]
    ds_read_b128 v[36:39], v230 offset:34816
    ds_read_b128 v[40:43], v230 offset:38912
    v_mfma_f32_32x32x16_bf16 v[180:195], v[96:99], v[88:91], v[180:195]
    ds_read_b64_tr_b16 v[44:45], v232 offset:40960
    ds_read_b64_tr_b16 v[46:47], v232 offset:43008
    v_mfma_f32_32x32x16_bf16 v[132:147], v[108:111], v[100:103], v[132:147]
    ds_read_b64_tr_b16 v[48:49], v233 offset:40960
    ds_read_b64_tr_b16 v[50:51], v233 offset:43008
    v_mfma_f32_32x32x16_bf16 v[148:163], v[112:115], v[100:103], v[148:163]
    ds_read_b128 v[52:55], v230 offset:35840
    ds_read_b128 v[56:59], v230 offset:39936
    v_mfma_f32_32x32x16_bf16 v[164:179], v[108:111], v[104:107], v[164:179]
    ds_read_b64_tr_b16 v[60:61], v232 offset:45056
    ds_read_b64_tr_b16 v[62:63], v232 offset:47104
    v_mfma_f32_32x32x16_bf16 v[180:195], v[112:115], v[104:107], v[180:195]
    ds_read_b64_tr_b16 v[64:65], v233 offset:45056
    ds_read_b64_tr_b16 v[66:67], v233 offset:47104
    v_mfma_f32_32x32x16_bf16 v[132:147], v[124:127], v[116:119], v[132:147]
    v_mfma_f32_32x32x16_bf16 v[148:163], v[128:131], v[116:119], v[148:163]
    v_mfma_f32_32x32x16_bf16 v[164:179], v[124:127], v[120:123], v[164:179]
    v_mfma_f32_32x32x16_bf16 v[180:195], v[128:131], v[120:123], v[180:195]
    s_waitcnt lgkmcnt(0)
    s_barrier
    v_mfma_f32_32x32x16_bf16 v[132:147], v[12:15], v[4:7], v[132:147]
    ds_read_b128 v[68:71], v230 offset:49152
    ds_read_b128 v[72:75], v230 offset:53248
    v_mfma_f32_32x32x16_bf16 v[148:163], v[16:19], v[4:7], v[148:163]
    ds_read_b64_tr_b16 v[76:77], v232 offset:49152
    ds_read_b64_tr_b16 v[78:79], v232 offset:51200
    v_mfma_f32_32x32x16_bf16 v[164:179], v[12:15], v[8:11], v[164:179]
    ds_read_b64_tr_b16 v[80:81], v233 offset:49152
    ds_read_b64_tr_b16 v[82:83], v233 offset:51200
    v_mfma_f32_32x32x16_bf16 v[180:195], v[16:19], v[8:11], v[180:195]
    ds_read_b128 v[84:87], v230 offset:50176
    ds_read_b128 v[88:91], v230 offset:54272
    v_mfma_f32_32x32x16_bf16 v[132:147], v[28:31], v[20:23], v[132:147]
    ds_read_b64_tr_b16 v[92:93], v232 offset:53248
    ds_read_b64_tr_b16 v[94:95], v232 offset:55296
    v_mfma_f32_32x32x16_bf16 v[148:163], v[32:35], v[20:23], v[148:163]
    ds_read_b64_tr_b16 v[96:97], v233 offset:53248
    ds_read_b64_tr_b16 v[98:99], v233 offset:55296
    v_mfma_f32_32x32x16_bf16 v[164:179], v[28:31], v[24:27], v[164:179]
    ds_read_b128 v[100:103], v230 offset:51200
    ds_read_b128 v[104:107], v230 offset:55296
    v_mfma_f32_32x32x16_bf16 v[180:195], v[32:35], v[24:27], v[180:195]
    ds_read_b64_tr_b16 v[108:109], v232 offset:57344
    ds_read_b64_tr_b16 v[110:111], v232 offset:59392
    v_mfma_f32_32x32x16_bf16 v[132:147], v[44:47], v[36:39], v[132:147]
    ds_read_b64_tr_b16 v[112:113], v233 offset:57344
    ds_read_b64_tr_b16 v[114:115], v233 offset:59392
    v_mfma_f32_32x32x16_bf16 v[148:163], v[48:51], v[36:39], v[148:163]
    ds_read_b128 v[116:119], v230 offset:52224
    ds_read_b128 v[120:123], v230 offset:56320
    v_mfma_f32_32x32x16_bf16 v[164:179], v[44:47], v[40:43], v[164:179]
    ds_read_b64_tr_b16 v[124:125], v232 offset:61440
    ds_read_b64_tr_b16 v[126:127], v232 offset:63488
    v_mfma_f32_32x32x16_bf16 v[180:195], v[48:51], v[40:43], v[180:195]
    ds_read_b64_tr_b16 v[128:129], v233 offset:61440
    ds_read_b64_tr_b16 v[130:131], v233 offset:63488
    v_mfma_f32_32x32x16_bf16 v[132:147], v[60:63], v[52:55], v[132:147]
    v_mfma_f32_32x32x16_bf16 v[148:163], v[64:67], v[52:55], v[148:163]
    v_mfma_f32_32x32x16_bf16 v[164:179], v[60:63], v[56:59], v[164:179]
    v_mfma_f32_32x32x16_bf16 v[180:195], v[64:67], v[56:59], v[180:195]
    s_waitcnt lgkmcnt(0)
    s_barrier
    v_mfma_f32_32x32x16_bf16 v[132:147], v[76:79], v[68:71], v[132:147]
    ds_read_b128 v[4:7], v230 offset:0
    ds_read_b128 v[8:11], v230 offset:4096
    v_mfma_f32_32x32x16_bf16 v[148:163], v[80:83], v[68:71], v[148:163]
    ds_read_b64_tr_b16 v[12:13], v232 offset:0
    ds_read_b64_tr_b16 v[14:15], v232 offset:2048
    v_mfma_f32_32x32x16_bf16 v[164:179], v[76:79], v[72:75], v[164:179]
    ds_read_b64_tr_b16 v[16:17], v233 offset:0
    ds_read_b64_tr_b16 v[18:19], v233 offset:2048
    v_mfma_f32_32x32x16_bf16 v[180:195], v[80:83], v[72:75], v[180:195]
    ds_read_b128 v[20:23], v230 offset:1024
    ds_read_b128 v[24:27], v230 offset:5120
    v_mfma_f32_32x32x16_bf16 v[132:147], v[92:95], v[84:87], v[132:147]
    ds_read_b64_tr_b16 v[28:29], v232 offset:4096
    ds_read_b64_tr_b16 v[30:31], v232 offset:6144
    v_mfma_f32_32x32x16_bf16 v[148:163], v[96:99], v[84:87], v[148:163]
    ds_read_b64_tr_b16 v[32:33], v233 offset:4096
    ds_read_b64_tr_b16 v[34:35], v233 offset:6144
    v_mfma_f32_32x32x16_bf16 v[164:179], v[92:95], v[88:91], v[164:179]
    ds_read_b128 v[36:39], v230 offset:2048
    ds_read_b128 v[40:43], v230 offset:6144
    v_mfma_f32_32x32x16_bf16 v[180:195], v[96:99], v[88:91], v[180:195]
    ds_read_b64_tr_b16 v[44:45], v232 offset:8192
    ds_read_b64_tr_b16 v[46:47], v232 offset:10240
    v_mfma_f32_32x32x16_bf16 v[132:147], v[108:111], v[100:103], v[132:147]
    ds_read_b64_tr_b16 v[48:49], v233 offset:8192
    ds_read_b64_tr_b16 v[50:51], v233 offset:10240
    v_mfma_f32_32x32x16_bf16 v[148:163], v[112:115], v[100:103], v[148:163]
    ds_read_b128 v[52:55], v230 offset:3072
    ds_read_b128 v[56:59], v230 offset:7168
    v_mfma_f32_32x32x16_bf16 v[164:179], v[108:111], v[104:107], v[164:179]
    ds_read_b64_tr_b16 v[60:61], v232 offset:12288
    ds_read_b64_tr_b16 v[62:63], v232 offset:14336
    v_mfma_f32_32x32x16_bf16 v[180:195], v[112:115], v[104:107], v[180:195]
    ds_read_b64_tr_b16 v[64:65], v233 offset:12288
    ds_read_b64_tr_b16 v[66:67], v233 offset:14336
    v_mfma_f32_32x32x16_bf16 v[132:147], v[124:127], v[116:119], v[132:147]
    v_mfma_f32_32x32x16_bf16 v[148:163], v[128:131], v[116:119], v[148:163]
    v_mfma_f32_32x32x16_bf16 v[164:179], v[124:127], v[120:123], v[164:179]
    v_mfma_f32_32x32x16_bf16 v[180:195], v[128:131], v[120:123], v[180:195]
    s_waitcnt lgkmcnt(0)
    s_barrier
    v_mfma_f32_32x32x16_bf16 v[132:147], v[12:15], v[4:7], v[132:147]
    ds_read_b128 v[68:71], v230 offset:16384
    ds_read_b128 v[72:75], v230 offset:20480
    v_mfma_f32_32x32x16_bf16 v[148:163], v[16:19], v[4:7], v[148:163]
    ds_read_b64_tr_b16 v[76:77], v232 offset:16384
    ds_read_b64_tr_b16 v[78:79], v232 offset:18432
    v_mfma_f32_32x32x16_bf16 v[164:179], v[12:15], v[8:11], v[164:179]
    ds_read_b64_tr_b16 v[80:81], v233 offset:16384
    ds_read_b64_tr_b16 v[82:83], v233 offset:18432
    v_mfma_f32_32x32x16_bf16 v[180:195], v[16:19], v[8:11], v[180:195]
    ds_read_b128 v[84:87], v230 offset:17408
    ds_read_b128 v[88:91], v230 offset:21504
    v_mfma_f32_32x32x16_bf16 v[132:147], v[28:31], v[20:23], v[132:147]
    ds_read_b64_tr_b16 v[92:93], v232 offset:20480
    ds_read_b64_tr_b16 v[94:95], v232 offset:22528
    v_mfma_f32_32x32x16_bf16 v[148:163], v[32:35], v[20:23], v[148:163]
    ds_read_b64_tr_b16 v[96:97], v233 offset:20480
    ds_read_b64_tr_b16 v[98:99], v233 offset:22528
    v_mfma_f32_32x32x16_bf16 v[164:179], v[28:31], v[24:27], v[164:179]
    ds_read_b128 v[100:103], v230 offset:18432
    ds_read_b128 v[104:107], v230 offset:22528
    v_mfma_f32_32x32x16_bf16 v[180:195], v[32:35], v[24:27], v[180:195]
    ds_read_b64_tr_b16 v[108:109], v232 offset:24576
    ds_read_b64_tr_b16 v[110:111], v232 offset:26624
    v_mfma_f32_32x32x16_bf16 v[132:147], v[44:47], v[36:39], v[132:147]
    ds_read_b64_tr_b16 v[112:113], v233 offset:24576
    ds_read_b64_tr_b16 v[114:115], v233 offset:26624
    v_mfma_f32_32x32x16_bf16 v[148:163], v[48:51], v[36:39], v[148:163]
    ds_read_b128 v[116:119], v230 offset:19456
    ds_read_b128 v[120:123], v230 offset:23552
    v_mfma_f32_32x32x16_bf16 v[164:179], v[44:47], v[40:43], v[164:179]
    ds_read_b64_tr_b16 v[124:125], v232 offset:28672
    ds_read_b64_tr_b16 v[126:127], v232 offset:30720
    v_mfma_f32_32x32x16_bf16 v[180:195], v[48:51], v[40:43], v[180:195]
    ds_read_b64_tr_b16 v[128:129], v233 offset:28672
    ds_read_b64_tr_b16 v[130:131], v233 offset:30720
    v_mfma_f32_32x32x16_bf16 v[132:147], v[60:63], v[52:55], v[132:147]
    v_mfma_f32_32x32x16_bf16 v[148:163], v[64:67], v[52:55], v[148:163]
    v_mfma_f32_32x32x16_bf16 v[164:179], v[60:63], v[56:59], v[164:179]
    v_mfma_f32_32x32x16_bf16 v[180:195], v[64:67], v[56:59], v[180:195]
    s_waitcnt lgkmcnt(0)
    s_barrier
    v_mfma_f32_32x32x16_bf16 v[132:147], v[76:79], v[68:71], v[132:147]
    ds_read_b128 v[4:7], v230 offset:32768
    ds_read_b128 v[8:11], v230 offset:36864
    v_mfma_f32_32x32x16_bf16 v[148:163], v[80:83], v[68:71], v[148:163]
    ds_read_b64_tr_b16 v[12:13], v232 offset:32768
    ds_read_b64_tr_b16 v[14:15], v232 offset:34816
    v_mfma_f32_32x32x16_bf16 v[164:179], v[76:79], v[72:75], v[164:179]
    ds_read_b64_tr_b16 v[16:17], v233 offset:32768
    ds_read_b64_tr_b16 v[18:19], v233 offset:34816
    v_mfma_f32_32x32x16_bf16 v[180:195], v[80:83], v[72:75], v[180:195]
    ds_read_b128 v[20:23], v230 offset:33792
    ds_read_b128 v[24:27], v230 offset:37888
    v_mfma_f32_32x32x16_bf16 v[132:147], v[92:95], v[84:87], v[132:147]
    ds_read_b64_tr_b16 v[28:29], v232 offset:36864
    ds_read_b64_tr_b16 v[30:31], v232 offset:38912
    v_mfma_f32_32x32x16_bf16 v[148:163], v[96:99], v[84:87], v[148:163]
    ds_read_b64_tr_b16 v[32:33], v233 offset:36864
    ds_read_b64_tr_b16 v[34:35], v233 offset:38912
    v_mfma_f32_32x32x16_bf16 v[164:179], v[92:95], v[88:91], v[164:179]
    ds_read_b128 v[36:39], v230 offset:34816
    ds_read_b128 v[40:43], v230 offset:38912
    v_mfma_f32_32x32x16_bf16 v[180:195], v[96:99], v[88:91], v[180:195]
    ds_read_b64_tr_b16 v[44:45], v232 offset:40960
    ds_read_b64_tr_b16 v[46:47], v232 offset:43008
    v_mfma_f32_32x32x16_bf16 v[132:147], v[108:111], v[100:103], v[132:147]
    ds_read_b64_tr_b16 v[48:49], v233 offset:40960
    ds_read_b64_tr_b16 v[50:51], v233 offset:43008
    v_mfma_f32_32x32x16_bf16 v[148:163], v[112:115], v[100:103], v[148:163]
    ds_read_b128 v[52:55], v230 offset:35840
    ds_read_b128 v[56:59], v230 offset:39936
    v_mfma_f32_32x32x16_bf16 v[164:179], v[108:111], v[104:107], v[164:179]
    ds_read_b64_tr_b16 v[60:61], v232 offset:45056
    ds_read_b64_tr_b16 v[62:63], v232 offset:47104
    v_mfma_f32_32x32x16_bf16 v[180:195], v[112:115], v[104:107], v[180:195]
    ds_read_b64_tr_b16 v[64:65], v233 offset:45056
    ds_read_b64_tr_b16 v[66:67], v233 offset:47104
    v_mfma_f32_32x32x16_bf16 v[132:147], v[124:127], v[116:119], v[132:147]
    v_mfma_f32_32x32x16_bf16 v[148:163], v[128:131], v[116:119], v[148:163]
    v_mfma_f32_32x32x16_bf16 v[164:179], v[124:127], v[120:123], v[164:179]
    v_mfma_f32_32x32x16_bf16 v[180:195], v[128:131], v[120:123], v[180:195]
    s_waitcnt lgkmcnt(0)
    s_barrier
    v_mfma_f32_32x32x16_bf16 v[132:147], v[12:15], v[4:7], v[132:147]
    ds_read_b128 v[68:71], v230 offset:49152
    ds_read_b128 v[72:75], v230 offset:53248
    v_mfma_f32_32x32x16_bf16 v[148:163], v[16:19], v[4:7], v[148:163]
    ds_read_b64_tr_b16 v[76:77], v232 offset:49152
    ds_read_b64_tr_b16 v[78:79], v232 offset:51200
    v_mfma_f32_32x32x16_bf16 v[164:179], v[12:15], v[8:11], v[164:179]
    ds_read_b64_tr_b16 v[80:81], v233 offset:49152
    ds_read_b64_tr_b16 v[82:83], v233 offset:51200
    v_mfma_f32_32x32x16_bf16 v[180:195], v[16:19], v[8:11], v[180:195]
    ds_read_b128 v[84:87], v230 offset:50176
    ds_read_b128 v[88:91], v230 offset:54272
    v_mfma_f32_32x32x16_bf16 v[132:147], v[28:31], v[20:23], v[132:147]
    ds_read_b64_tr_b16 v[92:93], v232 offset:53248
    ds_read_b64_tr_b16 v[94:95], v232 offset:55296
    v_mfma_f32_32x32x16_bf16 v[148:163], v[32:35], v[20:23], v[148:163]
    ds_read_b64_tr_b16 v[96:97], v233 offset:53248
    ds_read_b64_tr_b16 v[98:99], v233 offset:55296
    v_mfma_f32_32x32x16_bf16 v[164:179], v[28:31], v[24:27], v[164:179]
    ds_read_b128 v[100:103], v230 offset:51200
    ds_read_b128 v[104:107], v230 offset:55296
    v_mfma_f32_32x32x16_bf16 v[180:195], v[32:35], v[24:27], v[180:195]
    ds_read_b64_tr_b16 v[108:109], v232 offset:57344
    ds_read_b64_tr_b16 v[110:111], v232 offset:59392
    v_mfma_f32_32x32x16_bf16 v[132:147], v[44:47], v[36:39], v[132:147]
    ds_read_b64_tr_b16 v[112:113], v233 offset:57344
    ds_read_b64_tr_b16 v[114:115], v233 offset:59392
    v_mfma_f32_32x32x16_bf16 v[148:163], v[48:51], v[36:39], v[148:163]
    ds_read_b128 v[116:119], v230 offset:52224
    ds_read_b128 v[120:123], v230 offset:56320
    v_mfma_f32_32x32x16_bf16 v[164:179], v[44:47], v[40:43], v[164:179]
    ds_read_b64_tr_b16 v[124:125], v232 offset:61440
    ds_read_b64_tr_b16 v[126:127], v232 offset:63488
    v_mfma_f32_32x32x16_bf16 v[180:195], v[48:51], v[40:43], v[180:195]
    ds_read_b64_tr_b16 v[128:129], v233 offset:61440
    ds_read_b64_tr_b16 v[130:131], v233 offset:63488
    v_mfma_f32_32x32x16_bf16 v[132:147], v[60:63], v[52:55], v[132:147]
    v_mfma_f32_32x32x16_bf16 v[148:163], v[64:67], v[52:55], v[148:163]
    v_mfma_f32_32x32x16_bf16 v[164:179], v[60:63], v[56:59], v[164:179]
    v_mfma_f32_32x32x16_bf16 v[180:195], v[64:67], v[56:59], v[180:195]
    s_waitcnt lgkmcnt(0)
    v_mfma_f32_32x32x16_bf16 v[132:147], v[76:79], v[68:71], v[132:147]
    v_mfma_f32_32x32x16_bf16 v[148:163], v[80:83], v[68:71], v[148:163]
    v_mfma_f32_32x32x16_bf16 v[164:179], v[76:79], v[72:75], v[164:179]
    v_mfma_f32_32x32x16_bf16 v[180:195], v[80:83], v[72:75], v[180:195]
    v_mfma_f32_32x32x16_bf16 v[132:147], v[92:95], v[84:87], v[132:147]
    v_mfma_f32_32x32x16_bf16 v[148:163], v[96:99], v[84:87], v[148:163]
    v_mfma_f32_32x32x16_bf16 v[164:179], v[92:95], v[88:91], v[164:179]
    v_mfma_f32_32x32x16_bf16 v[180:195], v[96:99], v[88:91], v[180:195]
    v_mfma_f32_32x32x16_bf16 v[132:147], v[108:111], v[100:103], v[132:147]
    v_mfma_f32_32x32x16_bf16 v[148:163], v[112:115], v[100:103], v[148:163]
    v_mfma_f32_32x32x16_bf16 v[164:179], v[108:111], v[104:107], v[164:179]
    v_mfma_f32_32x32x16_bf16 v[180:195], v[112:115], v[104:107], v[180:195]
    v_mfma_f32_32x32x16_bf16 v[132:147], v[124:127], v[116:119], v[132:147]
    v_mfma_f32_32x32x16_bf16 v[148:163], v[128:131], v[116:119], v[148:163]
    v_mfma_f32_32x32x16_bf16 v[164:179], v[124:127], v[120:123], v[164:179]
    v_mfma_f32_32x32x16_bf16 v[180:195], v[128:131], v[120:123], v[180:195]
    s_barrier
    v_and_b32 v10, 31, v1
    s_lshl_b32 s48, s50, 6
    v_add_u32 v10, s48, v10
    v_lshlrev_b32 v10, 2, v10
    v_add_u32 v10, 0x20000, v10
    ds_read_b32 v6, v10 offset:15360
    ds_read_b32 v8, v10 offset:15872
    ds_read_b32 v7, v10 offset:15488
    ds_read_b32 v9, v10 offset:16000
    v_lshrrev_b32 v4, 5, v1
    v_lshlrev_b32 v4, 4, v4
    s_xor_b32 s48, s50, 0
    s_lshl_b32 s48, s48, 7
    s_lshl_b32 s49, s51, 8
    s_add_u32 s48, s48, s49
    s_add_u32 s48, s48, 0x20c00
    v_add_u32 v10, s48, v4
    ds_read_b128 v[20:23], v10 offset:0
    ds_read_b128 v[24:27], v10 offset:32
    ds_read_b128 v[28:31], v10 offset:64
    ds_read_b128 v[32:35], v10 offset:96
    s_xor_b32 s48, s50, 1
    s_lshl_b32 s48, s48, 7
    s_lshl_b32 s49, s51, 8
    s_add_u32 s48, s48, s49
    s_add_u32 s48, s48, 0x20c00
    v_add_u32 v10, s48, v4
    ds_read_b128 v[36:39], v10 offset:0
    ds_read_b128 v[40:43], v10 offset:32
    ds_read_b128 v[44:47], v10 offset:64
    ds_read_b128 v[48:51], v10 offset:96
    s_lshl_b32 s73, s31, 2
    s_lshl_b32 s48, s50, 1
    s_add_u32 s73, s73, s48
    s_mul_i32 s73, s73, 112
    s_lshl_b32 s48, s32, 3
    s_add_u32 s73, s73, s48
    s_lshl_b32 s48, s51, 2
    s_add_u32 s73, s73, s48
    s_lshl_b32 s73, s73, 10
    s_add_u32 s73, s73, 0x600000
    s_waitcnt lgkmcnt(0)
    v_rcp_f32 v11, v8
    v_mul_f32 v246, -1.0, v6
    v_mov_b32 v247, v8
    v_mul_f32 v248, 0xc0135761, v11
    v_mul_f32 v249, v11, v11
    v_mul_f32 v249, v249, v11
    v_mul_f32 v249, 0xbdd2d3e8, v249
    v_pk_fma_f32 v[132:133], v[20:21], v[246:247], v[132:133] op_sel_hi:[1,0,1]
    v_pk_fma_f32 v[134:135], v[22:23], v[246:247], v[134:135] op_sel_hi:[1,0,1]
    v_pk_fma_f32 v[136:137], v[24:25], v[246:247], v[136:137] op_sel_hi:[1,0,1]
    v_pk_fma_f32 v[138:139], v[26:27], v[246:247], v[138:139] op_sel_hi:[1,0,1]
    v_pk_fma_f32 v[140:141], v[28:29], v[246:247], v[140:141] op_sel_hi:[1,0,1]
    v_pk_fma_f32 v[142:143], v[30:31], v[246:247], v[142:143] op_sel_hi:[1,0,1]
    v_pk_fma_f32 v[144:145], v[32:33], v[246:247], v[144:145] op_sel_hi:[1,0,1]
    v_pk_fma_f32 v[146:147], v[34:35], v[246:247], v[146:147] op_sel_hi:[1,0,1]
    v_pk_mul_f32 v[68:69], v[132:133], v[132:133]
    v_pk_mul_f32 v[70:71], v[134:135], v[134:135]
    v_pk_mul_f32 v[72:73], v[136:137], v[136:137]
    v_pk_mul_f32 v[74:75], v[138:139], v[138:139]
    v_pk_mul_f32 v[76:77], v[140:141], v[140:141]
    v_pk_mul_f32 v[78:79], v[142:143], v[142:143]
    v_pk_mul_f32 v[80:81], v[144:145], v[144:145]
    v_pk_mul_f32 v[82:83], v[146:147], v[146:147]
    v_pk_fma_f32 v[68:69], v[68:69], v[248:249], v[248:249] op_sel:[0,1,0] op_sel_hi:[1,1,0]
    v_pk_fma_f32 v[70:71], v[70:71], v[248:249], v[248:249] op_sel:[0,1,0] op_sel_hi:[1,1,0]
    v_pk_fma_f32 v[72:73], v[72:73], v[248:249], v[248:249] op_sel:[0,1,0] op_sel_hi:[1,1,0]
    v_pk_fma_f32 v[74:75], v[74:75], v[248:249], v[248:249] op_sel:[0,1,0] op_sel_hi:[1,1,0]
    v_pk_fma_f32 v[76:77], v[76:77], v[248:249], v[248:249] op_sel:[0,1,0] op_sel_hi:[1,1,0]
    v_pk_fma_f32 v[78:79], v[78:79], v[248:249], v[248:249] op_sel:[0,1,0] op_sel_hi:[1,1,0]
    v_pk_fma_f32 v[80:81], v[80:81], v[248:249], v[248:249] op_sel:[0,1,0] op_sel_hi:[1,1,0]
    v_pk_fma_f32 v[82:83], v[82:83], v[248:249], v[248:249] op_sel:[0,1,0] op_sel_hi:[1,1,0]
    v_pk_mul_f32 v[68:69], v[68:69], v[132:133]
    v_pk_mul_f32 v[70:71], v[70:71], v[134:135]
    v_pk_mul_f32 v[72:73], v[72:73], v[136:137]
    v_pk_mul_f32 v[74:75], v[74:75], v[138:139]
    v_pk_mul_f32 v[76:77], v[76:77], v[140:141]
    v_pk_mul_f32 v[78:79], v[78:79], v[142:143]
    v_pk_mul_f32 v[80:81], v[80:81], v[144:145]
    v_pk_mul_f32 v[82:83], v[82:83], v[146:147]
    v_exp_f32 v68, v68
    v_exp_f32 v69, v69
    v_exp_f32 v70, v70
    v_exp_f32 v71, v71
    v_exp_f32 v72, v72
    v_exp_f32 v73, v73
    v_exp_f32 v74, v74
    v_exp_f32 v75, v75
    v_exp_f32 v76, v76
    v_exp_f32 v77, v77
    v_exp_f32 v78, v78
    v_exp_f32 v79, v79
    v_exp_f32 v80, v80
    v_exp_f32 v81, v81
    v_exp_f32 v82, v82
    v_exp_f32 v83, v83
    v_pk_fma_f32 v[68:69], v[68:69], v[246:247], v[246:247] op_sel:[0,1,1] op_sel_hi:[1,1,1]
    v_pk_fma_f32 v[70:71], v[70:71], v[246:247], v[246:247] op_sel:[0,1,1] op_sel_hi:[1,1,1]
    v_pk_fma_f32 v[72:73], v[72:73], v[246:247], v[246:247] op_sel:[0,1,1] op_sel_hi:[1,1,1]
    v_pk_fma_f32 v[74:75], v[74:75], v[246:247], v[246:247] op_sel:[0,1,1] op_sel_hi:[1,1,1]
    v_pk_fma_f32 v[76:77], v[76:77], v[246:247], v[246:247] op_sel:[0,1,1] op_sel_hi:[1,1,1]
    v_pk_fma_f32 v[78:79], v[78:79], v[246:247], v[246:247] op_sel:[0,1,1] op_sel_hi:[1,1,1]
    v_pk_fma_f32 v[80:81], v[80:81], v[246:247], v[246:247] op_sel:[0,1,1] op_sel_hi:[1,1,1]
    v_pk_fma_f32 v[82:83], v[82:83], v[246:247], v[246:247] op_sel:[0,1,1] op_sel_hi:[1,1,1]
    v_rcp_f32 v68, v68
    v_rcp_f32 v69, v69
    v_rcp_f32 v70, v70
    v_rcp_f32 v71, v71
    v_rcp_f32 v72, v72
    v_rcp_f32 v73, v73
    v_rcp_f32 v74, v74
    v_rcp_f32 v75, v75
    v_rcp_f32 v76, v76
    v_rcp_f32 v77, v77
    v_rcp_f32 v78, v78
    v_rcp_f32 v79, v79
    v_rcp_f32 v80, v80
    v_rcp_f32 v81, v81
    v_rcp_f32 v82, v82
    v_rcp_f32 v83, v83
    v_pk_mul_f32 v[132:133], v[132:133], v[68:69]
    v_pk_mul_f32 v[134:135], v[134:135], v[70:71]
    v_pk_mul_f32 v[136:137], v[136:137], v[72:73]
    v_pk_mul_f32 v[138:139], v[138:139], v[74:75]
    v_pk_mul_f32 v[140:141], v[140:141], v[76:77]
    v_pk_mul_f32 v[142:143], v[142:143], v[78:79]
    v_pk_mul_f32 v[144:145], v[144:145], v[80:81]
    v_pk_mul_f32 v[146:147], v[146:147], v[82:83]
    v_cvt_pk_bf16_f32 v100, v132, v133
    v_cvt_pk_bf16_f32 v101, v134, v135
    v_cvt_pk_bf16_f32 v102, v136, v137
    v_cvt_pk_bf16_f32 v103, v138, v139
    v_cvt_pk_bf16_f32 v104, v140, v141
    v_cvt_pk_bf16_f32 v105, v142, v143
    v_cvt_pk_bf16_f32 v106, v144, v145
    v_cvt_pk_bf16_f32 v107, v146, v147
    s_xor_b32 s48, s50, 0
    s_lshl_b32 s48, s48, 11
    s_add_u32 s48, s48, s73
    buffer_store_dwordx4 v[100:103], v244, s[40:43], s48 offen sc1
    buffer_store_dwordx4 v[104:107], v244, s[40:43], s48 offen offset:1024 sc1
    v_pk_fma_f32 v[148:149], v[36:37], v[246:247], v[148:149] op_sel_hi:[1,0,1]
    v_pk_fma_f32 v[150:151], v[38:39], v[246:247], v[150:151] op_sel_hi:[1,0,1]
    v_pk_fma_f32 v[152:153], v[40:41], v[246:247], v[152:153] op_sel_hi:[1,0,1]
    v_pk_fma_f32 v[154:155], v[42:43], v[246:247], v[154:155] op_sel_hi:[1,0,1]
    v_pk_fma_f32 v[156:157], v[44:45], v[246:247], v[156:157] op_sel_hi:[1,0,1]
    v_pk_fma_f32 v[158:159], v[46:47], v[246:247], v[158:159] op_sel_hi:[1,0,1]
    v_pk_fma_f32 v[160:161], v[48:49], v[246:247], v[160:161] op_sel_hi:[1,0,1]
    v_pk_fma_f32 v[162:163], v[50:51], v[246:247], v[162:163] op_sel_hi:[1,0,1]
    v_pk_mul_f32 v[84:85], v[148:149], v[148:149]
    v_pk_mul_f32 v[86:87], v[150:151], v[150:151]
    v_pk_mul_f32 v[88:89], v[152:153], v[152:153]
    v_pk_mul_f32 v[90:91], v[154:155], v[154:155]
    v_pk_mul_f32 v[92:93], v[156:157], v[156:157]
    v_pk_mul_f32 v[94:95], v[158:159], v[158:159]
    v_pk_mul_f32 v[96:97], v[160:161], v[160:161]
    v_pk_mul_f32 v[98:99], v[162:163], v[162:163]
    v_pk_fma_f32 v[84:85], v[84:85], v[248:249], v[248:249] op_sel:[0,1,0] op_sel_hi:[1,1,0]
    v_pk_fma_f32 v[86:87], v[86:87], v[248:249], v[248:249] op_sel:[0,1,0] op_sel_hi:[1,1,0]
    v_pk_fma_f32 v[88:89], v[88:89], v[248:249], v[248:249] op_sel:[0,1,0] op_sel_hi:[1,1,0]
    v_pk_fma_f32 v[90:91], v[90:91], v[248:249], v[248:249] op_sel:[0,1,0] op_sel_hi:[1,1,0]
    v_pk_fma_f32 v[92:93], v[92:93], v[248:249], v[248:249] op_sel:[0,1,0] op_sel_hi:[1,1,0]
    v_pk_fma_f32 v[94:95], v[94:95], v[248:249], v[248:249] op_sel:[0,1,0] op_sel_hi:[1,1,0]
    v_pk_fma_f32 v[96:97], v[96:97], v[248:249], v[248:249] op_sel:[0,1,0] op_sel_hi:[1,1,0]
    v_pk_fma_f32 v[98:99], v[98:99], v[248:249], v[248:249] op_sel:[0,1,0] op_sel_hi:[1,1,0]
    v_pk_mul_f32 v[84:85], v[84:85], v[148:149]
    v_pk_mul_f32 v[86:87], v[86:87], v[150:151]
    v_pk_mul_f32 v[88:89], v[88:89], v[152:153]
    v_pk_mul_f32 v[90:91], v[90:91], v[154:155]
    v_pk_mul_f32 v[92:93], v[92:93], v[156:157]
    v_pk_mul_f32 v[94:95], v[94:95], v[158:159]
    v_pk_mul_f32 v[96:97], v[96:97], v[160:161]
    v_pk_mul_f32 v[98:99], v[98:99], v[162:163]
    v_exp_f32 v84, v84
    v_exp_f32 v85, v85
    v_exp_f32 v86, v86
    v_exp_f32 v87, v87
    v_exp_f32 v88, v88
    v_exp_f32 v89, v89
    v_exp_f32 v90, v90
    v_exp_f32 v91, v91
    v_exp_f32 v92, v92
    v_exp_f32 v93, v93
    v_exp_f32 v94, v94
    v_exp_f32 v95, v95
    v_exp_f32 v96, v96
    v_exp_f32 v97, v97
    v_exp_f32 v98, v98
    v_exp_f32 v99, v99
    v_pk_fma_f32 v[84:85], v[84:85], v[246:247], v[246:247] op_sel:[0,1,1] op_sel_hi:[1,1,1]
    v_pk_fma_f32 v[86:87], v[86:87], v[246:247], v[246:247] op_sel:[0,1,1] op_sel_hi:[1,1,1]
    v_pk_fma_f32 v[88:89], v[88:89], v[246:247], v[246:247] op_sel:[0,1,1] op_sel_hi:[1,1,1]
    v_pk_fma_f32 v[90:91], v[90:91], v[246:247], v[246:247] op_sel:[0,1,1] op_sel_hi:[1,1,1]
    v_pk_fma_f32 v[92:93], v[92:93], v[246:247], v[246:247] op_sel:[0,1,1] op_sel_hi:[1,1,1]
    v_pk_fma_f32 v[94:95], v[94:95], v[246:247], v[246:247] op_sel:[0,1,1] op_sel_hi:[1,1,1]
    v_pk_fma_f32 v[96:97], v[96:97], v[246:247], v[246:247] op_sel:[0,1,1] op_sel_hi:[1,1,1]
    v_pk_fma_f32 v[98:99], v[98:99], v[246:247], v[246:247] op_sel:[0,1,1] op_sel_hi:[1,1,1]
    v_rcp_f32 v84, v84
    v_rcp_f32 v85, v85
    v_rcp_f32 v86, v86
    v_rcp_f32 v87, v87
    v_rcp_f32 v88, v88
    v_rcp_f32 v89, v89
    v_rcp_f32 v90, v90
    v_rcp_f32 v91, v91
    v_rcp_f32 v92, v92
    v_rcp_f32 v93, v93
    v_rcp_f32 v94, v94
    v_rcp_f32 v95, v95
    v_rcp_f32 v96, v96
    v_rcp_f32 v97, v97
    v_rcp_f32 v98, v98
    v_rcp_f32 v99, v99
    v_pk_mul_f32 v[148:149], v[148:149], v[84:85]
    v_pk_mul_f32 v[150:151], v[150:151], v[86:87]
    v_pk_mul_f32 v[152:153], v[152:153], v[88:89]
    v_pk_mul_f32 v[154:155], v[154:155], v[90:91]
    v_pk_mul_f32 v[156:157], v[156:157], v[92:93]
    v_pk_mul_f32 v[158:159], v[158:159], v[94:95]
    v_pk_mul_f32 v[160:161], v[160:161], v[96:97]
    v_pk_mul_f32 v[162:163], v[162:163], v[98:99]
    v_cvt_pk_bf16_f32 v108, v148, v149
    v_cvt_pk_bf16_f32 v109, v150, v151
    v_cvt_pk_bf16_f32 v110, v152, v153
    v_cvt_pk_bf16_f32 v111, v154, v155
    v_cvt_pk_bf16_f32 v112, v156, v157
    v_cvt_pk_bf16_f32 v113, v158, v159
    v_cvt_pk_bf16_f32 v114, v160, v161
    v_cvt_pk_bf16_f32 v115, v162, v163
    s_xor_b32 s48, s50, 1
    s_lshl_b32 s48, s48, 11
    s_add_u32 s48, s48, s73
    buffer_store_dwordx4 v[108:111], v244, s[40:43], s48 offen sc1
    buffer_store_dwordx4 v[112:115], v244, s[40:43], s48 offen offset:1024 sc1
    v_rcp_f32 v11, v9
    v_mul_f32 v246, -1.0, v7
    v_mov_b32 v247, v9
    v_mul_f32 v248, 0xc0135761, v11
    v_mul_f32 v249, v11, v11
    v_mul_f32 v249, v249, v11
    v_mul_f32 v249, 0xbdd2d3e8, v249
    v_pk_fma_f32 v[164:165], v[20:21], v[246:247], v[164:165] op_sel_hi:[1,0,1]
    v_pk_fma_f32 v[166:167], v[22:23], v[246:247], v[166:167] op_sel_hi:[1,0,1]
    v_pk_fma_f32 v[168:169], v[24:25], v[246:247], v[168:169] op_sel_hi:[1,0,1]
    v_pk_fma_f32 v[170:171], v[26:27], v[246:247], v[170:171] op_sel_hi:[1,0,1]
    v_pk_fma_f32 v[172:173], v[28:29], v[246:247], v[172:173] op_sel_hi:[1,0,1]
    v_pk_fma_f32 v[174:175], v[30:31], v[246:247], v[174:175] op_sel_hi:[1,0,1]
    v_pk_fma_f32 v[176:177], v[32:33], v[246:247], v[176:177] op_sel_hi:[1,0,1]
    v_pk_fma_f32 v[178:179], v[34:35], v[246:247], v[178:179] op_sel_hi:[1,0,1]
    v_pk_mul_f32 v[68:69], v[164:165], v[164:165]
    v_pk_mul_f32 v[70:71], v[166:167], v[166:167]
    v_pk_mul_f32 v[72:73], v[168:169], v[168:169]
    v_pk_mul_f32 v[74:75], v[170:171], v[170:171]
    v_pk_mul_f32 v[76:77], v[172:173], v[172:173]
    v_pk_mul_f32 v[78:79], v[174:175], v[174:175]
    v_pk_mul_f32 v[80:81], v[176:177], v[176:177]
    v_pk_mul_f32 v[82:83], v[178:179], v[178:179]
    v_pk_fma_f32 v[68:69], v[68:69], v[248:249], v[248:249] op_sel:[0,1,0] op_sel_hi:[1,1,0]
    v_pk_fma_f32 v[70:71], v[70:71], v[248:249], v[248:249] op_sel:[0,1,0] op_sel_hi:[1,1,0]
    v_pk_fma_f32 v[72:73], v[72:73], v[248:249], v[248:249] op_sel:[0,1,0] op_sel_hi:[1,1,0]
    v_pk_fma_f32 v[74:75], v[74:75], v[248:249], v[248:249] op_sel:[0,1,0] op_sel_hi:[1,1,0]
    v_pk_fma_f32 v[76:77], v[76:77], v[248:249], v[248:249] op_sel:[0,1,0] op_sel_hi:[1,1,0]
    v_pk_fma_f32 v[78:79], v[78:79], v[248:249], v[248:249] op_sel:[0,1,0] op_sel_hi:[1,1,0]
    v_pk_fma_f32 v[80:81], v[80:81], v[248:249], v[248:249] op_sel:[0,1,0] op_sel_hi:[1,1,0]
    v_pk_fma_f32 v[82:83], v[82:83], v[248:249], v[248:249] op_sel:[0,1,0] op_sel_hi:[1,1,0]
    v_pk_mul_f32 v[68:69], v[68:69], v[164:165]
    v_pk_mul_f32 v[70:71], v[70:71], v[166:167]
    v_pk_mul_f32 v[72:73], v[72:73], v[168:169]
    v_pk_mul_f32 v[74:75], v[74:75], v[170:171]
    v_pk_mul_f32 v[76:77], v[76:77], v[172:173]
    v_pk_mul_f32 v[78:79], v[78:79], v[174:175]
    v_pk_mul_f32 v[80:81], v[80:81], v[176:177]
    v_pk_mul_f32 v[82:83], v[82:83], v[178:179]
    v_exp_f32 v68, v68
    v_exp_f32 v69, v69
    v_exp_f32 v70, v70
    v_exp_f32 v71, v71
    v_exp_f32 v72, v72
    v_exp_f32 v73, v73
    v_exp_f32 v74, v74
    v_exp_f32 v75, v75
    v_exp_f32 v76, v76
    v_exp_f32 v77, v77
    v_exp_f32 v78, v78
    v_exp_f32 v79, v79
    v_exp_f32 v80, v80
    v_exp_f32 v81, v81
    v_exp_f32 v82, v82
    v_exp_f32 v83, v83
    v_pk_fma_f32 v[68:69], v[68:69], v[246:247], v[246:247] op_sel:[0,1,1] op_sel_hi:[1,1,1]
    v_pk_fma_f32 v[70:71], v[70:71], v[246:247], v[246:247] op_sel:[0,1,1] op_sel_hi:[1,1,1]
    v_pk_fma_f32 v[72:73], v[72:73], v[246:247], v[246:247] op_sel:[0,1,1] op_sel_hi:[1,1,1]
    v_pk_fma_f32 v[74:75], v[74:75], v[246:247], v[246:247] op_sel:[0,1,1] op_sel_hi:[1,1,1]
    v_pk_fma_f32 v[76:77], v[76:77], v[246:247], v[246:247] op_sel:[0,1,1] op_sel_hi:[1,1,1]
    v_pk_fma_f32 v[78:79], v[78:79], v[246:247], v[246:247] op_sel:[0,1,1] op_sel_hi:[1,1,1]
    v_pk_fma_f32 v[80:81], v[80:81], v[246:247], v[246:247] op_sel:[0,1,1] op_sel_hi:[1,1,1]
    v_pk_fma_f32 v[82:83], v[82:83], v[246:247], v[246:247] op_sel:[0,1,1] op_sel_hi:[1,1,1]
    v_rcp_f32 v68, v68
    v_rcp_f32 v69, v69
    v_rcp_f32 v70, v70
    v_rcp_f32 v71, v71
    v_rcp_f32 v72, v72
    v_rcp_f32 v73, v73
    v_rcp_f32 v74, v74
    v_rcp_f32 v75, v75
    v_rcp_f32 v76, v76
    v_rcp_f32 v77, v77
    v_rcp_f32 v78, v78
    v_rcp_f32 v79, v79
    v_rcp_f32 v80, v80
    v_rcp_f32 v81, v81
    v_rcp_f32 v82, v82
    v_rcp_f32 v83, v83
    v_pk_mul_f32 v[164:165], v[164:165], v[68:69]
    v_pk_mul_f32 v[166:167], v[166:167], v[70:71]
    v_pk_mul_f32 v[168:169], v[168:169], v[72:73]
    v_pk_mul_f32 v[170:171], v[170:171], v[74:75]
    v_pk_mul_f32 v[172:173], v[172:173], v[76:77]
    v_pk_mul_f32 v[174:175], v[174:175], v[78:79]
    v_pk_mul_f32 v[176:177], v[176:177], v[80:81]
    v_pk_mul_f32 v[178:179], v[178:179], v[82:83]
    v_cvt_pk_bf16_f32 v116, v164, v165
    v_cvt_pk_bf16_f32 v117, v166, v167
    v_cvt_pk_bf16_f32 v118, v168, v169
    v_cvt_pk_bf16_f32 v119, v170, v171
    v_cvt_pk_bf16_f32 v120, v172, v173
    v_cvt_pk_bf16_f32 v121, v174, v175
    v_cvt_pk_bf16_f32 v122, v176, v177
    v_cvt_pk_bf16_f32 v123, v178, v179
    s_xor_b32 s48, s50, 0
    s_lshl_b32 s48, s48, 11
    s_add_u32 s48, s48, s73
    s_add_u32 s48, s48, 114688
    buffer_store_dwordx4 v[116:119], v244, s[40:43], s48 offen sc1
    buffer_store_dwordx4 v[120:123], v244, s[40:43], s48 offen offset:1024 sc1
    v_pk_fma_f32 v[180:181], v[36:37], v[246:247], v[180:181] op_sel_hi:[1,0,1]
    v_pk_fma_f32 v[182:183], v[38:39], v[246:247], v[182:183] op_sel_hi:[1,0,1]
    v_pk_fma_f32 v[184:185], v[40:41], v[246:247], v[184:185] op_sel_hi:[1,0,1]
    v_pk_fma_f32 v[186:187], v[42:43], v[246:247], v[186:187] op_sel_hi:[1,0,1]
    v_pk_fma_f32 v[188:189], v[44:45], v[246:247], v[188:189] op_sel_hi:[1,0,1]
    v_pk_fma_f32 v[190:191], v[46:47], v[246:247], v[190:191] op_sel_hi:[1,0,1]
    v_pk_fma_f32 v[192:193], v[48:49], v[246:247], v[192:193] op_sel_hi:[1,0,1]
    v_pk_fma_f32 v[194:195], v[50:51], v[246:247], v[194:195] op_sel_hi:[1,0,1]
    v_pk_mul_f32 v[84:85], v[180:181], v[180:181]
    v_pk_mul_f32 v[86:87], v[182:183], v[182:183]
    v_pk_mul_f32 v[88:89], v[184:185], v[184:185]
    v_pk_mul_f32 v[90:91], v[186:187], v[186:187]
    v_pk_mul_f32 v[92:93], v[188:189], v[188:189]
    v_pk_mul_f32 v[94:95], v[190:191], v[190:191]
    v_pk_mul_f32 v[96:97], v[192:193], v[192:193]
    v_pk_mul_f32 v[98:99], v[194:195], v[194:195]
    v_pk_fma_f32 v[84:85], v[84:85], v[248:249], v[248:249] op_sel:[0,1,0] op_sel_hi:[1,1,0]
    v_pk_fma_f32 v[86:87], v[86:87], v[248:249], v[248:249] op_sel:[0,1,0] op_sel_hi:[1,1,0]
    v_pk_fma_f32 v[88:89], v[88:89], v[248:249], v[248:249] op_sel:[0,1,0] op_sel_hi:[1,1,0]
    v_pk_fma_f32 v[90:91], v[90:91], v[248:249], v[248:249] op_sel:[0,1,0] op_sel_hi:[1,1,0]
    v_pk_fma_f32 v[92:93], v[92:93], v[248:249], v[248:249] op_sel:[0,1,0] op_sel_hi:[1,1,0]
    v_pk_fma_f32 v[94:95], v[94:95], v[248:249], v[248:249] op_sel:[0,1,0] op_sel_hi:[1,1,0]
    v_pk_fma_f32 v[96:97], v[96:97], v[248:249], v[248:249] op_sel:[0,1,0] op_sel_hi:[1,1,0]
    v_pk_fma_f32 v[98:99], v[98:99], v[248:249], v[248:249] op_sel:[0,1,0] op_sel_hi:[1,1,0]
    v_pk_mul_f32 v[84:85], v[84:85], v[180:181]
    v_pk_mul_f32 v[86:87], v[86:87], v[182:183]
    v_pk_mul_f32 v[88:89], v[88:89], v[184:185]
    v_pk_mul_f32 v[90:91], v[90:91], v[186:187]
    v_pk_mul_f32 v[92:93], v[92:93], v[188:189]
    v_pk_mul_f32 v[94:95], v[94:95], v[190:191]
    v_pk_mul_f32 v[96:97], v[96:97], v[192:193]
    v_pk_mul_f32 v[98:99], v[98:99], v[194:195]
    v_exp_f32 v84, v84
    v_exp_f32 v85, v85
    v_exp_f32 v86, v86
    v_exp_f32 v87, v87
    v_exp_f32 v88, v88
    v_exp_f32 v89, v89
    v_exp_f32 v90, v90
    v_exp_f32 v91, v91
    v_exp_f32 v92, v92
    v_exp_f32 v93, v93
    v_exp_f32 v94, v94
    v_exp_f32 v95, v95
    v_exp_f32 v96, v96
    v_exp_f32 v97, v97
    v_exp_f32 v98, v98
    v_exp_f32 v99, v99
    v_pk_fma_f32 v[84:85], v[84:85], v[246:247], v[246:247] op_sel:[0,1,1] op_sel_hi:[1,1,1]
    v_pk_fma_f32 v[86:87], v[86:87], v[246:247], v[246:247] op_sel:[0,1,1] op_sel_hi:[1,1,1]
    v_pk_fma_f32 v[88:89], v[88:89], v[246:247], v[246:247] op_sel:[0,1,1] op_sel_hi:[1,1,1]
    v_pk_fma_f32 v[90:91], v[90:91], v[246:247], v[246:247] op_sel:[0,1,1] op_sel_hi:[1,1,1]
    v_pk_fma_f32 v[92:93], v[92:93], v[246:247], v[246:247] op_sel:[0,1,1] op_sel_hi:[1,1,1]
    v_pk_fma_f32 v[94:95], v[94:95], v[246:247], v[246:247] op_sel:[0,1,1] op_sel_hi:[1,1,1]
    v_pk_fma_f32 v[96:97], v[96:97], v[246:247], v[246:247] op_sel:[0,1,1] op_sel_hi:[1,1,1]
    v_pk_fma_f32 v[98:99], v[98:99], v[246:247], v[246:247] op_sel:[0,1,1] op_sel_hi:[1,1,1]
    v_rcp_f32 v84, v84
    v_rcp_f32 v85, v85
    v_rcp_f32 v86, v86
    v_rcp_f32 v87, v87
    v_rcp_f32 v88, v88
    v_rcp_f32 v89, v89
    v_rcp_f32 v90, v90
    v_rcp_f32 v91, v91
    v_rcp_f32 v92, v92
    v_rcp_f32 v93, v93
    v_rcp_f32 v94, v94
    v_rcp_f32 v95, v95
    v_rcp_f32 v96, v96
    v_rcp_f32 v97, v97
    v_rcp_f32 v98, v98
    v_rcp_f32 v99, v99
    v_pk_mul_f32 v[180:181], v[180:181], v[84:85]
    v_pk_mul_f32 v[182:183], v[182:183], v[86:87]
    v_pk_mul_f32 v[184:185], v[184:185], v[88:89]
    v_pk_mul_f32 v[186:187], v[186:187], v[90:91]
    v_pk_mul_f32 v[188:189], v[188:189], v[92:93]
    v_pk_mul_f32 v[190:191], v[190:191], v[94:95]
    v_pk_mul_f32 v[192:193], v[192:193], v[96:97]
    v_pk_mul_f32 v[194:195], v[194:195], v[98:99]
    v_cvt_pk_bf16_f32 v124, v180, v181
    v_cvt_pk_bf16_f32 v125, v182, v183
    v_cvt_pk_bf16_f32 v126, v184, v185
    v_cvt_pk_bf16_f32 v127, v186, v187
    v_cvt_pk_bf16_f32 v128, v188, v189
    v_cvt_pk_bf16_f32 v129, v190, v191
    v_cvt_pk_bf16_f32 v130, v192, v193
    v_cvt_pk_bf16_f32 v131, v194, v195
    s_xor_b32 s48, s50, 1
    s_lshl_b32 s48, s48, 11
    s_add_u32 s48, s48, s73
    s_add_u32 s48, s48, 114688
    buffer_store_dwordx4 v[124:127], v244, s[40:43], s48 offen sc1
    buffer_store_dwordx4 v[128:131], v244, s[40:43], s48 offen offset:1024 sc1
    v_mov_b32 v132, 0
    v_mov_b32 v133, 0
    v_mov_b32 v134, 0
    v_mov_b32 v135, 0
    v_mov_b32 v136, 0
    v_mov_b32 v137, 0
    v_mov_b32 v138, 0
    v_mov_b32 v139, 0
    v_mov_b32 v140, 0
    v_mov_b32 v141, 0
    v_mov_b32 v142, 0
    v_mov_b32 v143, 0
    v_mov_b32 v144, 0
    v_mov_b32 v145, 0
    v_mov_b32 v146, 0
    v_mov_b32 v147, 0
    v_mov_b32 v148, 0
    v_mov_b32 v149, 0
    v_mov_b32 v150, 0
    v_mov_b32 v151, 0
    v_mov_b32 v152, 0
    v_mov_b32 v153, 0
    v_mov_b32 v154, 0
    v_mov_b32 v155, 0
    v_mov_b32 v156, 0
    v_mov_b32 v157, 0
    v_mov_b32 v158, 0
    v_mov_b32 v159, 0
    v_mov_b32 v160, 0
    v_mov_b32 v161, 0
    v_mov_b32 v162, 0
    v_mov_b32 v163, 0
    v_mov_b32 v164, 0
    v_mov_b32 v165, 0
    v_mov_b32 v166, 0
    v_mov_b32 v167, 0
    v_mov_b32 v168, 0
    v_mov_b32 v169, 0
    v_mov_b32 v170, 0
    v_mov_b32 v171, 0
    v_mov_b32 v172, 0
    v_mov_b32 v173, 0
    v_mov_b32 v174, 0
    v_mov_b32 v175, 0
    v_mov_b32 v176, 0
    v_mov_b32 v177, 0
    v_mov_b32 v178, 0
    v_mov_b32 v179, 0
    v_mov_b32 v180, 0
    v_mov_b32 v181, 0
    v_mov_b32 v182, 0
    v_mov_b32 v183, 0
    v_mov_b32 v184, 0
    v_mov_b32 v185, 0
    v_mov_b32 v186, 0
    v_mov_b32 v187, 0
    v_mov_b32 v188, 0
    v_mov_b32 v189, 0
    v_mov_b32 v190, 0
    v_mov_b32 v191, 0
    v_mov_b32 v192, 0
    v_mov_b32 v193, 0
    v_mov_b32 v194, 0
    v_mov_b32 v195, 0
    s_branch L_C_u4_14
L_C_sp_13:
    s_waitcnt vmcnt(0)
    s_mov_b64 exec, 1
    v_mov_b32 v246, 0x20e08
    v_mov_b32 v247, 1
    ds_add_rtn_u32 v248, v246, v247
    s_lshl_b32 s52, s29, 4
    s_add_u32 s52, s52, s30
    s_lshl_b32 s52, s52, 3
    s_add_u32 s52, s52, 0x2000
    s_waitcnt lgkmcnt(0)
    v_readfirstlane_b32 s48, v248
    s_cmp_eq_u32 s48, 3
    s_cbranch_scc0 L_C_sig_17
    v_mov_b32 v246, s34
    v_mov_b32 v247, s35
    v_mov_b32 v248, s52
    s_cmp_lg_u32 s53, 0
    s_cbranch_scc1 L_C_sigp_18
    buffer_store_dwordx2 v[246:247], v248, s[40:43], 0 offen sc1
    s_branch L_C_sig_17
L_C_sigp_18:
    v_xor_b32 v247, s10, v247
    v_add_u32 v248, 0x4000, v248
    buffer_store_dwordx2 v[246:247], v248, s[40:43], 0 offen
L_C_sig_17:
    s_mov_b64 exec, -1
L_C_u4_14:
    s_barrier
    ds_read_b128 v[4:7], v230 offset:0
    ds_read_b64_tr_b16 v[8:9], v231 offset:0
    ds_read_b64_tr_b16 v[10:11], v231 offset:1024
    ds_read_b128 v[12:15], v230 offset:1024
    ds_read_b64_tr_b16 v[16:17], v231 offset:2048
    ds_read_b64_tr_b16 v[18:19], v231 offset:3072
    ds_read_b128 v[20:23], v230 offset:2048
    ds_read_b64_tr_b16 v[24:25], v231 offset:4096
    ds_read_b64_tr_b16 v[26:27], v231 offset:5120
    ds_read_b128 v[28:31], v230 offset:3072
    ds_read_b64_tr_b16 v[32:33], v231 offset:6144
    ds_read_b64_tr_b16 v[34:35], v231 offset:7168
    ds_read_b128 v[36:39], v230 offset:4096
    ds_read_b64_tr_b16 v[40:41], v231 offset:8192
    ds_read_b64_tr_b16 v[42:43], v231 offset:9216
    ds_read_b128 v[44:47], v230 offset:5120
    ds_read_b64_tr_b16 v[48:49], v231 offset:10240
    ds_read_b64_tr_b16 v[50:51], v231 offset:11264
    ds_read_b128 v[52:55], v230 offset:6144
    ds_read_b64_tr_b16 v[56:57], v231 offset:12288
    ds_read_b64_tr_b16 v[58:59], v231 offset:13312
    ds_read_b128 v[60:63], v230 offset:7168
    ds_read_b64_tr_b16 v[64:65], v231 offset:14336
    ds_read_b64_tr_b16 v[66:67], v231 offset:15360
    s_waitcnt lgkmcnt(0)
    s_barrier
    v_mfma_f32_32x32x16_bf16 v[164:179], v[8:11], v[4:7], v[164:179]
    ds_read_b128 v[68:71], v230 offset:16384
    ds_read_b64_tr_b16 v[72:73], v231 offset:16384
    ds_read_b64_tr_b16 v[74:75], v231 offset:17408
    ds_read_b128 v[76:79], v230 offset:17408
    v_mfma_f32_32x32x16_bf16 v[180:195], v[16:19], v[12:15], v[180:195]
    ds_read_b64_tr_b16 v[80:81], v231 offset:18432
    ds_read_b64_tr_b16 v[82:83], v231 offset:19456
    ds_read_b128 v[84:87], v230 offset:18432
    ds_read_b64_tr_b16 v[88:89], v231 offset:20480
    v_mfma_f32_32x32x16_bf16 v[164:179], v[24:27], v[20:23], v[164:179]
    ds_read_b64_tr_b16 v[90:91], v231 offset:21504
    ds_read_b128 v[92:95], v230 offset:19456
    ds_read_b64_tr_b16 v[96:97], v231 offset:22528
    ds_read_b64_tr_b16 v[98:99], v231 offset:23552
    v_mfma_f32_32x32x16_bf16 v[180:195], v[32:35], v[28:31], v[180:195]
    ds_read_b128 v[100:103], v230 offset:20480
    ds_read_b64_tr_b16 v[104:105], v231 offset:24576
    ds_read_b64_tr_b16 v[106:107], v231 offset:25600
    ds_read_b128 v[108:111], v230 offset:21504
    v_mfma_f32_32x32x16_bf16 v[164:179], v[40:43], v[36:39], v[164:179]
    ds_read_b64_tr_b16 v[112:113], v231 offset:26624
    ds_read_b64_tr_b16 v[114:115], v231 offset:27648
    ds_read_b128 v[116:119], v230 offset:22528
    ds_read_b64_tr_b16 v[120:121], v231 offset:28672
    v_mfma_f32_32x32x16_bf16 v[180:195], v[48:51], v[44:47], v[180:195]
    ds_read_b64_tr_b16 v[122:123], v231 offset:29696
    ds_read_b128 v[124:127], v230 offset:23552
    ds_read_b64_tr_b16 v[128:129], v231 offset:30720
    ds_read_b64_tr_b16 v[130:131], v231 offset:31744
    v_mfma_f32_32x32x16_bf16 v[164:179], v[56:59], v[52:55], v[164:179]
    v_mfma_f32_32x32x16_bf16 v[180:195], v[64:67], v[60:63], v[180:195]
    s_waitcnt lgkmcnt(0)
    s_barrier
    v_mfma_f32_32x32x16_bf16 v[164:179], v[72:75], v[68:71], v[164:179]
    ds_read_b128 v[4:7], v230 offset:32768
    ds_read_b64_tr_b16 v[8:9], v231 offset:32768
    ds_read_b64_tr_b16 v[10:11], v231 offset:33792
    ds_read_b128 v[12:15], v230 offset:33792
    v_mfma_f32_32x32x16_bf16 v[180:195], v[80:83], v[76:79], v[180:195]
    ds_read_b64_tr_b16 v[16:17], v231 offset:34816
    ds_read_b64_tr_b16 v[18:19], v231 offset:35840
    ds_read_b128 v[20:23], v230 offset:34816
    ds_read_b64_tr_b16 v[24:25], v231 offset:36864
    v_mfma_f32_32x32x16_bf16 v[164:179], v[88:91], v[84:87], v[164:179]
    ds_read_b64_tr_b16 v[26:27], v231 offset:37888
    ds_read_b128 v[28:31], v230 offset:35840
    ds_read_b64_tr_b16 v[32:33], v231 offset:38912
    ds_read_b64_tr_b16 v[34:35], v231 offset:39936
    v_mfma_f32_32x32x16_bf16 v[180:195], v[96:99], v[92:95], v[180:195]
    ds_read_b128 v[36:39], v230 offset:36864
    ds_read_b64_tr_b16 v[40:41], v231 offset:40960
    ds_read_b64_tr_b16 v[42:43], v231 offset:41984
    ds_read_b128 v[44:47], v230 offset:37888
    v_mfma_f32_32x32x16_bf16 v[164:179], v[104:107], v[100:103], v[164:179]
    ds_read_b64_tr_b16 v[48:49], v231 offset:43008
    ds_read_b64_tr_b16 v[50:51], v231 offset:44032
    ds_read_b128 v[52:55], v230 offset:38912
    ds_read_b64_tr_b16 v[56:57], v231 offset:45056
    v_mfma_f32_32x32x16_bf16 v[180:195], v[112:115], v[108:111], v[180:195]
    ds_read_b64_tr_b16 v[58:59], v231 offset:46080
    ds_read_b128 v[60:63], v230 offset:39936
    ds_read_b64_tr_b16 v[64:65], v231 offset:47104
    ds_read_b64_tr_b16 v[66:67], v231 offset:48128
    v_mfma_f32_32x32x16_bf16 v[164:179], v[120:123], v[116:119], v[164:179]
    v_mfma_f32_32x32x16_bf16 v[180:195], v[128:131], v[124:127], v[180:195]
    s_waitcnt lgkmcnt(0)
    s_cmp_lg_u32 s33, 0
    s_cbranch_scc1 L_C_nosig_19
    s_waitcnt vmcnt(0)
    s_mov_b64 exec, 1
    v_mov_b32 v246, 0x20e0c
    v_mov_b32 v247, 1
    ds_add_rtn_u32 v248, v246, v247
    s_lshl_b32 s52, s31, 4
    s_add_u32 s52, s52, s32
    s_lshl_b32 s52, s52, 3
    s_add_u32 s52, s52, 0x1800
    s_waitcnt lgkmcnt(0)
    v_readfirstlane_b32 s48, v248
    s_cmp_eq_u32 s48, 3
    s_cbranch_scc0 L_C_sig_20
    v_mov_b32 v246, s34
    v_mov_b32 v247, s35
    v_mov_b32 v248, s52
    s_cmp_lg_u32 s53, 0
    s_cbranch_scc1 L_C_sigp_21
    buffer_store_dwordx2 v[246:247], v248, s[40:43], 0 offen sc1
    s_branch L_C_sig_20
L_C_sigp_21:
    v_xor_b32 v247, s10, v247
    v_add_u32 v248, 0x4000, v248
    buffer_store_dwordx2 v[246:247], v248, s[40:43], 0 offen
L_C_sig_20:
    s_mov_b64 exec, -1
L_C_nosig_19:
    s_barrier
    v_mfma_f32_32x32x16_bf16 v[164:179], v[8:11], v[4:7], v[164:179]
    ds_read_b128 v[68:71], v230 offset:49152
    ds_read_b64_tr_b16 v[72:73], v231 offset:49152
    ds_read_b64_tr_b16 v[74:75], v231 offset:50176
    ds_read_b128 v[76:79], v230 offset:50176
    v_mfma_f32_32x32x16_bf16 v[180:195], v[16:19], v[12:15], v[180:195]
    ds_read_b64_tr_b16 v[80:81], v231 offset:51200
    ds_read_b64_tr_b16 v[82:83], v231 offset:52224
    ds_read_b128 v[84:87], v230 offset:51200
    ds_read_b64_tr_b16 v[88:89], v231 offset:53248
    v_mfma_f32_32x32x16_bf16 v[164:179], v[24:27], v[20:23], v[164:179]
    ds_read_b64_tr_b16 v[90:91], v231 offset:54272
    ds_read_b128 v[92:95], v230 offset:52224
    ds_read_b64_tr_b16 v[96:97], v231 offset:55296
    ds_read_b64_tr_b16 v[98:99], v231 offset:56320
    v_mfma_f32_32x32x16_bf16 v[180:195], v[32:35], v[28:31], v[180:195]
    ds_read_b128 v[100:103], v230 offset:53248
    ds_read_b64_tr_b16 v[104:105], v231 offset:57344
    ds_read_b64_tr_b16 v[106:107], v231 offset:58368
    ds_read_b128 v[108:111], v230 offset:54272
    v_mfma_f32_32x32x16_bf16 v[164:179], v[40:43], v[36:39], v[164:179]
    ds_read_b64_tr_b16 v[112:113], v231 offset:59392
    ds_read_b64_tr_b16 v[114:115], v231 offset:60416
    ds_read_b128 v[116:119], v230 offset:55296
    ds_read_b64_tr_b16 v[120:121], v231 offset:61440
    v_mfma_f32_32x32x16_bf16 v[180:195], v[48:51], v[44:47], v[180:195]
    ds_read_b64_tr_b16 v[122:123], v231 offset:62464
    ds_read_b128 v[124:127], v230 offset:56320
    ds_read_b64_tr_b16 v[128:129], v231 offset:63488
    ds_read_b64_tr_b16 v[130:131], v231 offset:64512
    v_mfma_f32_32x32x16_bf16 v[164:179], v[56:59], v[52:55], v[164:179]
    v_mfma_f32_32x32x16_bf16 v[180:195], v[64:67], v[60:63], v[180:195]
    s_waitcnt lgkmcnt(0)
    v_mfma_f32_32x32x16_bf16 v[164:179], v[72:75], v[68:71], v[164:179]
    v_mfma_f32_32x32x16_bf16 v[180:195], v[80:83], v[76:79], v[180:195]
    v_mfma_f32_32x32x16_bf16 v[164:179], v[88:91], v[84:87], v[164:179]
    v_mfma_f32_32x32x16_bf16 v[180:195], v[96:99], v[92:95], v[180:195]
    v_mfma_f32_32x32x16_bf16 v[164:179], v[104:107], v[100:103], v[164:179]
    v_mfma_f32_32x32x16_bf16 v[180:195], v[112:115], v[108:111], v[180:195]
    v_mfma_f32_32x32x16_bf16 v[164:179], v[120:123], v[116:119], v[164:179]
    v_mfma_f32_32x32x16_bf16 v[180:195], v[128:131], v[124:127], v[180:195]
    s_nop 7
    s_nop 3
    v_pk_add_f32 v[164:165], v[164:165], v[180:181]
    v_pk_add_f32 v[166:167], v[166:167], v[182:183]
    v_pk_add_f32 v[168:169], v[168:169], v[184:185]
    v_pk_add_f32 v[170:171], v[170:171], v[186:187]
    v_pk_add_f32 v[172:173], v[172:173], v[188:189]
    v_pk_add_f32 v[174:175], v[174:175], v[190:191]
    v_pk_add_f32 v[176:177], v[176:177], v[192:193]
    v_pk_add_f32 v[178:179], v[178:179], v[194:195]
    v_cvt_pk_bf16_f32 v4, v164, v165
    v_cvt_pk_bf16_f32 v5, v166, v167
    v_cvt_pk_bf16_f32 v6, v168, v169
    v_cvt_pk_bf16_f32 v7, v170, v171
    v_cvt_pk_bf16_f32 v8, v172, v173
    v_cvt_pk_bf16_f32 v9, v174, v175
    v_cvt_pk_bf16_f32 v10, v176, v177
    v_cvt_pk_bf16_f32 v11, v178, v179
    v_lshlrev_b32 v164, 16, v4
    v_and_b32 v165, 0xffff0000, v4
    v_lshlrev_b32 v166, 16, v5
    v_and_b32 v167, 0xffff0000, v5
    v_lshlrev_b32 v168, 16, v6
    v_and_b32 v169, 0xffff0000, v6
    v_lshlrev_b32 v170, 16, v7
    v_and_b32 v171, 0xffff0000, v7
    v_lshlrev_b32 v172, 16, v8
    v_and_b32 v173, 0xffff0000, v8
    v_lshlrev_b32 v174, 16, v9
    v_and_b32 v175, 0xffff0000, v9
    v_lshlrev_b32 v176, 16, v10
    v_and_b32 v177, 0xffff0000, v10
    v_lshlrev_b32 v178, 16, v11
    v_and_b32 v179, 0xffff0000, v11
    v_lshlrev_b32 v180, 16, v212
    v_and_b32 v181, 0xffff0000, v212
    v_lshlrev_b32 v182, 16, v213
    v_and_b32 v183, 0xffff0000, v213
    v_lshlrev_b32 v184, 16, v214
    v_and_b32 v185, 0xffff0000, v214
    v_lshlrev_b32 v186, 16, v215
    v_and_b32 v187, 0xffff0000, v215
    v_lshlrev_b32 v188, 16, v216
    v_and_b32 v189, 0xffff0000, v216
    v_lshlrev_b32 v190, 16, v217
    v_and_b32 v191, 0xffff0000, v217
    v_lshlrev_b32 v192, 16, v218
    v_and_b32 v193, 0xffff0000, v218
    v_lshlrev_b32 v194, 16, v219
    v_and_b32 v195, 0xffff0000, v219
    s_barrier
    ds_read_b128 v[4:7], v230 offset:0
    ds_read_b64_tr_b16 v[8:9], v231 offset:0
    ds_read_b64_tr_b16 v[10:11], v231 offset:1024
    ds_read_b128 v[12:15], v230 offset:1024
    ds_read_b64_tr_b16 v[16:17], v231 offset:2048
    ds_read_b64_tr_b16 v[18:19], v231 offset:3072
    ds_read_b128 v[20:23], v230 offset:2048
    ds_read_b64_tr_b16 v[24:25], v231 offset:4096
    ds_read_b64_tr_b16 v[26:27], v231 offset:5120
    ds_read_b128 v[28:31], v230 offset:3072
    ds_read_b64_tr_b16 v[32:33], v231 offset:6144
    ds_read_b64_tr_b16 v[34:35], v231 offset:7168
    ds_read_b128 v[36:39], v230 offset:4096
    ds_read_b64_tr_b16 v[40:41], v231 offset:8192
    ds_read_b64_tr_b16 v[42:43], v231 offset:9216
    ds_read_b128 v[44:47], v230 offset:5120
    ds_read_b64_tr_b16 v[48:49], v231 offset:10240
    ds_read_b64_tr_b16 v[50:51], v231 offset:11264
    ds_read_b128 v[52:55], v230 offset:6144
    ds_read_b64_tr_b16 v[56:57], v231 offset:12288
    ds_read_b64_tr_b16 v[58:59], v231 offset:13312
    ds_read_b128 v[60:63], v230 offset:7168
    ds_read_b64_tr_b16 v[64:65], v231 offset:14336
    ds_read_b64_tr_b16 v[66:67], v231 offset:15360
    s_waitcnt lgkmcnt(0)
    s_barrier
    v_mfma_f32_32x32x16_bf16 v[132:147], v[8:11], v[4:7], v[132:147]
    ds_read_b128 v[68:71], v230 offset:16384
    ds_read_b64_tr_b16 v[72:73], v231 offset:16384
    ds_read_b64_tr_b16 v[74:75], v231 offset:17408
    ds_read_b128 v[76:79], v230 offset:17408
    v_mfma_f32_32x32x16_bf16 v[148:163], v[16:19], v[12:15], v[148:163]
    ds_read_b64_tr_b16 v[80:81], v231 offset:18432
    ds_read_b64_tr_b16 v[82:83], v231 offset:19456
    ds_read_b128 v[84:87], v230 offset:18432
    ds_read_b64_tr_b16 v[88:89], v231 offset:20480
    v_mfma_f32_32x32x16_bf16 v[132:147], v[24:27], v[20:23], v[132:147]
    ds_read_b64_tr_b16 v[90:91], v231 offset:21504
    ds_read_b128 v[92:95], v230 offset:19456
    ds_read_b64_tr_b16 v[96:97], v231 offset:22528
    ds_read_b64_tr_b16 v[98:99], v231 offset:23552
    v_mfma_f32_32x32x16_bf16 v[148:163], v[32:35], v[28:31], v[148:163]
    ds_read_b128 v[100:103], v230 offset:20480
    ds_read_b64_tr_b16 v[104:105], v231 offset:24576
    ds_read_b64_tr_b16 v[106:107], v231 offset:25600
    ds_read_b128 v[108:111], v230 offset:21504
    v_mfma_f32_32x32x16_bf16 v[132:147], v[40:43], v[36:39], v[132:147]
    ds_read_b64_tr_b16 v[112:113], v231 offset:26624
    ds_read_b64_tr_b16 v[114:115], v231 offset:27648
    ds_read_b128 v[116:119], v230 offset:22528
    ds_read_b64_tr_b16 v[120:121], v231 offset:28672
    v_mfma_f32_32x32x16_bf16 v[148:163], v[48:51], v[44:47], v[148:163]
    ds_read_b64_tr_b16 v[122:123], v231 offset:29696
    ds_read_b128 v[124:127], v230 offset:23552
    ds_read_b64_tr_b16 v[128:129], v231 offset:30720
    ds_read_b64_tr_b16 v[130:131], v231 offset:31744
    v_mfma_f32_32x32x16_bf16 v[132:147], v[56:59], v[52:55], v[132:147]
    v_mfma_f32_32x32x16_bf16 v[148:163], v[64:67], v[60:63], v[148:163]
    s_waitcnt lgkmcnt(0)
    s_barrier
    v_mfma_f32_32x32x16_bf16 v[132:147], v[72:75], v[68:71], v[132:147]
    ds_read_b128 v[4:7], v230 offset:32768
    ds_read_b64_tr_b16 v[8:9], v231 offset:32768
    ds_read_b64_tr_b16 v[10:11], v231 offset:33792
    ds_read_b128 v[12:15], v230 offset:33792
    v_mfma_f32_32x32x16_bf16 v[148:163], v[80:83], v[76:79], v[148:163]
    ds_read_b64_tr_b16 v[16:17], v231 offset:34816
    ds_read_b64_tr_b16 v[18:19], v231 offset:35840
    ds_read_b128 v[20:23], v230 offset:34816
    ds_read_b64_tr_b16 v[24:25], v231 offset:36864
    v_mfma_f32_32x32x16_bf16 v[132:147], v[88:91], v[84:87], v[132:147]
    ds_read_b64_tr_b16 v[26:27], v231 offset:37888
    ds_read_b128 v[28:31], v230 offset:35840
    ds_read_b64_tr_b16 v[32:33], v231 offset:38912
    ds_read_b64_tr_b16 v[34:35], v231 offset:39936
    v_mfma_f32_32x32x16_bf16 v[148:163], v[96:99], v[92:95], v[148:163]
    ds_read_b128 v[36:39], v230 offset:36864
    ds_read_b64_tr_b16 v[40:41], v231 offset:40960
    ds_read_b64_tr_b16 v[42:43], v231 offset:41984
    ds_read_b128 v[44:47], v230 offset:37888
    v_mfma_f32_32x32x16_bf16 v[132:147], v[104:107], v[100:103], v[132:147]
    ds_read_b64_tr_b16 v[48:49], v231 offset:43008
    ds_read_b64_tr_b16 v[50:51], v231 offset:44032
    ds_read_b128 v[52:55], v230 offset:38912
    ds_read_b64_tr_b16 v[56:57], v231 offset:45056
    v_mfma_f32_32x32x16_bf16 v[148:163], v[112:115], v[108:111], v[148:163]
    ds_read_b64_tr_b16 v[58:59], v231 offset:46080
    ds_read_b128 v[60:63], v230 offset:39936
    ds_read_b64_tr_b16 v[64:65], v231 offset:47104
    ds_read_b64_tr_b16 v[66:67], v231 offset:48128
    v_mfma_f32_32x32x16_bf16 v[132:147], v[120:123], v[116:119], v[132:147]
    v_mfma_f32_32x32x16_bf16 v[148:163], v[128:131], v[124:127], v[148:163]
    s_waitcnt lgkmcnt(0)
    s_barrier
    v_mfma_f32_32x32x16_bf16 v[132:147], v[8:11], v[4:7], v[132:147]
    ds_read_b128 v[68:71], v230 offset:49152
    ds_read_b64_tr_b16 v[72:73], v231 offset:49152
    ds_read_b64_tr_b16 v[74:75], v231 offset:50176
    ds_read_b128 v[76:79], v230 offset:50176
    v_mfma_f32_32x32x16_bf16 v[148:163], v[16:19], v[12:15], v[148:163]
    ds_read_b64_tr_b16 v[80:81], v231 offset:51200
    ds_read_b64_tr_b16 v[82:83], v231 offset:52224
    ds_read_b128 v[84:87], v230 offset:51200
    ds_read_b64_tr_b16 v[88:89], v231 offset:53248
    v_mfma_f32_32x32x16_bf16 v[132:147], v[24:27], v[20:23], v[132:147]
    ds_read_b64_tr_b16 v[90:91], v231 offset:54272
    ds_read_b128 v[92:95], v230 offset:52224
    ds_read_b64_tr_b16 v[96:97], v231 offset:55296
    ds_read_b64_tr_b16 v[98:99], v231 offset:56320
    v_mfma_f32_32x32x16_bf16 v[148:163], v[32:35], v[28:31], v[148:163]
    ds_read_b128 v[100:103], v230 offset:53248
    ds_read_b64_tr_b16 v[104:105], v231 offset:57344
    ds_read_b64_tr_b16 v[106:107], v231 offset:58368
    ds_read_b128 v[108:111], v230 offset:54272
    v_mfma_f32_32x32x16_bf16 v[132:147], v[40:43], v[36:39], v[132:147]
    ds_read_b64_tr_b16 v[112:113], v231 offset:59392
    ds_read_b64_tr_b16 v[114:115], v231 offset:60416
    ds_read_b128 v[116:119], v230 offset:55296
    ds_read_b64_tr_b16 v[120:121], v231 offset:61440
    v_mfma_f32_32x32x16_bf16 v[148:163], v[48:51], v[44:47], v[148:163]
    ds_read_b64_tr_b16 v[122:123], v231 offset:62464
    ds_read_b128 v[124:127], v230 offset:56320
    ds_read_b64_tr_b16 v[128:129], v231 offset:63488
    ds_read_b64_tr_b16 v[130:131], v231 offset:64512
    v_mfma_f32_32x32x16_bf16 v[132:147], v[56:59], v[52:55], v[132:147]
    v_mfma_f32_32x32x16_bf16 v[148:163], v[64:67], v[60:63], v[148:163]
    s_waitcnt lgkmcnt(0)
    s_barrier
    v_mfma_f32_32x32x16_bf16 v[132:147], v[72:75], v[68:71], v[132:147]
    ds_read_b128 v[4:7], v230 offset:0
    ds_read_b64_tr_b16 v[8:9], v231 offset:0
    ds_read_b64_tr_b16 v[10:11], v231 offset:1024
    ds_read_b128 v[12:15], v230 offset:1024
    v_mfma_f32_32x32x16_bf16 v[148:163], v[80:83], v[76:79], v[148:163]
    ds_read_b64_tr_b16 v[16:17], v231 offset:2048
    ds_read_b64_tr_b16 v[18:19], v231 offset:3072
    ds_read_b128 v[20:23], v230 offset:2048
    ds_read_b64_tr_b16 v[24:25], v231 offset:4096
    v_mfma_f32_32x32x16_bf16 v[132:147], v[88:91], v[84:87], v[132:147]
    ds_read_b64_tr_b16 v[26:27], v231 offset:5120
    ds_read_b128 v[28:31], v230 offset:3072
    ds_read_b64_tr_b16 v[32:33], v231 offset:6144
    ds_read_b64_tr_b16 v[34:35], v231 offset:7168
    v_mfma_f32_32x32x16_bf16 v[148:163], v[96:99], v[92:95], v[148:163]
    ds_read_b128 v[36:39], v230 offset:4096
    ds_read_b64_tr_b16 v[40:41], v231 offset:8192
    ds_read_b64_tr_b16 v[42:43], v231 offset:9216
    ds_read_b128 v[44:47], v230 offset:5120
    v_mfma_f32_32x32x16_bf16 v[132:147], v[104:107], v[100:103], v[132:147]
    ds_read_b64_tr_b16 v[48:49], v231 offset:10240
    ds_read_b64_tr_b16 v[50:51], v231 offset:11264
    ds_read_b128 v[52:55], v230 offset:6144
    ds_read_b64_tr_b16 v[56:57], v231 offset:12288
    v_mfma_f32_32x32x16_bf16 v[148:163], v[112:115], v[108:111], v[148:163]
    ds_read_b64_tr_b16 v[58:59], v231 offset:13312
    ds_read_b128 v[60:63], v230 offset:7168
    ds_read_b64_tr_b16 v[64:65], v231 offset:14336
    ds_read_b64_tr_b16 v[66:67], v231 offset:15360
    v_mfma_f32_32x32x16_bf16 v[132:147], v[120:123], v[116:119], v[132:147]
    v_mfma_f32_32x32x16_bf16 v[148:163], v[128:131], v[124:127], v[148:163]
    s_waitcnt lgkmcnt(0)
    s_barrier
    v_mfma_f32_32x32x16_bf16 v[132:147], v[8:11], v[4:7], v[132:147]
    ds_read_b128 v[68:71], v230 offset:16384
    ds_read_b64_tr_b16 v[72:73], v231 offset:16384
    ds_read_b64_tr_b16 v[74:75], v231 offset:17408
    ds_read_b128 v[76:79], v230 offset:17408
    v_mfma_f32_32x32x16_bf16 v[148:163], v[16:19], v[12:15], v[148:163]
    ds_read_b64_tr_b16 v[80:81], v231 offset:18432
    ds_read_b64_tr_b16 v[82:83], v231 offset:19456
    ds_read_b128 v[84:87], v230 offset:18432
    ds_read_b64_tr_b16 v[88:89], v231 offset:20480
    v_mfma_f32_32x32x16_bf16 v[132:147], v[24:27], v[20:23], v[132:147]
    ds_read_b64_tr_b16 v[90:91], v231 offset:21504
    ds_read_b128 v[92:95], v230 offset:19456
    ds_read_b64_tr_b16 v[96:97], v231 offset:22528
    ds_read_b64_tr_b16 v[98:99], v231 offset:23552
    v_mfma_f32_32x32x16_bf16 v[148:163], v[32:35], v[28:31], v[148:163]
    ds_read_b128 v[100:103], v230 offset:20480
    ds_read_b64_tr_b16 v[104:105], v231 offset:24576
    ds_read_b64_tr_b16 v[106:107], v231 offset:25600
    ds_read_b128 v[108:111], v230 offset:21504
    v_mfma_f32_32x32x16_bf16 v[132:147], v[40:43], v[36:39], v[132:147]
    ds_read_b64_tr_b16 v[112:113], v231 offset:26624
    ds_read_b64_tr_b16 v[114:115], v231 offset:27648
    ds_read_b128 v[116:119], v230 offset:22528
    ds_read_b64_tr_b16 v[120:121], v231 offset:28672
    v_mfma_f32_32x32x16_bf16 v[148:163], v[48:51], v[44:47], v[148:163]
    ds_read_b64_tr_b16 v[122:123], v231 offset:29696
    ds_read_b128 v[124:127], v230 offset:23552
    ds_read_b64_tr_b16 v[128:129], v231 offset:30720
    ds_read_b64_tr_b16 v[130:131], v231 offset:31744
    v_mfma_f32_32x32x16_bf16 v[132:147], v[56:59], v[52:55], v[132:147]
    v_mfma_f32_32x32x16_bf16 v[148:163], v[64:67], v[60:63], v[148:163]
    s_waitcnt lgkmcnt(0)
    s_barrier
    v_mfma_f32_32x32x16_bf16 v[132:147], v[72:75], v[68:71], v[132:147]
    ds_read_b128 v[4:7], v230 offset:32768
    ds_read_b64_tr_b16 v[8:9], v231 offset:32768
    ds_read_b64_tr_b16 v[10:11], v231 offset:33792
    ds_read_b128 v[12:15], v230 offset:33792
    v_mfma_f32_32x32x16_bf16 v[148:163], v[80:83], v[76:79], v[148:163]
    ds_read_b64_tr_b16 v[16:17], v231 offset:34816
    ds_read_b64_tr_b16 v[18:19], v231 offset:35840
    ds_read_b128 v[20:23], v230 offset:34816
    ds_read_b64_tr_b16 v[24:25], v231 offset:36864
    v_mfma_f32_32x32x16_bf16 v[132:147], v[88:91], v[84:87], v[132:147]
    ds_read_b64_tr_b16 v[26:27], v231 offset:37888
    ds_read_b128 v[28:31], v230 offset:35840
    ds_read_b64_tr_b16 v[32:33], v231 offset:38912
    ds_read_b64_tr_b16 v[34:35], v231 offset:39936
    v_mfma_f32_32x32x16_bf16 v[148:163], v[96:99], v[92:95], v[148:163]
    ds_read_b128 v[36:39], v230 offset:36864
    ds_read_b64_tr_b16 v[40:41], v231 offset:40960
    ds_read_b64_tr_b16 v[42:43], v231 offset:41984
    ds_read_b128 v[44:47], v230 offset:37888
    v_mfma_f32_32x32x16_bf16 v[132:147], v[104:107], v[100:103], v[132:147]
    ds_read_b64_tr_b16 v[48:49], v231 offset:43008
    ds_read_b64_tr_b16 v[50:51], v231 offset:44032
    ds_read_b128 v[52:55], v230 offset:38912
    ds_read_b64_tr_b16 v[56:57], v231 offset:45056
    v_mfma_f32_32x32x16_bf16 v[148:163], v[112:115], v[108:111], v[148:163]
    ds_read_b64_tr_b16 v[58:59], v231 offset:46080
    ds_read_b128 v[60:63], v230 offset:39936
    ds_read_b64_tr_b16 v[64:65], v231 offset:47104
    ds_read_b64_tr_b16 v[66:67], v231 offset:48128
    v_mfma_f32_32x32x16_bf16 v[132:147], v[120:123], v[116:119], v[132:147]
    v_mfma_f32_32x32x16_bf16 v[148:163], v[128:131], v[124:127], v[148:163]
    s_waitcnt lgkmcnt(0)
    s_barrier
    v_mfma_f32_32x32x16_bf16 v[132:147], v[8:11], v[4:7], v[132:147]
    ds_read_b128 v[68:71], v230 offset:49152
    ds_read_b64_tr_b16 v[72:73], v231 offset:49152
    ds_read_b64_tr_b16 v[74:75], v231 offset:50176
    ds_read_b128 v[76:79], v230 offset:50176
    v_mfma_f32_32x32x16_bf16 v[148:163], v[16:19], v[12:15], v[148:163]
    ds_read_b64_tr_b16 v[80:81], v231 offset:51200
    ds_read_b64_tr_b16 v[82:83], v231 offset:52224
    ds_read_b128 v[84:87], v230 offset:51200
    ds_read_b64_tr_b16 v[88:89], v231 offset:53248
    v_mfma_f32_32x32x16_bf16 v[132:147], v[24:27], v[20:23], v[132:147]
    ds_read_b64_tr_b16 v[90:91], v231 offset:54272
    ds_read_b128 v[92:95], v230 offset:52224
    ds_read_b64_tr_b16 v[96:97], v231 offset:55296
    ds_read_b64_tr_b16 v[98:99], v231 offset:56320
    v_mfma_f32_32x32x16_bf16 v[148:163], v[32:35], v[28:31], v[148:163]
    ds_read_b128 v[100:103], v230 offset:53248
    ds_read_b64_tr_b16 v[104:105], v231 offset:57344
    ds_read_b64_tr_b16 v[106:107], v231 offset:58368
    ds_read_b128 v[108:111], v230 offset:54272
    v_mfma_f32_32x32x16_bf16 v[132:147], v[40:43], v[36:39], v[132:147]
    ds_read_b64_tr_b16 v[112:113], v231 offset:59392
    ds_read_b64_tr_b16 v[114:115], v231 offset:60416
    ds_read_b128 v[116:119], v230 offset:55296
    ds_read_b64_tr_b16 v[120:121], v231 offset:61440
    v_mfma_f32_32x32x16_bf16 v[148:163], v[48:51], v[44:47], v[148:163]
    ds_read_b64_tr_b16 v[122:123], v231 offset:62464
    ds_read_b128 v[124:127], v230 offset:56320
    ds_read_b64_tr_b16 v[128:129], v231 offset:63488
    ds_read_b64_tr_b16 v[130:131], v231 offset:64512
    v_mfma_f32_32x32x16_bf16 v[132:147], v[56:59], v[52:55], v[132:147]
    v_mfma_f32_32x32x16_bf16 v[148:163], v[64:67], v[60:63], v[148:163]
    s_waitcnt lgkmcnt(0)
    s_barrier
    v_mfma_f32_32x32x16_bf16 v[132:147], v[72:75], v[68:71], v[132:147]
    ds_read_b128 v[4:7], v230 offset:0
    ds_read_b64_tr_b16 v[8:9], v231 offset:0
    ds_read_b64_tr_b16 v[10:11], v231 offset:1024
    ds_read_b128 v[12:15], v230 offset:1024
    v_mfma_f32_32x32x16_bf16 v[148:163], v[80:83], v[76:79], v[148:163]
    ds_read_b64_tr_b16 v[16:17], v231 offset:2048
    ds_read_b64_tr_b16 v[18:19], v231 offset:3072
    ds_read_b128 v[20:23], v230 offset:2048
    ds_read_b64_tr_b16 v[24:25], v231 offset:4096
    v_mfma_f32_32x32x16_bf16 v[132:147], v[88:91], v[84:87], v[132:147]
    ds_read_b64_tr_b16 v[26:27], v231 offset:5120
    ds_read_b128 v[28:31], v230 offset:3072
    ds_read_b64_tr_b16 v[32:33], v231 offset:6144
    ds_read_b64_tr_b16 v[34:35], v231 offset:7168
    v_mfma_f32_32x32x16_bf16 v[148:163], v[96:99], v[92:95], v[148:163]
    ds_read_b128 v[36:39], v230 offset:4096
    ds_read_b64_tr_b16 v[40:41], v231 offset:8192
    ds_read_b64_tr_b16 v[42:43], v231 offset:9216
    ds_read_b128 v[44:47], v230 offset:5120
    v_mfma_f32_32x32x16_bf16 v[132:147], v[104:107], v[100:103], v[132:147]
    ds_read_b64_tr_b16 v[48:49], v231 offset:10240
    ds_read_b64_tr_b16 v[50:51], v231 offset:11264
    ds_read_b128 v[52:55], v230 offset:6144
    ds_read_b64_tr_b16 v[56:57], v231 offset:12288
    v_mfma_f32_32x32x16_bf16 v[148:163], v[112:115], v[108:111], v[148:163]
    ds_read_b64_tr_b16 v[58:59], v231 offset:13312
    ds_read_b128 v[60:63], v230 offset:7168
    ds_read_b64_tr_b16 v[64:65], v231 offset:14336
    ds_read_b64_tr_b16 v[66:67], v231 offset:15360
    v_mfma_f32_32x32x16_bf16 v[132:147], v[120:123], v[116:119], v[132:147]
    v_mfma_f32_32x32x16_bf16 v[148:163], v[128:131], v[124:127], v[148:163]
    s_waitcnt lgkmcnt(0)
    s_barrier
    v_mfma_f32_32x32x16_bf16 v[132:147], v[8:11], v[4:7], v[132:147]
    ds_read_b128 v[68:71], v230 offset:16384
    ds_read_b64_tr_b16 v[72:73], v231 offset:16384
    ds_read_b64_tr_b16 v[74:75], v231 offset:17408
    ds_read_b128 v[76:79], v230 offset:17408
    v_mfma_f32_32x32x16_bf16 v[148:163], v[16:19], v[12:15], v[148:163]
    ds_read_b64_tr_b16 v[80:81], v231 offset:18432
    ds_read_b64_tr_b16 v[82:83], v231 offset:19456
    ds_read_b128 v[84:87], v230 offset:18432
    ds_read_b64_tr_b16 v[88:89], v231 offset:20480
    v_mfma_f32_32x32x16_bf16 v[132:147], v[24:27], v[20:23], v[132:147]
    ds_read_b64_tr_b16 v[90:91], v231 offset:21504
    ds_read_b128 v[92:95], v230 offset:19456
    ds_read_b64_tr_b16 v[96:97], v231 offset:22528
    ds_read_b64_tr_b16 v[98:99], v231 offset:23552
    v_mfma_f32_32x32x16_bf16 v[148:163], v[32:35], v[28:31], v[148:163]
    ds_read_b128 v[100:103], v230 offset:20480
    ds_read_b64_tr_b16 v[104:105], v231 offset:24576
    ds_read_b64_tr_b16 v[106:107], v231 offset:25600
    ds_read_b128 v[108:111], v230 offset:21504
    v_mfma_f32_32x32x16_bf16 v[132:147], v[40:43], v[36:39], v[132:147]
    ds_read_b64_tr_b16 v[112:113], v231 offset:26624
    ds_read_b64_tr_b16 v[114:115], v231 offset:27648
    ds_read_b128 v[116:119], v230 offset:22528
    ds_read_b64_tr_b16 v[120:121], v231 offset:28672
    v_mfma_f32_32x32x16_bf16 v[148:163], v[48:51], v[44:47], v[148:163]
    ds_read_b64_tr_b16 v[122:123], v231 offset:29696
    ds_read_b128 v[124:127], v230 offset:23552
    ds_read_b64_tr_b16 v[128:129], v231 offset:30720
    ds_read_b64_tr_b16 v[130:131], v231 offset:31744
    v_mfma_f32_32x32x16_bf16 v[132:147], v[56:59], v[52:55], v[132:147]
    v_mfma_f32_32x32x16_bf16 v[148:163], v[64:67], v[60:63], v[148:163]
    s_waitcnt lgkmcnt(0)
    s_barrier
    v_mfma_f32_32x32x16_bf16 v[132:147], v[72:75], v[68:71], v[132:147]
    ds_read_b128 v[4:7], v230 offset:32768
    ds_read_b64_tr_b16 v[8:9], v231 offset:32768
    ds_read_b64_tr_b16 v[10:11], v231 offset:33792
    ds_read_b128 v[12:15], v230 offset:33792
    v_mfma_f32_32x32x16_bf16 v[148:163], v[80:83], v[76:79], v[148:163]
    ds_read_b64_tr_b16 v[16:17], v231 offset:34816
    ds_read_b64_tr_b16 v[18:19], v231 offset:35840
    ds_read_b128 v[20:23], v230 offset:34816
    ds_read_b64_tr_b16 v[24:25], v231 offset:36864
    v_mfma_f32_32x32x16_bf16 v[132:147], v[88:91], v[84:87], v[132:147]
    ds_read_b64_tr_b16 v[26:27], v231 offset:37888
    ds_read_b128 v[28:31], v230 offset:35840
    ds_read_b64_tr_b16 v[32:33], v231 offset:38912
    ds_read_b64_tr_b16 v[34:35], v231 offset:39936
    v_mfma_f32_32x32x16_bf16 v[148:163], v[96:99], v[92:95], v[148:163]
    ds_read_b128 v[36:39], v230 offset:36864
    ds_read_b64_tr_b16 v[40:41], v231 offset:40960
    ds_read_b64_tr_b16 v[42:43], v231 offset:41984
    ds_read_b128 v[44:47], v230 offset:37888
    v_mfma_f32_32x32x16_bf16 v[132:147], v[104:107], v[100:103], v[132:147]
    ds_read_b64_tr_b16 v[48:49], v231 offset:43008
    ds_read_b64_tr_b16 v[50:51], v231 offset:44032
    ds_read_b128 v[52:55], v230 offset:38912
    ds_read_b64_tr_b16 v[56:57], v231 offset:45056
    v_mfma_f32_32x32x16_bf16 v[148:163], v[112:115], v[108:111], v[148:163]
    ds_read_b64_tr_b16 v[58:59], v231 offset:46080
    ds_read_b128 v[60:63], v230 offset:39936
    ds_read_b64_tr_b16 v[64:65], v231 offset:47104
    ds_read_b64_tr_b16 v[66:67], v231 offset:48128
    v_mfma_f32_32x32x16_bf16 v[132:147], v[120:123], v[116:119], v[132:147]
    v_mfma_f32_32x32x16_bf16 v[148:163], v[128:131], v[124:127], v[148:163]
    s_waitcnt lgkmcnt(0)
    s_barrier
    v_mfma_f32_32x32x16_bf16 v[132:147], v[8:11], v[4:7], v[132:147]
    ds_read_b128 v[68:71], v230 offset:49152
    ds_read_b64_tr_b16 v[72:73], v231 offset:49152
    ds_read_b64_tr_b16 v[74:75], v231 offset:50176
    ds_read_b128 v[76:79], v230 offset:50176
    v_mfma_f32_32x32x16_bf16 v[148:163], v[16:19], v[12:15], v[148:163]
    ds_read_b64_tr_b16 v[80:81], v231 offset:51200
    ds_read_b64_tr_b16 v[82:83], v231 offset:52224
    ds_read_b128 v[84:87], v230 offset:51200
    ds_read_b64_tr_b16 v[88:89], v231 offset:53248
    v_mfma_f32_32x32x16_bf16 v[132:147], v[24:27], v[20:23], v[132:147]
    ds_read_b64_tr_b16 v[90:91], v231 offset:54272
    ds_read_b128 v[92:95], v230 offset:52224
    ds_read_b64_tr_b16 v[96:97], v231 offset:55296
    ds_read_b64_tr_b16 v[98:99], v231 offset:56320
    v_mfma_f32_32x32x16_bf16 v[148:163], v[32:35], v[28:31], v[148:163]
    ds_read_b128 v[100:103], v230 offset:53248
    ds_read_b64_tr_b16 v[104:105], v231 offset:57344
    ds_read_b64_tr_b16 v[106:107], v231 offset:58368
    ds_read_b128 v[108:111], v230 offset:54272
    v_mfma_f32_32x32x16_bf16 v[132:147], v[40:43], v[36:39], v[132:147]
    ds_read_b64_tr_b16 v[112:113], v231 offset:59392
    ds_read_b64_tr_b16 v[114:115], v231 offset:60416
    ds_read_b128 v[116:119], v230 offset:55296
    ds_read_b64_tr_b16 v[120:121], v231 offset:61440
    v_mfma_f32_32x32x16_bf16 v[148:163], v[48:51], v[44:47], v[148:163]
    ds_read_b64_tr_b16 v[122:123], v231 offset:62464
    ds_read_b128 v[124:127], v230 offset:56320
    ds_read_b64_tr_b16 v[128:129], v231 offset:63488
    ds_read_b64_tr_b16 v[130:131], v231 offset:64512
    v_mfma_f32_32x32x16_bf16 v[132:147], v[56:59], v[52:55], v[132:147]
    v_mfma_f32_32x32x16_bf16 v[148:163], v[64:67], v[60:63], v[148:163]
    s_waitcnt lgkmcnt(0)
    s_barrier
    v_mfma_f32_32x32x16_bf16 v[132:147], v[72:75], v[68:71], v[132:147]
    ds_read_b128 v[4:7], v230 offset:0
    ds_read_b64_tr_b16 v[8:9], v231 offset:0
    ds_read_b64_tr_b16 v[10:11], v231 offset:1024
    ds_read_b128 v[12:15], v230 offset:1024
    v_mfma_f32_32x32x16_bf16 v[148:163], v[80:83], v[76:79], v[148:163]
    ds_read_b64_tr_b16 v[16:17], v231 offset:2048
    ds_read_b64_tr_b16 v[18:19], v231 offset:3072
    ds_read_b128 v[20:23], v230 offset:2048
    ds_read_b64_tr_b16 v[24:25], v231 offset:4096
    v_mfma_f32_32x32x16_bf16 v[132:147], v[88:91], v[84:87], v[132:147]
    ds_read_b64_tr_b16 v[26:27], v231 offset:5120
    ds_read_b128 v[28:31], v230 offset:3072
    ds_read_b64_tr_b16 v[32:33], v231 offset:6144
    ds_read_b64_tr_b16 v[34:35], v231 offset:7168
    v_mfma_f32_32x32x16_bf16 v[148:163], v[96:99], v[92:95], v[148:163]
    ds_read_b128 v[36:39], v230 offset:4096
    ds_read_b64_tr_b16 v[40:41], v231 offset:8192
    ds_read_b64_tr_b16 v[42:43], v231 offset:9216
    ds_read_b128 v[44:47], v230 offset:5120
    v_mfma_f32_32x32x16_bf16 v[132:147], v[104:107], v[100:103], v[132:147]
    ds_read_b64_tr_b16 v[48:49], v231 offset:10240
    ds_read_b64_tr_b16 v[50:51], v231 offset:11264
    ds_read_b128 v[52:55], v230 offset:6144
    ds_read_b64_tr_b16 v[56:57], v231 offset:12288
    v_mfma_f32_32x32x16_bf16 v[148:163], v[112:115], v[108:111], v[148:163]
    ds_read_b64_tr_b16 v[58:59], v231 offset:13312
    ds_read_b128 v[60:63], v230 offset:7168
    ds_read_b64_tr_b16 v[64:65], v231 offset:14336
    ds_read_b64_tr_b16 v[66:67], v231 offset:15360
    v_mfma_f32_32x32x16_bf16 v[132:147], v[120:123], v[116:119], v[132:147]
    v_mfma_f32_32x32x16_bf16 v[148:163], v[128:131], v[124:127], v[148:163]
    s_waitcnt lgkmcnt(0)
    s_barrier
    v_mfma_f32_32x32x16_bf16 v[132:147], v[8:11], v[4:7], v[132:147]
    ds_read_b128 v[68:71], v230 offset:16384
    ds_read_b64_tr_b16 v[72:73], v231 offset:16384
    ds_read_b64_tr_b16 v[74:75], v231 offset:17408
    ds_read_b128 v[76:79], v230 offset:17408
    v_mfma_f32_32x32x16_bf16 v[148:163], v[16:19], v[12:15], v[148:163]
    ds_read_b64_tr_b16 v[80:81], v231 offset:18432
    ds_read_b64_tr_b16 v[82:83], v231 offset:19456
    ds_read_b128 v[84:87], v230 offset:18432
    ds_read_b64_tr_b16 v[88:89], v231 offset:20480
    v_mfma_f32_32x32x16_bf16 v[132:147], v[24:27], v[20:23], v[132:147]
    ds_read_b64_tr_b16 v[90:91], v231 offset:21504
    ds_read_b128 v[92:95], v230 offset:19456
    ds_read_b64_tr_b16 v[96:97], v231 offset:22528
    ds_read_b64_tr_b16 v[98:99], v231 offset:23552
    v_mfma_f32_32x32x16_bf16 v[148:163], v[32:35], v[28:31], v[148:163]
    ds_read_b128 v[100:103], v230 offset:20480
    ds_read_b64_tr_b16 v[104:105], v231 offset:24576
    ds_read_b64_tr_b16 v[106:107], v231 offset:25600
    ds_read_b128 v[108:111], v230 offset:21504
    v_mfma_f32_32x32x16_bf16 v[132:147], v[40:43], v[36:39], v[132:147]
    ds_read_b64_tr_b16 v[112:113], v231 offset:26624
    ds_read_b64_tr_b16 v[114:115], v231 offset:27648
    ds_read_b128 v[116:119], v230 offset:22528
    ds_read_b64_tr_b16 v[120:121], v231 offset:28672
    v_mfma_f32_32x32x16_bf16 v[148:163], v[48:51], v[44:47], v[148:163]
    ds_read_b64_tr_b16 v[122:123], v231 offset:29696
    ds_read_b128 v[124:127], v230 offset:23552
    ds_read_b64_tr_b16 v[128:129], v231 offset:30720
    ds_read_b64_tr_b16 v[130:131], v231 offset:31744
    v_mfma_f32_32x32x16_bf16 v[132:147], v[56:59], v[52:55], v[132:147]
    v_mfma_f32_32x32x16_bf16 v[148:163], v[64:67], v[60:63], v[148:163]
    s_waitcnt lgkmcnt(0)
    v_mfma_f32_32x32x16_bf16 v[132:147], v[72:75], v[68:71], v[132:147]
    v_mfma_f32_32x32x16_bf16 v[148:163], v[80:83], v[76:79], v[148:163]
    v_mfma_f32_32x32x16_bf16 v[132:147], v[88:91], v[84:87], v[132:147]
    v_mfma_f32_32x32x16_bf16 v[148:163], v[96:99], v[92:95], v[148:163]
    v_mfma_f32_32x32x16_bf16 v[132:147], v[104:107], v[100:103], v[132:147]
    v_mfma_f32_32x32x16_bf16 v[148:163], v[112:115], v[108:111], v[148:163]
    v_mfma_f32_32x32x16_bf16 v[132:147], v[120:123], v[116:119], v[132:147]
    v_mfma_f32_32x32x16_bf16 v[148:163], v[128:131], v[124:127], v[148:163]
    s_nop 7
    s_nop 3
    v_pk_add_f32 v[132:133], v[132:133], v[148:149]
    v_pk_add_f32 v[134:135], v[134:135], v[150:151]
    v_pk_add_f32 v[136:137], v[136:137], v[152:153]
    v_pk_add_f32 v[138:139], v[138:139], v[154:155]
    v_pk_add_f32 v[140:141], v[140:141], v[156:157]
    v_pk_add_f32 v[142:143], v[142:143], v[158:159]
    v_pk_add_f32 v[144:145], v[144:145], v[160:161]
    v_pk_add_f32 v[146:147], v[146:147], v[162:163]
    v_cvt_pk_bf16_f32 v4, v132, v133
    v_cvt_pk_bf16_f32 v5, v134, v135
    v_cvt_pk_bf16_f32 v6, v136, v137
    v_cvt_pk_bf16_f32 v7, v138, v139
    v_cvt_pk_bf16_f32 v8, v140, v141
    v_cvt_pk_bf16_f32 v9, v142, v143
    v_cvt_pk_bf16_f32 v10, v144, v145
    v_cvt_pk_bf16_f32 v11, v146, v147
    v_lshlrev_b32 v132, 16, v4
    v_and_b32 v133, 0xffff0000, v4
    v_lshlrev_b32 v134, 16, v5
    v_and_b32 v135, 0xffff0000, v5
    v_lshlrev_b32 v136, 16, v6
    v_and_b32 v137, 0xffff0000, v6
    v_lshlrev_b32 v138, 16, v7
    v_and_b32 v139, 0xffff0000, v7
    v_lshlrev_b32 v140, 16, v8
    v_and_b32 v141, 0xffff0000, v8
    v_lshlrev_b32 v142, 16, v9
    v_and_b32 v143, 0xffff0000, v9
    v_lshlrev_b32 v144, 16, v10
    v_and_b32 v145, 0xffff0000, v10
    v_lshlrev_b32 v146, 16, v11
    v_and_b32 v147, 0xffff0000, v11
    v_pk_add_f32 v[132:133], v[132:133], v[180:181]
    v_pk_add_f32 v[134:135], v[134:135], v[182:183]
    v_pk_add_f32 v[136:137], v[136:137], v[184:185]
    v_pk_add_f32 v[138:139], v[138:139], v[186:187]
    v_pk_add_f32 v[140:141], v[140:141], v[188:189]
    v_pk_add_f32 v[142:143], v[142:143], v[190:191]
    v_pk_add_f32 v[144:145], v[144:145], v[192:193]
    v_pk_add_f32 v[146:147], v[146:147], v[194:195]
    v_cvt_pk_bf16_f32 v4, v132, v133
    v_cvt_pk_bf16_f32 v5, v134, v135
    v_cvt_pk_bf16_f32 v6, v136, v137
    v_cvt_pk_bf16_f32 v7, v138, v139
    v_cvt_pk_bf16_f32 v8, v140, v141
    v_cvt_pk_bf16_f32 v9, v142, v143
    v_cvt_pk_bf16_f32 v10, v144, v145
    v_cvt_pk_bf16_f32 v11, v146, v147
    v_lshlrev_b32 v132, 16, v4
    v_and_b32 v133, 0xffff0000, v4
    v_lshlrev_b32 v134, 16, v5
    v_and_b32 v135, 0xffff0000, v5
    v_lshlrev_b32 v136, 16, v6
    v_and_b32 v137, 0xffff0000, v6
    v_lshlrev_b32 v138, 16, v7
    v_and_b32 v139, 0xffff0000, v7
    v_lshlrev_b32 v140, 16, v8
    v_and_b32 v141, 0xffff0000, v8
    v_lshlrev_b32 v142, 16, v9
    v_and_b32 v143, 0xffff0000, v9
    v_lshlrev_b32 v144, 16, v10
    v_and_b32 v145, 0xffff0000, v10
    v_lshlrev_b32 v146, 16, v11
    v_and_b32 v147, 0xffff0000, v11
    v_pk_mul_f32 v[68:69], v[132:133], s[58:59]
    v_pk_mul_f32 v[70:71], v[134:135], s[58:59]
    v_pk_mul_f32 v[72:73], v[136:137], s[58:59]
    v_pk_mul_f32 v[74:75], v[138:139], s[58:59]
    v_pk_mul_f32 v[76:77], v[140:141], s[58:59]
    v_pk_mul_f32 v[78:79], v[142:143], s[58:59]
    v_pk_mul_f32 v[80:81], v[144:145], s[58:59]
    v_pk_mul_f32 v[82:83], v[146:147], s[58:59]
    v_exp_f32 v68, v68
    v_exp_f32 v69, v69
    v_exp_f32 v70, v70
    v_exp_f32 v71, v71
    v_exp_f32 v72, v72
    v_exp_f32 v73, v73
    v_exp_f32 v74, v74
    v_exp_f32 v75, v75
    v_exp_f32 v76, v76
    v_exp_f32 v77, v77
    v_exp_f32 v78, v78
    v_exp_f32 v79, v79
    v_exp_f32 v80, v80
    v_exp_f32 v81, v81
    v_exp_f32 v82, v82
    v_exp_f32 v83, v83
    v_pk_add_f32 v[68:69], v[68:69], s[60:61]
    v_pk_add_f32 v[70:71], v[70:71], s[60:61]
    v_pk_add_f32 v[72:73], v[72:73], s[60:61]
    v_pk_add_f32 v[74:75], v[74:75], s[60:61]
    v_pk_add_f32 v[76:77], v[76:77], s[60:61]
    v_pk_add_f32 v[78:79], v[78:79], s[60:61]
    v_pk_add_f32 v[80:81], v[80:81], s[60:61]
    v_pk_add_f32 v[82:83], v[82:83], s[60:61]
    v_rcp_f32 v68, v68
    v_rcp_f32 v69, v69
    v_rcp_f32 v70, v70
    v_rcp_f32 v71, v71
    v_rcp_f32 v72, v72
    v_rcp_f32 v73, v73
    v_rcp_f32 v74, v74
    v_rcp_f32 v75, v75
    v_rcp_f32 v76, v76
    v_rcp_f32 v77, v77
    v_rcp_f32 v78, v78
    v_rcp_f32 v79, v79
    v_rcp_f32 v80, v80
    v_rcp_f32 v81, v81
    v_rcp_f32 v82, v82
    v_rcp_f32 v83, v83
    v_lshlrev_b32 v148, 16, v196
    v_and_b32 v149, 0xffff0000, v196
    v_lshlrev_b32 v150, 16, v197
    v_and_b32 v151, 0xffff0000, v197
    v_lshlrev_b32 v152, 16, v200
    v_and_b32 v153, 0xffff0000, v200
    v_lshlrev_b32 v154, 16, v201
    v_and_b32 v155, 0xffff0000, v201
    v_lshlrev_b32 v156, 16, v198
    v_and_b32 v157, 0xffff0000, v198
    v_lshlrev_b32 v158, 16, v199
    v_and_b32 v159, 0xffff0000, v199
    v_lshlrev_b32 v160, 16, v202
    v_and_b32 v161, 0xffff0000, v202
    v_lshlrev_b32 v162, 16, v203
    v_and_b32 v163, 0xffff0000, v203
    v_pk_mul_f32 v[132:133], v[132:133], v[68:69]
    v_pk_mul_f32 v[134:135], v[134:135], v[70:71]
    v_pk_mul_f32 v[136:137], v[136:137], v[72:73]
    v_pk_mul_f32 v[138:139], v[138:139], v[74:75]
    v_pk_mul_f32 v[140:141], v[140:141], v[76:77]
    v_pk_mul_f32 v[142:143], v[142:143], v[78:79]
    v_pk_mul_f32 v[144:145], v[144:145], v[80:81]
    v_pk_mul_f32 v[146:147], v[146:147], v[82:83]
    v_cvt_pk_bf16_f32 v4, v132, v133
    v_cvt_pk_bf16_f32 v5, v134, v135
    v_cvt_pk_bf16_f32 v6, v136, v137
    v_cvt_pk_bf16_f32 v7, v138, v139
    v_cvt_pk_bf16_f32 v8, v140, v141
    v_cvt_pk_bf16_f32 v9, v142, v143
    v_cvt_pk_bf16_f32 v10, v144, v145
    v_cvt_pk_bf16_f32 v11, v146, v147
    v_lshlrev_b32 v132, 16, v4
    v_and_b32 v133, 0xffff0000, v4
    v_lshlrev_b32 v134, 16, v5
    v_and_b32 v135, 0xffff0000, v5
    v_lshlrev_b32 v136, 16, v6
    v_and_b32 v137, 0xffff0000, v6
    v_lshlrev_b32 v138, 16, v7
    v_and_b32 v139, 0xffff0000, v7
    v_lshlrev_b32 v140, 16, v8
    v_and_b32 v141, 0xffff0000, v8
    v_lshlrev_b32 v142, 16, v9
    v_and_b32 v143, 0xffff0000, v9
    v_lshlrev_b32 v144, 16, v10
    v_and_b32 v145, 0xffff0000, v10
    v_lshlrev_b32 v146, 16, v11
    v_and_b32 v147, 0xffff0000, v11
    v_pk_mul_f32 v[132:133], v[132:133], v[164:165]
    v_pk_mul_f32 v[134:135], v[134:135], v[166:167]
    v_pk_mul_f32 v[136:137], v[136:137], v[168:169]
    v_pk_mul_f32 v[138:139], v[138:139], v[170:171]
    v_pk_mul_f32 v[140:141], v[140:141], v[172:173]
    v_pk_mul_f32 v[142:143], v[142:143], v[174:175]
    v_pk_mul_f32 v[144:145], v[144:145], v[176:177]
    v_pk_mul_f32 v[146:147], v[146:147], v[178:179]
    v_cvt_pk_bf16_f32 v4, v132, v133
    v_cvt_pk_bf16_f32 v5, v134, v135
    v_cvt_pk_bf16_f32 v6, v136, v137
    v_cvt_pk_bf16_f32 v7, v138, v139
    v_cvt_pk_bf16_f32 v8, v140, v141
    v_cvt_pk_bf16_f32 v9, v142, v143
    v_cvt_pk_bf16_f32 v10, v144, v145
    v_cvt_pk_bf16_f32 v11, v146, v147
    v_lshlrev_b32 v132, 16, v4
    v_and_b32 v133, 0xffff0000, v4
    v_lshlrev_b32 v134, 16, v5
    v_and_b32 v135, 0xffff0000, v5
    v_lshlrev_b32 v136, 16, v6
    v_and_b32 v137, 0xffff0000, v6
    v_lshlrev_b32 v138, 16, v7
    v_and_b32 v139, 0xffff0000, v7
    v_lshlrev_b32 v140, 16, v8
    v_and_b32 v141, 0xffff0000, v8
    v_lshlrev_b32 v142, 16, v9
    v_and_b32 v143, 0xffff0000, v9
    v_lshlrev_b32 v144, 16, v10
    v_and_b32 v145, 0xffff0000, v10
    v_lshlrev_b32 v146, 16, v11
    v_and_b32 v147, 0xffff0000, v11
    v_pk_add_f32 v[132:133], v[132:133], v[148:149]
    v_pk_add_f32 v[134:135], v[134:135], v[150:151]
    v_pk_add_f32 v[136:137], v[136:137], v[152:153]
    v_pk_add_f32 v[138:139], v[138:139], v[154:155]
    v_pk_add_f32 v[140:141], v[140:141], v[156:157]
    v_pk_add_f32 v[142:143], v[142:143], v[158:159]
    v_pk_add_f32 v[144:145], v[144:145], v[160:161]
    v_pk_add_f32 v[146:147], v[146:147], v[162:163]
    v_cvt_pk_bf16_f32 v196, v132, v133
    v_cvt_pk_bf16_f32 v197, v134, v135
    v_cvt_pk_bf16_f32 v200, v136, v137
    v_cvt_pk_bf16_f32 v201, v138, v139
    v_cvt_pk_bf16_f32 v198, v140, v141
    v_cvt_pk_bf16_f32 v199, v142, v143
    v_cvt_pk_bf16_f32 v202, v144, v145
    v_cvt_pk_bf16_f32 v203, v146, v147
    v_permlane32_swap_b32 v196, v198
    v_permlane32_swap_b32 v200, v202
    v_permlane32_swap_b32 v197, v199
    v_permlane32_swap_b32 v201, v203
    buffer_store_dwordx4 v[196:199], v242, s[44:47], 0 offen
    buffer_store_dwordx4 v[200:203], v242, s[44:47], 0 offen offset:16
    s_endpgm
L_RX:
    s_mov_b32 s40, s4
    s_mov_b32 s41, s5
    s_mov_b32 s42, 0x200000
    s_mov_b32 s43, 0x20000
    v_lshrrev_b32 v6, 4, v1
    v_and_b32 v7, 15, v1
    s_lshl_b32 s44, s27, 16
    v_add_u32 v8, 0, v6
    v_xor_b32 v2, v8, v7
    v_lshlrev_b32 v2, 4, v2
    v_lshl_add_u32 v2, v8, 10, v2
    v_add_u32 v2, s44, v2
    v_add_u32 v8, 4, v6
    v_xor_b32 v3, v8, v7
    v_lshlrev_b32 v3, 4, v3
    v_lshl_add_u32 v3, v8, 10, v3
    v_add_u32 v3, s44, v3
    v_add_u32 v8, 8, v6
    v_xor_b32 v4, v8, v7
    v_lshlrev_b32 v4, 4, v4
    v_lshl_add_u32 v4, v8, 10, v4
    v_add_u32 v4, s44, v4
    v_add_u32 v8, 12, v6
    v_xor_b32 v5, v8, v7
    v_lshlrev_b32 v5, 4, v5
    v_lshl_add_u32 v5, v8, 10, v5
    v_add_u32 v5, s44, v5
    s_mov_b32 m0, 0
    s_mov_b32 s45, 0
    buffer_load_dwordx4 v2, s[40:43], s45 offen lds
    s_mov_b32 m0, 1024
    s_mov_b32 s45, 0
    buffer_load_dwordx4 v3, s[40:43], s45 offen lds
    s_mov_b32 m0, 2048
    s_mov_b32 s45, 0
    buffer_load_dwordx4 v4, s[40:43], s45 offen lds
    s_mov_b32 m0, 3072
    s_mov_b32 s45, 0
    buffer_load_dwordx4 v5, s[40:43], s45 offen lds
    s_mov_b32 m0, 4096
    s_mov_b32 s45, 16384
    buffer_load_dwordx4 v2, s[40:43], s45 offen lds
    s_mov_b32 m0, 5120
    s_mov_b32 s45, 16384
    buffer_load_dwordx4 v3, s[40:43], s45 offen lds
    s_mov_b32 m0, 6144
    s_mov_b32 s45, 16384
    buffer_load_dwordx4 v4, s[40:43], s45 offen lds
    s_mov_b32 m0, 7168
    s_mov_b32 s45, 16384
    buffer_load_dwordx4 v5, s[40:43], s45 offen lds
    s_mov_b32 m0, 8192
    s_mov_b32 s45, 32768
    buffer_load_dwordx4 v2, s[40:43], s45 offen lds
    s_mov_b32 m0, 9216
    s_mov_b32 s45, 32768
    buffer_load_dwordx4 v3, s[40:43], s45 offen lds
    s_mov_b32 m0, 10240
    s_mov_b32 s45, 32768
    buffer_load_dwordx4 v4, s[40:43], s45 offen lds
    s_mov_b32 m0, 11264
    s_mov_b32 s45, 32768
    buffer_load_dwordx4 v5, s[40:43], s45 offen lds
    s_mov_b32 m0, 12288
    s_mov_b32 s45, 49152
    buffer_load_dwordx4 v2, s[40:43], s45 offen lds
    s_mov_b32 m0, 13312
    s_mov_b32 s45, 49152
    buffer_load_dwordx4 v3, s[40:43], s45 offen lds
    s_mov_b32 m0, 14336
    s_mov_b32 s45, 49152
    buffer_load_dwordx4 v4, s[40:43], s45 offen lds
    s_mov_b32 m0, 15360
    s_mov_b32 s45, 49152
    buffer_load_dwordx4 v5, s[40:43], s45 offen lds
    s_mov_b32 m0, 16384
    s_mov_b32 s45, 256
    buffer_load_dwordx4 v2, s[40:43], s45 offen lds
    s_mov_b32 m0, 17408
    s_mov_b32 s45, 256
    buffer_load_dwordx4 v3, s[40:43], s45 offen lds
    s_mov_b32 m0, 18432
    s_mov_b32 s45, 256
    buffer_load_dwordx4 v4, s[40:43], s45 offen lds
    s_mov_b32 m0, 19456
    s_mov_b32 s45, 256
    buffer_load_dwordx4 v5, s[40:43], s45 offen lds
    s_mov_b32 m0, 20480
    s_mov_b32 s45, 16640
    buffer_load_dwordx4 v2, s[40:43], s45 offen lds
    s_mov_b32 m0, 21504
    s_mov_b32 s45, 16640
    buffer_load_dwordx4 v3, s[40:43], s45 offen lds
    s_mov_b32 m0, 22528
    s_mov_b32 s45, 16640
    buffer_load_dwordx4 v4, s[40:43], s45 offen lds
    s_mov_b32 m0, 23552
    s_mov_b32 s45, 16640
    buffer_load_dwordx4 v5, s[40:43], s45 offen lds
    s_mov_b32 m0, 24576
    s_mov_b32 s45, 33024
    buffer_load_dwordx4 v2, s[40:43], s45 offen lds
    s_mov_b32 m0, 25600
    s_mov_b32 s45, 33024
    buffer_load_dwordx4 v3, s[40:43], s45 offen lds
    s_mov_b32 m0, 26624
    s_mov_b32 s45, 33024
    buffer_load_dwordx4 v4, s[40:43], s45 offen lds
    s_mov_b32 m0, 27648
    s_mov_b32 s45, 33024
    buffer_load_dwordx4 v5, s[40:43], s45 offen lds
    s_mov_b32 m0, 28672
    s_mov_b32 s45, 49408
    buffer_load_dwordx4 v2, s[40:43], s45 offen lds
    s_mov_b32 m0, 29696
    s_mov_b32 s45, 49408
    buffer_load_dwordx4 v3, s[40:43], s45 offen lds
    s_mov_b32 m0, 30720
    s_mov_b32 s45, 49408
    buffer_load_dwordx4 v4, s[40:43], s45 offen lds
    s_mov_b32 m0, 31744
    s_mov_b32 s45, 49408
    buffer_load_dwordx4 v5, s[40:43], s45 offen lds
    s_mov_b32 m0, 32768
    s_mov_b32 s45, 512
    buffer_load_dwordx4 v2, s[40:43], s45 offen lds
    s_mov_b32 m0, 33792
    s_mov_b32 s45, 512
    buffer_load_dwordx4 v3, s[40:43], s45 offen lds
    s_mov_b32 m0, 34816
    s_mov_b32 s45, 512
    buffer_load_dwordx4 v4, s[40:43], s45 offen lds
    s_mov_b32 m0, 35840
    s_mov_b32 s45, 512
    buffer_load_dwordx4 v5, s[40:43], s45 offen lds
    s_mov_b32 m0, 36864
    s_mov_b32 s45, 16896
    buffer_load_dwordx4 v2, s[40:43], s45 offen lds
    s_mov_b32 m0, 37888
    s_mov_b32 s45, 16896
    buffer_load_dwordx4 v3, s[40:43], s45 offen lds
    s_mov_b32 m0, 38912
    s_mov_b32 s45, 16896
    buffer_load_dwordx4 v4, s[40:43], s45 offen lds
    s_mov_b32 m0, 39936
    s_mov_b32 s45, 16896
    buffer_load_dwordx4 v5, s[40:43], s45 offen lds
    s_mov_b32 m0, 40960
    s_mov_b32 s45, 33280
    buffer_load_dwordx4 v2, s[40:43], s45 offen lds
    s_mov_b32 m0, 41984
    s_mov_b32 s45, 33280
    buffer_load_dwordx4 v3, s[40:43], s45 offen lds
    s_mov_b32 m0, 43008
    s_mov_b32 s45, 33280
    buffer_load_dwordx4 v4, s[40:43], s45 offen lds
    s_mov_b32 m0, 44032
    s_mov_b32 s45, 33280
    buffer_load_dwordx4 v5, s[40:43], s45 offen lds
    s_mov_b32 m0, 45056
    s_mov_b32 s45, 49664
    buffer_load_dwordx4 v2, s[40:43], s45 offen lds
    s_mov_b32 m0, 46080
    s_mov_b32 s45, 49664
    buffer_load_dwordx4 v3, s[40:43], s45 offen lds
    s_mov_b32 m0, 47104
    s_mov_b32 s45, 49664
    buffer_load_dwordx4 v4, s[40:43], s45 offen lds
    s_mov_b32 m0, 48128
    s_mov_b32 s45, 49664
    buffer_load_dwordx4 v5, s[40:43], s45 offen lds
    s_mov_b32 s48, s22
    s_mov_b32 s49, s23
    s_mov_b32 s50, 0xfe0000
    s_mov_b32 s51, 0x20000
    s_add_u32 s52, s22, 0x200000
    s_addc_u32 s53, s23, 0
    s_mov_b32 s54, 0x200000
    s_mov_b32 s55, 0x20000
    s_lshl_b32 s44, s29, 17
    v_lshrrev_b32 v6, 4, v1
    v_add_u32 v6, 0, v6
    v_and_b32 v7, 7, v1
    v_xor_b32 v6, v6, v7
    v_lshlrev_b32 v6, 4, v6
    v_lshrrev_b32 v8, 3, v1
    v_add_u32 v8, 0, v8
    v_lshl_add_u32 v9, v8, 10, v6
    v_add_u32 v9, s44, v9
    v_lshrrev_b32 v6, 4, v1
    v_add_u32 v6, 4, v6
    v_and_b32 v7, 7, v1
    v_xor_b32 v6, v6, v7
    v_lshlrev_b32 v6, 4, v6
    v_lshrrev_b32 v8, 3, v1
    v_add_u32 v8, 8, v8
    v_lshl_add_u32 v10, v8, 10, v6
    v_add_u32 v10, s44, v10
    v_mov_b32 v19, 0x80000000
    s_lshl_b32 s44, s27, 6
    s_add_u32 s44, s44, 4294967295
    v_and_b32 v20, 31, v1
    v_add_u32 v20, s44, v20
    v_lshrrev_b32 v6, 5, v20
    v_lshlrev_b32 v6, 15, v6
    v_and_b32 v7, 31, v20
    v_lshl_add_u32 v6, v7, 4, v6
    v_lshrrev_b32 v7, 5, v1
    v_lshl_add_u32 v6, v7, 9, v6
    v_cmp_gt_u32 vcc, 2048, v20
    s_nop 1
    v_cndmask_b32 v11, v19, v6, vcc
    s_lshl_b32 s44, s27, 6
    s_add_u32 s44, s44, 31
    v_and_b32 v20, 31, v1
    v_add_u32 v20, s44, v20
    v_lshrrev_b32 v6, 5, v20
    v_lshlrev_b32 v6, 15, v6
    v_and_b32 v7, 31, v20
    v_lshl_add_u32 v6, v7, 4, v6
    v_lshrrev_b32 v7, 5, v1
    v_lshl_add_u32 v6, v7, 9, v6
    v_cmp_gt_u32 vcc, 2048, v20
    s_nop 1
    v_cndmask_b32 v12, v19, v6, vcc
    s_lshl_b32 s44, s27, 6
    s_add_u32 s44, s44, 1
    v_and_b32 v20, 31, v1
    v_add_u32 v20, s44, v20
    v_lshrrev_b32 v6, 5, v20
    v_lshlrev_b32 v6, 15, v6
    v_and_b32 v7, 31, v20
    v_lshl_add_u32 v6, v7, 4, v6
    v_lshrrev_b32 v7, 5, v1
    v_lshl_add_u32 v6, v7, 9, v6
    v_cmp_gt_u32 vcc, 2048, v20
    s_nop 1
    v_cndmask_b32 v13, v19, v6, vcc
    s_lshl_b32 s44, s27, 6
    s_add_u32 s44, s44, 33
    v_and_b32 v20, 31, v1
    v_add_u32 v20, s44, v20
    v_lshrrev_b32 v6, 5, v20
    v_lshlrev_b32 v6, 15, v6
    v_and_b32 v7, 31, v20
    v_lshl_add_u32 v6, v7, 4, v6
    v_lshrrev_b32 v7, 5, v1
    v_lshl_add_u32 v6, v7, 9, v6
    v_cmp_gt_u32 vcc, 2048, v20
    s_nop 1
    v_cndmask_b32 v14, v19, v6, vcc
    s_lshl_b32 s44, s27, 6
    s_add_u32 s44, s44, 4294967294
    v_and_b32 v20, 31, v1
    v_add_u32 v20, s44, v20
    v_lshrrev_b32 v6, 5, v20
    v_lshlrev_b32 v6, 15, v6
    v_and_b32 v7, 31, v20
    v_lshl_add_u32 v6, v7, 4, v6
    v_lshrrev_b32 v7, 5, v1
    v_lshl_add_u32 v6, v7, 9, v6
    v_cmp_gt_u32 vcc, 2048, v20
    s_nop 1
    v_cndmask_b32 v15, v19, v6, vcc
    s_lshl_b32 s44, s27, 6
    s_add_u32 s44, s44, 30
    v_and_b32 v20, 31, v1
    v_add_u32 v20, s44, v20
    v_lshrrev_b32 v6, 5, v20
    v_lshlrev_b32 v6, 15, v6
    v_and_b32 v7, 31, v20
    v_lshl_add_u32 v6, v7, 4, v6
    v_lshrrev_b32 v7, 5, v1
    v_lshl_add_u32 v6, v7, 9, v6
    v_cmp_gt_u32 vcc, 2048, v20
    s_nop 1
    v_cndmask_b32 v16, v19, v6, vcc
    s_lshl_b32 s44, s27, 6
    s_add_u32 s44, s44, 2
    v_and_b32 v20, 31, v1
    v_add_u32 v20, s44, v20
    v_lshrrev_b32 v6, 5, v20
    v_lshlrev_b32 v6, 15, v6
    v_and_b32 v7, 31, v20
    v_lshl_add_u32 v6, v7, 4, v6
    v_lshrrev_b32 v7, 5, v1
    v_lshl_add_u32 v6, v7, 9, v6
    v_cmp_gt_u32 vcc, 2048, v20
    s_nop 1
    v_cndmask_b32 v17, v19, v6, vcc
    s_lshl_b32 s44, s27, 6
    s_add_u32 s44, s44, 34
    v_and_b32 v20, 31, v1
    v_add_u32 v20, s44, v20
    v_lshrrev_b32 v6, 5, v20
    v_lshlrev_b32 v6, 15, v6
    v_and_b32 v7, 31, v20
    v_lshl_add_u32 v6, v7, 4, v6
    v_lshrrev_b32 v7, 5, v1
    v_lshl_add_u32 v6, v7, 9, v6
    v_cmp_gt_u32 vcc, 2048, v20
    s_nop 1
    v_cndmask_b32 v18, v19, v6, vcc
    v_lshlrev_b32 v21, 4, v1
    s_lshl_b32 s44, s27, 3
    s_sub_u32 s44, s44, 8
    v_min_u32 v22, 23, v1
    v_add_u32 v22, s44, v22
    v_max_i32 v22, 0, v22
    v_min_i32 v22, 255, v22
    v_lshlrev_b32 v22, 3, v22
    v_add_u32 v22, 0x0, v22
    s_lshl_b32 s44, s31, 4
    v_and_b32 v23, 31, v1
    v_min_u32 v23, 15, v23
    v_add_u32 v23, s44, v23
    v_lshlrev_b32 v23, 3, v23
    v_add_u32 v23, 0x1000, v23
    v_lshrrev_b32 v6, 5, v1
    v_xor_b32 v6, 1, v6
    v_mul_u32_u24 v6, 0x4000, v6
    v_add_u32 v23, v6, v23
    s_lshl_b32 s44, s29, 4
    v_and_b32 v24, 31, v1
    v_min_u32 v24, 15, v24
    v_add_u32 v24, s44, v24
    v_lshlrev_b32 v24, 3, v24
    v_add_u32 v24, 0x2000, v24
    v_lshrrev_b32 v6, 5, v1
    v_xor_b32 v6, 1, v6
    v_mul_u32_u24 v6, 0x4000, v6
    v_add_u32 v24, v6, v24
    s_lshl_b32 s44, s29, 4
    v_and_b32 v25, 31, v1
    v_min_u32 v25, 13, v25
    v_add_u32 v25, s44, v25
    v_lshlrev_b32 v25, 3, v25
    v_add_u32 v25, 0x1800, v25
    v_lshrrev_b32 v6, 5, v1
    v_xor_b32 v6, 1, v6
    v_mul_u32_u24 v6, 0x4000, v6
    v_add_u32 v25, v6, v25
    s_lshl_b32 s56, s31, 17
    s_add_u32 s56, s56, 0x400000
    s_lshl_b32 s57, s27, 16
    s_add_u32 s57, s57, 0xd00000
    s_mul_i32 s58, s27, 229376
    s_add_u32 s58, s58, 0x600000
    s_waitcnt lgkmcnt(0)
    s_add_u32 s34, s34, 1
    s_addc_u32 s35, s35, 0
    s_waitcnt vmcnt(32)
    s_barrier
    s_mov_b32 m0, 49152
    s_mov_b32 s45, 768
    buffer_load_dwordx4 v2, s[40:43], s45 offen lds
    s_mov_b32 m0, 50176
    s_mov_b32 s45, 768
    buffer_load_dwordx4 v3, s[40:43], s45 offen lds
    s_mov_b32 m0, 51200
    s_mov_b32 s45, 768
    buffer_load_dwordx4 v4, s[40:43], s45 offen lds
    s_mov_b32 m0, 52224
    s_mov_b32 s45, 768
    buffer_load_dwordx4 v5, s[40:43], s45 offen lds
    s_mov_b32 m0, 53248
    s_mov_b32 s45, 17152
    buffer_load_dwordx4 v2, s[40:43], s45 offen lds
    s_mov_b32 m0, 54272
    s_mov_b32 s45, 17152
    buffer_load_dwordx4 v3, s[40:43], s45 offen lds
    s_mov_b32 m0, 55296
    s_mov_b32 s45, 17152
    buffer_load_dwordx4 v4, s[40:43], s45 offen lds
    s_mov_b32 m0, 56320
    s_mov_b32 s45, 17152
    buffer_load_dwordx4 v5, s[40:43], s45 offen lds
    s_mov_b32 m0, 57344
    s_mov_b32 s45, 33536
    buffer_load_dwordx4 v2, s[40:43], s45 offen lds
    s_mov_b32 m0, 58368
    s_mov_b32 s45, 33536
    buffer_load_dwordx4 v3, s[40:43], s45 offen lds
    s_mov_b32 m0, 59392
    s_mov_b32 s45, 33536
    buffer_load_dwordx4 v4, s[40:43], s45 offen lds
    s_mov_b32 m0, 60416
    s_mov_b32 s45, 33536
    buffer_load_dwordx4 v5, s[40:43], s45 offen lds
    s_mov_b32 m0, 61440
    s_mov_b32 s45, 49920
    buffer_load_dwordx4 v2, s[40:43], s45 offen lds
    s_mov_b32 m0, 62464
    s_mov_b32 s45, 49920
    buffer_load_dwordx4 v3, s[40:43], s45 offen lds
    s_mov_b32 m0, 63488
    s_mov_b32 s45, 49920
    buffer_load_dwordx4 v4, s[40:43], s45 offen lds
    s_mov_b32 m0, 64512
    s_mov_b32 s45, 49920
    buffer_load_dwordx4 v5, s[40:43], s45 offen lds
    s_waitcnt vmcnt(32)
    s_barrier
    s_mov_b32 m0, 0
    s_mov_b32 s45, 0
    buffer_load_dwordx4 v9, s[40:43], s45 offen lds
    s_mov_b32 m0, 1024
    s_mov_b32 s45, 0
    buffer_load_dwordx4 v10, s[40:43], s45 offen lds
    s_mov_b32 m0, 2048
    s_mov_b32 s45, 16384
    buffer_load_dwordx4 v9, s[40:43], s45 offen lds
    s_mov_b32 m0, 3072
    s_mov_b32 s45, 16384
    buffer_load_dwordx4 v10, s[40:43], s45 offen lds
    s_mov_b32 m0, 4096
    s_mov_b32 s45, 32768
    buffer_load_dwordx4 v9, s[40:43], s45 offen lds
    s_mov_b32 m0, 5120
    s_mov_b32 s45, 32768
    buffer_load_dwordx4 v10, s[40:43], s45 offen lds
    s_mov_b32 m0, 6144
    s_mov_b32 s45, 49152
    buffer_load_dwordx4 v9, s[40:43], s45 offen lds
    s_mov_b32 m0, 7168
    s_mov_b32 s45, 49152
    buffer_load_dwordx4 v10, s[40:43], s45 offen lds
    s_mov_b32 m0, 8192
    s_mov_b32 s45, 65536
    buffer_load_dwordx4 v9, s[40:43], s45 offen lds
    s_mov_b32 m0, 9216
    s_mov_b32 s45, 65536
    buffer_load_dwordx4 v10, s[40:43], s45 offen lds
    s_mov_b32 m0, 10240
    s_mov_b32 s45, 81920
    buffer_load_dwordx4 v9, s[40:43], s45 offen lds
    s_mov_b32 m0, 11264
    s_mov_b32 s45, 81920
    buffer_load_dwordx4 v10, s[40:43], s45 offen lds
    s_mov_b32 m0, 12288
    s_mov_b32 s45, 98304
    buffer_load_dwordx4 v9, s[40:43], s45 offen lds
    s_mov_b32 m0, 13312
    s_mov_b32 s45, 98304
    buffer_load_dwordx4 v10, s[40:43], s45 offen lds
    s_mov_b32 m0, 14336
    s_mov_b32 s45, 114688
    buffer_load_dwordx4 v9, s[40:43], s45 offen lds
    s_mov_b32 m0, 15360
    s_mov_b32 s45, 114688
    buffer_load_dwordx4 v10, s[40:43], s45 offen lds
    s_waitcnt vmcnt(32)
    s_barrier
    s_mov_b32 m0, 16384
    s_mov_b32 s45, 128
    buffer_load_dwordx4 v9, s[40:43], s45 offen lds
    s_mov_b32 m0, 17408
    s_mov_b32 s45, 128
    buffer_load_dwordx4 v10, s[40:43], s45 offen lds
    s_mov_b32 m0, 18432
    s_mov_b32 s45, 16512
    buffer_load_dwordx4 v9, s[40:43], s45 offen lds
    s_mov_b32 m0, 19456
    s_mov_b32 s45, 16512
    buffer_load_dwordx4 v10, s[40:43], s45 offen lds
    s_mov_b32 m0, 20480
    s_mov_b32 s45, 32896
    buffer_load_dwordx4 v9, s[40:43], s45 offen lds
    s_mov_b32 m0, 21504
    s_mov_b32 s45, 32896
    buffer_load_dwordx4 v10, s[40:43], s45 offen lds
    s_mov_b32 m0, 22528
    s_mov_b32 s45, 49280
    buffer_load_dwordx4 v9, s[40:43], s45 offen lds
    s_mov_b32 m0, 23552
    s_mov_b32 s45, 49280
    buffer_load_dwordx4 v10, s[40:43], s45 offen lds
    s_mov_b32 m0, 24576
    s_mov_b32 s45, 65664
    buffer_load_dwordx4 v9, s[40:43], s45 offen lds
    s_mov_b32 m0, 25600
    s_mov_b32 s45, 65664
    buffer_load_dwordx4 v10, s[40:43], s45 offen lds
    s_mov_b32 m0, 26624
    s_mov_b32 s45, 82048
    buffer_load_dwordx4 v9, s[40:43], s45 offen lds
    s_mov_b32 m0, 27648
    s_mov_b32 s45, 82048
    buffer_load_dwordx4 v10, s[40:43], s45 offen lds
    s_mov_b32 m0, 28672
    s_mov_b32 s45, 98432
    buffer_load_dwordx4 v9, s[40:43], s45 offen lds
    s_mov_b32 m0, 29696
    s_mov_b32 s45, 98432
    buffer_load_dwordx4 v10, s[40:43], s45 offen lds
    s_mov_b32 m0, 30720
    s_mov_b32 s45, 114816
    buffer_load_dwordx4 v9, s[40:43], s45 offen lds
    s_mov_b32 m0, 31744
    s_mov_b32 s45, 114816
    buffer_load_dwordx4 v10, s[40:43], s45 offen lds
    s_waitcnt vmcnt(32)
    s_barrier
    s_mov_b32 m0, 32768
    s_mov_b32 s45, 256
    buffer_load_dwordx4 v9, s[40:43], s45 offen lds
    s_mov_b32 m0, 33792
    s_mov_b32 s45, 256
    buffer_load_dwordx4 v10, s[40:43], s45 offen lds
    s_mov_b32 m0, 34816
    s_mov_b32 s45, 16640
    buffer_load_dwordx4 v9, s[40:43], s45 offen lds
    s_mov_b32 m0, 35840
    s_mov_b32 s45, 16640
    buffer_load_dwordx4 v10, s[40:43], s45 offen lds
    s_mov_b32 m0, 36864
    s_mov_b32 s45, 33024
    buffer_load_dwordx4 v9, s[40:43], s45 offen lds
    s_mov_b32 m0, 37888
    s_mov_b32 s45, 33024
    buffer_load_dwordx4 v10, s[40:43], s45 offen lds
    s_mov_b32 m0, 38912
    s_mov_b32 s45, 49408
    buffer_load_dwordx4 v9, s[40:43], s45 offen lds
    s_mov_b32 m0, 39936
    s_mov_b32 s45, 49408
    buffer_load_dwordx4 v10, s[40:43], s45 offen lds
    s_mov_b32 m0, 40960
    s_mov_b32 s45, 65792
    buffer_load_dwordx4 v9, s[40:43], s45 offen lds
    s_mov_b32 m0, 41984
    s_mov_b32 s45, 65792
    buffer_load_dwordx4 v10, s[40:43], s45 offen lds
    s_mov_b32 m0, 43008
    s_mov_b32 s45, 82176
    buffer_load_dwordx4 v9, s[40:43], s45 offen lds
    s_mov_b32 m0, 44032
    s_mov_b32 s45, 82176
    buffer_load_dwordx4 v10, s[40:43], s45 offen lds
    s_mov_b32 m0, 45056
    s_mov_b32 s45, 98560
    buffer_load_dwordx4 v9, s[40:43], s45 offen lds
    s_mov_b32 m0, 46080
    s_mov_b32 s45, 98560
    buffer_load_dwordx4 v10, s[40:43], s45 offen lds
    s_mov_b32 m0, 47104
    s_mov_b32 s45, 114944
    buffer_load_dwordx4 v9, s[40:43], s45 offen lds
    s_mov_b32 m0, 48128
    s_mov_b32 s45, 114944
    buffer_load_dwordx4 v10, s[40:43], s45 offen lds
    s_barrier
    s_waitcnt vmcnt(32)
    s_mov_b32 m0, 49152
    s_mov_b32 s45, 384
    buffer_load_dwordx4 v9, s[40:43], s45 offen lds
    s_mov_b32 m0, 50176
    s_mov_b32 s45, 384
    buffer_load_dwordx4 v10, s[40:43], s45 offen lds
    s_mov_b32 m0, 51200
    s_mov_b32 s45, 16768
    buffer_load_dwordx4 v9, s[40:43], s45 offen lds
    s_mov_b32 m0, 52224
    s_mov_b32 s45, 16768
    buffer_load_dwordx4 v10, s[40:43], s45 offen lds
    s_mov_b32 m0, 53248
    s_mov_b32 s45, 33152
    buffer_load_dwordx4 v9, s[40:43], s45 offen lds
    s_mov_b32 m0, 54272
    s_mov_b32 s45, 33152
    buffer_load_dwordx4 v10, s[40:43], s45 offen lds
    s_mov_b32 m0, 55296
    s_mov_b32 s45, 49536
    buffer_load_dwordx4 v9, s[40:43], s45 offen lds
    s_mov_b32 m0, 56320
    s_mov_b32 s45, 49536
    buffer_load_dwordx4 v10, s[40:43], s45 offen lds
    s_mov_b32 m0, 57344
    s_mov_b32 s45, 65920
    buffer_load_dwordx4 v9, s[40:43], s45 offen lds
    s_mov_b32 m0, 58368
    s_mov_b32 s45, 65920
    buffer_load_dwordx4 v10, s[40:43], s45 offen lds
    s_mov_b32 m0, 59392
    s_mov_b32 s45, 82304
    buffer_load_dwordx4 v9, s[40:43], s45 offen lds
    s_mov_b32 m0, 60416
    s_mov_b32 s45, 82304
    buffer_load_dwordx4 v10, s[40:43], s45 offen lds
    s_mov_b32 m0, 61440
    s_mov_b32 s45, 98688
    buffer_load_dwordx4 v9, s[40:43], s45 offen lds
    s_mov_b32 m0, 62464
    s_mov_b32 s45, 98688
    buffer_load_dwordx4 v10, s[40:43], s45 offen lds
    s_mov_b32 m0, 63488
    s_mov_b32 s45, 115072
    buffer_load_dwordx4 v9, s[40:43], s45 offen lds
    s_mov_b32 m0, 64512
    s_mov_b32 s45, 115072
    buffer_load_dwordx4 v10, s[40:43], s45 offen lds
    s_barrier
    s_waitcnt vmcnt(32)
    s_barrier
    s_mov_b32 m0, 0
    s_mov_b32 s45, 512
    buffer_load_dwordx4 v9, s[40:43], s45 offen lds
    s_mov_b32 m0, 1024
    s_mov_b32 s45, 512
    buffer_load_dwordx4 v10, s[40:43], s45 offen lds
    s_mov_b32 m0, 2048
    s_mov_b32 s45, 16896
    buffer_load_dwordx4 v9, s[40:43], s45 offen lds
    s_mov_b32 m0, 3072
    s_mov_b32 s45, 16896
    buffer_load_dwordx4 v10, s[40:43], s45 offen lds
    s_mov_b32 m0, 4096
    s_mov_b32 s45, 33280
    buffer_load_dwordx4 v9, s[40:43], s45 offen lds
    s_mov_b32 m0, 5120
    s_mov_b32 s45, 33280
    buffer_load_dwordx4 v10, s[40:43], s45 offen lds
    s_mov_b32 m0, 6144
    s_mov_b32 s45, 49664
    buffer_load_dwordx4 v9, s[40:43], s45 offen lds
    s_mov_b32 m0, 7168
    s_mov_b32 s45, 49664
    buffer_load_dwordx4 v10, s[40:43], s45 offen lds
    s_mov_b32 m0, 8192
    s_mov_b32 s45, 66048
    buffer_load_dwordx4 v9, s[40:43], s45 offen lds
    s_mov_b32 m0, 9216
    s_mov_b32 s45, 66048
    buffer_load_dwordx4 v10, s[40:43], s45 offen lds
    s_mov_b32 m0, 10240
    s_mov_b32 s45, 82432
    buffer_load_dwordx4 v9, s[40:43], s45 offen lds
    s_mov_b32 m0, 11264
    s_mov_b32 s45, 82432
    buffer_load_dwordx4 v10, s[40:43], s45 offen lds
    s_mov_b32 m0, 12288
    s_mov_b32 s45, 98816
    buffer_load_dwordx4 v9, s[40:43], s45 offen lds
    s_mov_b32 m0, 13312
    s_mov_b32 s45, 98816
    buffer_load_dwordx4 v10, s[40:43], s45 offen lds
    s_mov_b32 m0, 14336
    s_mov_b32 s45, 115200
    buffer_load_dwordx4 v9, s[40:43], s45 offen lds
    s_mov_b32 m0, 15360
    s_mov_b32 s45, 115200
    buffer_load_dwordx4 v10, s[40:43], s45 offen lds
    s_waitcnt vmcnt(32)
    s_barrier
    s_mov_b32 m0, 16384
    s_mov_b32 s45, 640
    buffer_load_dwordx4 v9, s[40:43], s45 offen lds
    s_mov_b32 m0, 17408
    s_mov_b32 s45, 640
    buffer_load_dwordx4 v10, s[40:43], s45 offen lds
    s_mov_b32 m0, 18432
    s_mov_b32 s45, 17024
    buffer_load_dwordx4 v9, s[40:43], s45 offen lds
    s_mov_b32 m0, 19456
    s_mov_b32 s45, 17024
    buffer_load_dwordx4 v10, s[40:43], s45 offen lds
    s_mov_b32 m0, 20480
    s_mov_b32 s45, 33408
    buffer_load_dwordx4 v9, s[40:43], s45 offen lds
    s_mov_b32 m0, 21504
    s_mov_b32 s45, 33408
    buffer_load_dwordx4 v10, s[40:43], s45 offen lds
    s_mov_b32 m0, 22528
    s_mov_b32 s45, 49792
    buffer_load_dwordx4 v9, s[40:43], s45 offen lds
    s_mov_b32 m0, 23552
    s_mov_b32 s45, 49792
    buffer_load_dwordx4 v10, s[40:43], s45 offen lds
    s_mov_b32 m0, 24576
    s_mov_b32 s45, 66176
    buffer_load_dwordx4 v9, s[40:43], s45 offen lds
    s_mov_b32 m0, 25600
    s_mov_b32 s45, 66176
    buffer_load_dwordx4 v10, s[40:43], s45 offen lds
    s_mov_b32 m0, 26624
    s_mov_b32 s45, 82560
    buffer_load_dwordx4 v9, s[40:43], s45 offen lds
    s_mov_b32 m0, 27648
    s_mov_b32 s45, 82560
    buffer_load_dwordx4 v10, s[40:43], s45 offen lds
    s_mov_b32 m0, 28672
    s_mov_b32 s45, 98944
    buffer_load_dwordx4 v9, s[40:43], s45 offen lds
    s_mov_b32 m0, 29696
    s_mov_b32 s45, 98944
    buffer_load_dwordx4 v10, s[40:43], s45 offen lds
    s_mov_b32 m0, 30720
    s_mov_b32 s45, 115328
    buffer_load_dwordx4 v9, s[40:43], s45 offen lds
    s_mov_b32 m0, 31744
    s_mov_b32 s45, 115328
    buffer_load_dwordx4 v10, s[40:43], s45 offen lds
    s_waitcnt vmcnt(32)
    s_barrier
    s_mov_b32 m0, 32768
    s_mov_b32 s45, 768
    buffer_load_dwordx4 v9, s[40:43], s45 offen lds
    s_mov_b32 m0, 33792
    s_mov_b32 s45, 768
    buffer_load_dwordx4 v10, s[40:43], s45 offen lds
    s_mov_b32 m0, 34816
    s_mov_b32 s45, 17152
    buffer_load_dwordx4 v9, s[40:43], s45 offen lds
    s_mov_b32 m0, 35840
    s_mov_b32 s45, 17152
    buffer_load_dwordx4 v10, s[40:43], s45 offen lds
    s_mov_b32 m0, 36864
    s_mov_b32 s45, 33536
    buffer_load_dwordx4 v9, s[40:43], s45 offen lds
    s_mov_b32 m0, 37888
    s_mov_b32 s45, 33536
    buffer_load_dwordx4 v10, s[40:43], s45 offen lds
    s_mov_b32 m0, 38912
    s_mov_b32 s45, 49920
    buffer_load_dwordx4 v9, s[40:43], s45 offen lds
    s_mov_b32 m0, 39936
    s_mov_b32 s45, 49920
    buffer_load_dwordx4 v10, s[40:43], s45 offen lds
    s_mov_b32 m0, 40960
    s_mov_b32 s45, 66304
    buffer_load_dwordx4 v9, s[40:43], s45 offen lds
    s_mov_b32 m0, 41984
    s_mov_b32 s45, 66304
    buffer_load_dwordx4 v10, s[40:43], s45 offen lds
    s_mov_b32 m0, 43008
    s_mov_b32 s45, 82688
    buffer_load_dwordx4 v9, s[40:43], s45 offen lds
    s_mov_b32 m0, 44032
    s_mov_b32 s45, 82688
    buffer_load_dwordx4 v10, s[40:43], s45 offen lds
    s_mov_b32 m0, 45056
    s_mov_b32 s45, 99072
    buffer_load_dwordx4 v9, s[40:43], s45 offen lds
    s_mov_b32 m0, 46080
    s_mov_b32 s45, 99072
    buffer_load_dwordx4 v10, s[40:43], s45 offen lds
    s_mov_b32 m0, 47104
    s_mov_b32 s45, 115456
    buffer_load_dwordx4 v9, s[40:43], s45 offen lds
    s_mov_b32 m0, 48128
    s_mov_b32 s45, 115456
    buffer_load_dwordx4 v10, s[40:43], s45 offen lds
    s_waitcnt vmcnt(32)
    s_barrier
    s_mov_b32 m0, 49152
    s_mov_b32 s45, 896
    buffer_load_dwordx4 v9, s[40:43], s45 offen lds
    s_mov_b32 m0, 50176
    s_mov_b32 s45, 896
    buffer_load_dwordx4 v10, s[40:43], s45 offen lds
    s_mov_b32 m0, 51200
    s_mov_b32 s45, 17280
    buffer_load_dwordx4 v9, s[40:43], s45 offen lds
    s_mov_b32 m0, 52224
    s_mov_b32 s45, 17280
    buffer_load_dwordx4 v10, s[40:43], s45 offen lds
    s_mov_b32 m0, 53248
    s_mov_b32 s45, 33664
    buffer_load_dwordx4 v9, s[40:43], s45 offen lds
    s_mov_b32 m0, 54272
    s_mov_b32 s45, 33664
    buffer_load_dwordx4 v10, s[40:43], s45 offen lds
    s_mov_b32 m0, 55296
    s_mov_b32 s45, 50048
    buffer_load_dwordx4 v9, s[40:43], s45 offen lds
    s_mov_b32 m0, 56320
    s_mov_b32 s45, 50048
    buffer_load_dwordx4 v10, s[40:43], s45 offen lds
    s_mov_b32 m0, 57344
    s_mov_b32 s45, 66432
    buffer_load_dwordx4 v9, s[40:43], s45 offen lds
    s_mov_b32 m0, 58368
    s_mov_b32 s45, 66432
    buffer_load_dwordx4 v10, s[40:43], s45 offen lds
    s_mov_b32 m0, 59392
    s_mov_b32 s45, 82816
    buffer_load_dwordx4 v9, s[40:43], s45 offen lds
    s_mov_b32 m0, 60416
    s_mov_b32 s45, 82816
    buffer_load_dwordx4 v10, s[40:43], s45 offen lds
    s_mov_b32 m0, 61440
    s_mov_b32 s45, 99200
    buffer_load_dwordx4 v9, s[40:43], s45 offen lds
    s_mov_b32 m0, 62464
    s_mov_b32 s45, 99200
    buffer_load_dwordx4 v10, s[40:43], s45 offen lds
    s_mov_b32 m0, 63488
    s_mov_b32 s45, 115584
    buffer_load_dwordx4 v9, s[40:43], s45 offen lds
    s_mov_b32 m0, 64512
    s_mov_b32 s45, 115584
    buffer_load_dwordx4 v10, s[40:43], s45 offen lds
    s_waitcnt vmcnt(32)
    s_barrier
    s_waitcnt vmcnt(16)
    s_barrier
    s_waitcnt vmcnt(0)
    s_barrier
    s_barrier
    s_mov_b32 s36, 20000
L_X_poll_22:
    buffer_load_dwordx2 v[26:27], v22, s[48:51], 0 offen sc1
    s_waitcnt vmcnt(0)
    v_cmp_ne_u64_e64 vcc, v[26:27], s[34:35]
    s_cmp_eq_u64 vcc, 0
    s_cbranch_scc1 L_X_polld_23
    s_sub_u32 s36, s36, 1
    s_cbranch_scc1 L_X_polld_23
    s_sleep 1
    s_branch L_X_poll_22
L_X_polld_23:
    s_mov_b32 m0, 0
    s_mov_b32 s45, 0
    buffer_load_dwordx4 v11, s[52:55], s45 offen offset:0 sc1 lds
    buffer_load_dwordx4 v11, s[52:55], s45 offen offset:1024 sc1 lds
    buffer_load_dwordx4 v11, s[52:55], s45 offen offset:2048 sc1 lds
    buffer_load_dwordx4 v11, s[52:55], s45 offen offset:3072 sc1 lds
    s_mov_b32 m0, 4096
    s_mov_b32 s45, 4096
    buffer_load_dwordx4 v11, s[52:55], s45 offen offset:0 sc1 lds
    buffer_load_dwordx4 v11, s[52:55], s45 offen offset:1024 sc1 lds
    buffer_load_dwordx4 v11, s[52:55], s45 offen offset:2048 sc1 lds
    buffer_load_dwordx4 v11, s[52:55], s45 offen offset:3072 sc1 lds
    s_mov_b32 m0, 8192
    s_mov_b32 s45, 0
    buffer_load_dwordx4 v12, s[52:55], s45 offen offset:0 sc1 lds
    buffer_load_dwordx4 v12, s[52:55], s45 offen offset:1024 sc1 lds
    buffer_load_dwordx4 v12, s[52:55], s45 offen offset:2048 sc1 lds
    buffer_load_dwordx4 v12, s[52:55], s45 offen offset:3072 sc1 lds
    s_mov_b32 m0, 12288
    s_mov_b32 s45, 4096
    buffer_load_dwordx4 v12, s[52:55], s45 offen offset:0 sc1 lds
    buffer_load_dwordx4 v12, s[52:55], s45 offen offset:1024 sc1 lds
    buffer_load_dwordx4 v12, s[52:55], s45 offen offset:2048 sc1 lds
    buffer_load_dwordx4 v12, s[52:55], s45 offen offset:3072 sc1 lds
    s_mov_b32 m0, 16384
    s_mov_b32 s45, 8192
    buffer_load_dwordx4 v13, s[52:55], s45 offen offset:0 sc1 lds
    buffer_load_dwordx4 v13, s[52:55], s45 offen offset:1024 sc1 lds
    buffer_load_dwordx4 v13, s[52:55], s45 offen offset:2048 sc1 lds
    buffer_load_dwordx4 v13, s[52:55], s45 offen offset:3072 sc1 lds
    s_mov_b32 m0, 20480
    s_mov_b32 s45, 12288
    buffer_load_dwordx4 v13, s[52:55], s45 offen offset:0 sc1 lds
    buffer_load_dwordx4 v13, s[52:55], s45 offen offset:1024 sc1 lds
    buffer_load_dwordx4 v13, s[52:55], s45 offen offset:2048 sc1 lds
    buffer_load_dwordx4 v13, s[52:55], s45 offen offset:3072 sc1 lds
    s_mov_b32 m0, 24576
    s_mov_b32 s45, 8192
    buffer_load_dwordx4 v14, s[52:55], s45 offen offset:0 sc1 lds
    buffer_load_dwordx4 v14, s[52:55], s45 offen offset:1024 sc1 lds
    buffer_load_dwordx4 v14, s[52:55], s45 offen offset:2048 sc1 lds
    buffer_load_dwordx4 v14, s[52:55], s45 offen offset:3072 sc1 lds
    s_mov_b32 m0, 28672
    s_mov_b32 s45, 12288
    buffer_load_dwordx4 v14, s[52:55], s45 offen offset:0 sc1 lds
    buffer_load_dwordx4 v14, s[52:55], s45 offen offset:1024 sc1 lds
    buffer_load_dwordx4 v14, s[52:55], s45 offen offset:2048 sc1 lds
    buffer_load_dwordx4 v14, s[52:55], s45 offen offset:3072 sc1 lds
    s_mov_b32 m0, 32768
    s_mov_b32 s45, 16384
    buffer_load_dwordx4 v15, s[52:55], s45 offen offset:0 sc1 lds
    buffer_load_dwordx4 v15, s[52:55], s45 offen offset:1024 sc1 lds
    buffer_load_dwordx4 v15, s[52:55], s45 offen offset:2048 sc1 lds
    buffer_load_dwordx4 v15, s[52:55], s45 offen offset:3072 sc1 lds
    s_mov_b32 m0, 36864
    s_mov_b32 s45, 20480
    buffer_load_dwordx4 v15, s[52:55], s45 offen offset:0 sc1 lds
    buffer_load_dwordx4 v15, s[52:55], s45 offen offset:1024 sc1 lds
    buffer_load_dwordx4 v15, s[52:55], s45 offen offset:2048 sc1 lds
    buffer_load_dwordx4 v15, s[52:55], s45 offen offset:3072 sc1 lds
    s_mov_b32 m0, 40960
    s_mov_b32 s45, 16384
    buffer_load_dwordx4 v16, s[52:55], s45 offen offset:0 sc1 lds
    buffer_load_dwordx4 v16, s[52:55], s45 offen offset:1024 sc1 lds
    buffer_load_dwordx4 v16, s[52:55], s45 offen offset:2048 sc1 lds
    buffer_load_dwordx4 v16, s[52:55], s45 offen offset:3072 sc1 lds
    s_mov_b32 m0, 45056
    s_mov_b32 s45, 20480
    buffer_load_dwordx4 v16, s[52:55], s45 offen offset:0 sc1 lds
    buffer_load_dwordx4 v16, s[52:55], s45 offen offset:1024 sc1 lds
    buffer_load_dwordx4 v16, s[52:55], s45 offen offset:2048 sc1 lds
    buffer_load_dwordx4 v16, s[52:55], s45 offen offset:3072 sc1 lds
    s_waitcnt vmcnt(32)
    s_mov_b32 m0, 49152
    s_mov_b32 s45, 24576
    buffer_load_dwordx4 v17, s[52:55], s45 offen offset:0 sc1 lds
    buffer_load_dwordx4 v17, s[52:55], s45 offen offset:1024 sc1 lds
    buffer_load_dwordx4 v17, s[52:55], s45 offen offset:2048 sc1 lds
    buffer_load_dwordx4 v17, s[52:55], s45 offen offset:3072 sc1 lds
    s_mov_b32 m0, 53248
    s_mov_b32 s45, 28672
    buffer_load_dwordx4 v17, s[52:55], s45 offen offset:0 sc1 lds
    buffer_load_dwordx4 v17, s[52:55], s45 offen offset:1024 sc1 lds
    buffer_load_dwordx4 v17, s[52:55], s45 offen offset:2048 sc1 lds
    buffer_load_dwordx4 v17, s[52:55], s45 offen offset:3072 sc1 lds
    s_mov_b32 m0, 57344
    s_mov_b32 s45, 24576
    buffer_load_dwordx4 v18, s[52:55], s45 offen offset:0 sc1 lds
    buffer_load_dwordx4 v18, s[52:55], s45 offen offset:1024 sc1 lds
    buffer_load_dwordx4 v18, s[52:55], s45 offen offset:2048 sc1 lds
    buffer_load_dwordx4 v18, s[52:55], s45 offen offset:3072 sc1 lds
    s_mov_b32 m0, 61440
    s_mov_b32 s45, 28672
    buffer_load_dwordx4 v18, s[52:55], s45 offen offset:0 sc1 lds
    buffer_load_dwordx4 v18, s[52:55], s45 offen offset:1024 sc1 lds
    buffer_load_dwordx4 v18, s[52:55], s45 offen offset:2048 sc1 lds
    buffer_load_dwordx4 v18, s[52:55], s45 offen offset:3072 sc1 lds
    s_barrier
    s_waitcnt vmcnt(32)
    s_barrier
    s_waitcnt vmcnt(16)
    s_barrier
    s_waitcnt vmcnt(0)
    s_barrier
    s_cmp_lg_u32 s33, 0
    s_cbranch_scc1 L_X_sp_24
    s_mov_b32 s36, 20000
L_X_poll_26:
    buffer_load_dwordx2 v[26:27], v23, s[48:51], 0 offen sc1
    s_waitcnt vmcnt(0)
    s_mov_b32 exec_hi, 0
    v_xor_b32 v27, s10, v27
    s_mov_b32 exec_hi, -1
    v_cmp_eq_u64_e64 vcc, v[26:27], s[34:35]
    s_or_b32 s44, vcc_lo, vcc_hi
    s_cmp_eq_u32 s44, -1
    s_cbranch_scc1 L_X_polld_27
    s_sub_u32 s36, s36, 1
    s_cbranch_scc1 L_X_polld_27
    s_sleep 1
    s_branch L_X_poll_26
L_X_polld_27:
    s_mov_b32 m0, 0
    s_add_u32 s45, s56, 0
    buffer_load_dwordx4 v21, s[48:51], s45 offen offset:0 sc1 lds
    buffer_load_dwordx4 v21, s[48:51], s45 offen offset:1024 sc1 lds
    buffer_load_dwordx4 v21, s[48:51], s45 offen offset:2048 sc1 lds
    buffer_load_dwordx4 v21, s[48:51], s45 offen offset:3072 sc1 lds
    s_mov_b32 m0, 4096
    s_add_u32 s45, s56, 32768
    buffer_load_dwordx4 v21, s[48:51], s45 offen offset:0 sc1 lds
    buffer_load_dwordx4 v21, s[48:51], s45 offen offset:1024 sc1 lds
    buffer_load_dwordx4 v21, s[48:51], s45 offen offset:2048 sc1 lds
    buffer_load_dwordx4 v21, s[48:51], s45 offen offset:3072 sc1 lds
    s_mov_b32 m0, 8192
    s_add_u32 s45, s56, 65536
    buffer_load_dwordx4 v21, s[48:51], s45 offen offset:0 sc1 lds
    buffer_load_dwordx4 v21, s[48:51], s45 offen offset:1024 sc1 lds
    buffer_load_dwordx4 v21, s[48:51], s45 offen offset:2048 sc1 lds
    buffer_load_dwordx4 v21, s[48:51], s45 offen offset:3072 sc1 lds
    s_mov_b32 m0, 12288
    s_add_u32 s45, s56, 98304
    buffer_load_dwordx4 v21, s[48:51], s45 offen offset:0 sc1 lds
    buffer_load_dwordx4 v21, s[48:51], s45 offen offset:1024 sc1 lds
    buffer_load_dwordx4 v21, s[48:51], s45 offen offset:2048 sc1 lds
    buffer_load_dwordx4 v21, s[48:51], s45 offen offset:3072 sc1 lds
    s_mov_b32 m0, 16384
    s_add_u32 s45, s56, 4096
    buffer_load_dwordx4 v21, s[48:51], s45 offen offset:0 sc1 lds
    buffer_load_dwordx4 v21, s[48:51], s45 offen offset:1024 sc1 lds
    buffer_load_dwordx4 v21, s[48:51], s45 offen offset:2048 sc1 lds
    buffer_load_dwordx4 v21, s[48:51], s45 offen offset:3072 sc1 lds
    s_mov_b32 m0, 20480
    s_add_u32 s45, s56, 36864
    buffer_load_dwordx4 v21, s[48:51], s45 offen offset:0 sc1 lds
    buffer_load_dwordx4 v21, s[48:51], s45 offen offset:1024 sc1 lds
    buffer_load_dwordx4 v21, s[48:51], s45 offen offset:2048 sc1 lds
    buffer_load_dwordx4 v21, s[48:51], s45 offen offset:3072 sc1 lds
    s_mov_b32 m0, 24576
    s_add_u32 s45, s56, 69632
    buffer_load_dwordx4 v21, s[48:51], s45 offen offset:0 sc1 lds
    buffer_load_dwordx4 v21, s[48:51], s45 offen offset:1024 sc1 lds
    buffer_load_dwordx4 v21, s[48:51], s45 offen offset:2048 sc1 lds
    buffer_load_dwordx4 v21, s[48:51], s45 offen offset:3072 sc1 lds
    s_mov_b32 m0, 28672
    s_add_u32 s45, s56, 102400
    buffer_load_dwordx4 v21, s[48:51], s45 offen offset:0 sc1 lds
    buffer_load_dwordx4 v21, s[48:51], s45 offen offset:1024 sc1 lds
    buffer_load_dwordx4 v21, s[48:51], s45 offen offset:2048 sc1 lds
    buffer_load_dwordx4 v21, s[48:51], s45 offen offset:3072 sc1 lds
    s_mov_b32 m0, 32768
    s_add_u32 s45, s56, 8192
    buffer_load_dwordx4 v21, s[48:51], s45 offen offset:0 sc1 lds
    buffer_load_dwordx4 v21, s[48:51], s45 offen offset:1024 sc1 lds
    buffer_load_dwordx4 v21, s[48:51], s45 offen offset:2048 sc1 lds
    buffer_load_dwordx4 v21, s[48:51], s45 offen offset:3072 sc1 lds
    s_mov_b32 m0, 36864
    s_add_u32 s45, s56, 40960
    buffer_load_dwordx4 v21, s[48:51], s45 offen offset:0 sc1 lds
    buffer_load_dwordx4 v21, s[48:51], s45 offen offset:1024 sc1 lds
    buffer_load_dwordx4 v21, s[48:51], s45 offen offset:2048 sc1 lds
    buffer_load_dwordx4 v21, s[48:51], s45 offen offset:3072 sc1 lds
    s_mov_b32 m0, 40960
    s_add_u32 s45, s56, 73728
    buffer_load_dwordx4 v21, s[48:51], s45 offen offset:0 sc1 lds
    buffer_load_dwordx4 v21, s[48:51], s45 offen offset:1024 sc1 lds
    buffer_load_dwordx4 v21, s[48:51], s45 offen offset:2048 sc1 lds
    buffer_load_dwordx4 v21, s[48:51], s45 offen offset:3072 sc1 lds
    s_mov_b32 m0, 45056
    s_add_u32 s45, s56, 106496
    buffer_load_dwordx4 v21, s[48:51], s45 offen offset:0 sc1 lds
    buffer_load_dwordx4 v21, s[48:51], s45 offen offset:1024 sc1 lds
    buffer_load_dwordx4 v21, s[48:51], s45 offen offset:2048 sc1 lds
    buffer_load_dwordx4 v21, s[48:51], s45 offen offset:3072 sc1 lds
    s_barrier
    s_waitcnt vmcnt(32)
    s_barrier
    s_mov_b32 m0, 49152
    s_add_u32 s45, s56, 12288
    buffer_load_dwordx4 v21, s[48:51], s45 offen offset:0 sc1 lds
    buffer_load_dwordx4 v21, s[48:51], s45 offen offset:1024 sc1 lds
    buffer_load_dwordx4 v21, s[48:51], s45 offen offset:2048 sc1 lds
    buffer_load_dwordx4 v21, s[48:51], s45 offen offset:3072 sc1 lds
    s_mov_b32 m0, 53248
    s_add_u32 s45, s56, 45056
    buffer_load_dwordx4 v21, s[48:51], s45 offen offset:0 sc1 lds
    buffer_load_dwordx4 v21, s[48:51], s45 offen offset:1024 sc1 lds
    buffer_load_dwordx4 v21, s[48:51], s45 offen offset:2048 sc1 lds
    buffer_load_dwordx4 v21, s[48:51], s45 offen offset:3072 sc1 lds
    s_mov_b32 m0, 57344
    s_add_u32 s45, s56, 77824
    buffer_load_dwordx4 v21, s[48:51], s45 offen offset:0 sc1 lds
    buffer_load_dwordx4 v21, s[48:51], s45 offen offset:1024 sc1 lds
    buffer_load_dwordx4 v21, s[48:51], s45 offen offset:2048 sc1 lds
    buffer_load_dwordx4 v21, s[48:51], s45 offen offset:3072 sc1 lds
    s_mov_b32 m0, 61440
    s_add_u32 s45, s56, 110592
    buffer_load_dwordx4 v21, s[48:51], s45 offen offset:0 sc1 lds
    buffer_load_dwordx4 v21, s[48:51], s45 offen offset:1024 sc1 lds
    buffer_load_dwordx4 v21, s[48:51], s45 offen offset:2048 sc1 lds
    buffer_load_dwordx4 v21, s[48:51], s45 offen offset:3072 sc1 lds
    s_waitcnt vmcnt(32)
    s_barrier
    s_mov_b32 m0, 0
    s_add_u32 s45, s56, 16384
    buffer_load_dwordx4 v21, s[48:51], s45 offen offset:0 sc1 lds
    buffer_load_dwordx4 v21, s[48:51], s45 offen offset:1024 sc1 lds
    buffer_load_dwordx4 v21, s[48:51], s45 offen offset:2048 sc1 lds
    buffer_load_dwordx4 v21, s[48:51], s45 offen offset:3072 sc1 lds
    s_mov_b32 m0, 4096
    s_add_u32 s45, s56, 49152
    buffer_load_dwordx4 v21, s[48:51], s45 offen offset:0 sc1 lds
    buffer_load_dwordx4 v21, s[48:51], s45 offen offset:1024 sc1 lds
    buffer_load_dwordx4 v21, s[48:51], s45 offen offset:2048 sc1 lds
    buffer_load_dwordx4 v21, s[48:51], s45 offen offset:3072 sc1 lds
    s_mov_b32 m0, 8192
    s_add_u32 s45, s56, 81920
    buffer_load_dwordx4 v21, s[48:51], s45 offen offset:0 sc1 lds
    buffer_load_dwordx4 v21, s[48:51], s45 offen offset:1024 sc1 lds
    buffer_load_dwordx4 v21, s[48:51], s45 offen offset:2048 sc1 lds
    buffer_load_dwordx4 v21, s[48:51], s45 offen offset:3072 sc1 lds
    s_mov_b32 m0, 12288
    s_add_u32 s45, s56, 114688
    buffer_load_dwordx4 v21, s[48:51], s45 offen offset:0 sc1 lds
    buffer_load_dwordx4 v21, s[48:51], s45 offen offset:1024 sc1 lds
    buffer_load_dwordx4 v21, s[48:51], s45 offen offset:2048 sc1 lds
    buffer_load_dwordx4 v21, s[48:51], s45 offen offset:3072 sc1 lds
    s_waitcnt vmcnt(32)
    s_barrier
    s_mov_b32 m0, 16384
    s_add_u32 s45, s56, 20480
    buffer_load_dwordx4 v21, s[48:51], s45 offen offset:0 sc1 lds
    buffer_load_dwordx4 v21, s[48:51], s45 offen offset:1024 sc1 lds
    buffer_load_dwordx4 v21, s[48:51], s45 offen offset:2048 sc1 lds
    buffer_load_dwordx4 v21, s[48:51], s45 offen offset:3072 sc1 lds
    s_mov_b32 m0, 20480
    s_add_u32 s45, s56, 53248
    buffer_load_dwordx4 v21, s[48:51], s45 offen offset:0 sc1 lds
    buffer_load_dwordx4 v21, s[48:51], s45 offen offset:1024 sc1 lds
    buffer_load_dwordx4 v21, s[48:51], s45 offen offset:2048 sc1 lds
    buffer_load_dwordx4 v21, s[48:51], s45 offen offset:3072 sc1 lds
    s_mov_b32 m0, 24576
    s_add_u32 s45, s56, 86016
    buffer_load_dwordx4 v21, s[48:51], s45 offen offset:0 sc1 lds
    buffer_load_dwordx4 v21, s[48:51], s45 offen offset:1024 sc1 lds
    buffer_load_dwordx4 v21, s[48:51], s45 offen offset:2048 sc1 lds
    buffer_load_dwordx4 v21, s[48:51], s45 offen offset:3072 sc1 lds
    s_mov_b32 m0, 28672
    s_add_u32 s45, s56, 118784
    buffer_load_dwordx4 v21, s[48:51], s45 offen offset:0 sc1 lds
    buffer_load_dwordx4 v21, s[48:51], s45 offen offset:1024 sc1 lds
    buffer_load_dwordx4 v21, s[48:51], s45 offen offset:2048 sc1 lds
    buffer_load_dwordx4 v21, s[48:51], s45 offen offset:3072 sc1 lds
    s_waitcnt vmcnt(32)
    s_barrier
    s_mov_b32 m0, 32768
    s_add_u32 s45, s56, 24576
    buffer_load_dwordx4 v21, s[48:51], s45 offen offset:0 sc1 lds
    buffer_load_dwordx4 v21, s[48:51], s45 offen offset:1024 sc1 lds
    buffer_load_dwordx4 v21, s[48:51], s45 offen offset:2048 sc1 lds
    buffer_load_dwordx4 v21, s[48:51], s45 offen offset:3072 sc1 lds
    s_mov_b32 m0, 36864
    s_add_u32 s45, s56, 57344
    buffer_load_dwordx4 v21, s[48:51], s45 offen offset:0 sc1 lds
    buffer_load_dwordx4 v21, s[48:51], s45 offen offset:1024 sc1 lds
    buffer_load_dwordx4 v21, s[48:51], s45 offen offset:2048 sc1 lds
    buffer_load_dwordx4 v21, s[48:51], s45 offen offset:3072 sc1 lds
    s_mov_b32 m0, 40960
    s_add_u32 s45, s56, 90112
    buffer_load_dwordx4 v21, s[48:51], s45 offen offset:0 sc1 lds
    buffer_load_dwordx4 v21, s[48:51], s45 offen offset:1024 sc1 lds
    buffer_load_dwordx4 v21, s[48:51], s45 offen offset:2048 sc1 lds
    buffer_load_dwordx4 v21, s[48:51], s45 offen offset:3072 sc1 lds
    s_mov_b32 m0, 45056
    s_add_u32 s45, s56, 122880
    buffer_load_dwordx4 v21, s[48:51], s45 offen offset:0 sc1 lds
    buffer_load_dwordx4 v21, s[48:51], s45 offen offset:1024 sc1 lds
    buffer_load_dwordx4 v21, s[48:51], s45 offen offset:2048 sc1 lds
    buffer_load_dwordx4 v21, s[48:51], s45 offen offset:3072 sc1 lds
    s_waitcnt vmcnt(32)
    s_barrier
    s_mov_b32 m0, 49152
    s_add_u32 s45, s56, 28672
    buffer_load_dwordx4 v21, s[48:51], s45 offen offset:0 sc1 lds
    buffer_load_dwordx4 v21, s[48:51], s45 offen offset:1024 sc1 lds
    buffer_load_dwordx4 v21, s[48:51], s45 offen offset:2048 sc1 lds
    buffer_load_dwordx4 v21, s[48:51], s45 offen offset:3072 sc1 lds
    s_mov_b32 m0, 53248
    s_add_u32 s45, s56, 61440
    buffer_load_dwordx4 v21, s[48:51], s45 offen offset:0 sc1 lds
    buffer_load_dwordx4 v21, s[48:51], s45 offen offset:1024 sc1 lds
    buffer_load_dwordx4 v21, s[48:51], s45 offen offset:2048 sc1 lds
    buffer_load_dwordx4 v21, s[48:51], s45 offen offset:3072 sc1 lds
    s_mov_b32 m0, 57344
    s_add_u32 s45, s56, 94208
    buffer_load_dwordx4 v21, s[48:51], s45 offen offset:0 sc1 lds
    buffer_load_dwordx4 v21, s[48:51], s45 offen offset:1024 sc1 lds
    buffer_load_dwordx4 v21, s[48:51], s45 offen offset:2048 sc1 lds
    buffer_load_dwordx4 v21, s[48:51], s45 offen offset:3072 sc1 lds
    s_mov_b32 m0, 61440
    s_add_u32 s45, s56, 126976
    buffer_load_dwordx4 v21, s[48:51], s45 offen offset:0 sc1 lds
    buffer_load_dwordx4 v21, s[48:51], s45 offen offset:1024 sc1 lds
    buffer_load_dwordx4 v21, s[48:51], s45 offen offset:2048 sc1 lds
    buffer_load_dwordx4 v21, s[48:51], s45 offen offset:3072 sc1 lds
    s_waitcnt vmcnt(32)
    s_barrier
    s_waitcnt vmcnt(16)
    s_barrier
    s_waitcnt vmcnt(0)
    s_barrier
    s_barrier
    s_mov_b32 s36, 20000
L_X_poll_28:
    buffer_load_dwordx2 v[26:27], v24, s[48:51], 0 offen sc1
    s_waitcnt vmcnt(0)
    s_mov_b32 exec_hi, 0
    v_xor_b32 v27, s10, v27
    s_mov_b32 exec_hi, -1
    v_cmp_eq_u64_e64 vcc, v[26:27], s[34:35]
    s_or_b32 s44, vcc_lo, vcc_hi
    s_cmp_eq_u32 s44, -1
    s_cbranch_scc1 L_X_polld_29
    s_sub_u32 s36, s36, 1
    s_cbranch_scc1 L_X_polld_29
    s_sleep 1
    s_branch L_X_poll_28
L_X_polld_29:
    s_mov_b32 m0, 0
    s_add_u32 s45, s57, 0
    buffer_load_dwordx4 v21, s[48:51], s45 offen offset:0 sc1 lds
    buffer_load_dwordx4 v21, s[48:51], s45 offen offset:1024 sc1 lds
    buffer_load_dwordx4 v21, s[48:51], s45 offen offset:2048 sc1 lds
    buffer_load_dwordx4 v21, s[48:51], s45 offen offset:3072 sc1 lds
    s_mov_b32 m0, 4096
    s_add_u32 s45, s57, 4096
    buffer_load_dwordx4 v21, s[48:51], s45 offen offset:0 sc1 lds
    buffer_load_dwordx4 v21, s[48:51], s45 offen offset:1024 sc1 lds
    buffer_load_dwordx4 v21, s[48:51], s45 offen offset:2048 sc1 lds
    buffer_load_dwordx4 v21, s[48:51], s45 offen offset:3072 sc1 lds
    s_mov_b32 m0, 8192
    s_add_u32 s45, s57, 32768
    buffer_load_dwordx4 v21, s[48:51], s45 offen offset:0 sc1 lds
    buffer_load_dwordx4 v21, s[48:51], s45 offen offset:1024 sc1 lds
    buffer_load_dwordx4 v21, s[48:51], s45 offen offset:2048 sc1 lds
    buffer_load_dwordx4 v21, s[48:51], s45 offen offset:3072 sc1 lds
    s_mov_b32 m0, 12288
    s_add_u32 s45, s57, 36864
    buffer_load_dwordx4 v21, s[48:51], s45 offen offset:0 sc1 lds
    buffer_load_dwordx4 v21, s[48:51], s45 offen offset:1024 sc1 lds
    buffer_load_dwordx4 v21, s[48:51], s45 offen offset:2048 sc1 lds
    buffer_load_dwordx4 v21, s[48:51], s45 offen offset:3072 sc1 lds
    s_mov_b32 m0, 16384
    s_add_u32 s45, s57, 8192
    buffer_load_dwordx4 v21, s[48:51], s45 offen offset:0 sc1 lds
    buffer_load_dwordx4 v21, s[48:51], s45 offen offset:1024 sc1 lds
    buffer_load_dwordx4 v21, s[48:51], s45 offen offset:2048 sc1 lds
    buffer_load_dwordx4 v21, s[48:51], s45 offen offset:3072 sc1 lds
    s_mov_b32 m0, 20480
    s_add_u32 s45, s57, 12288
    buffer_load_dwordx4 v21, s[48:51], s45 offen offset:0 sc1 lds
    buffer_load_dwordx4 v21, s[48:51], s45 offen offset:1024 sc1 lds
    buffer_load_dwordx4 v21, s[48:51], s45 offen offset:2048 sc1 lds
    buffer_load_dwordx4 v21, s[48:51], s45 offen offset:3072 sc1 lds
    s_mov_b32 m0, 24576
    s_add_u32 s45, s57, 40960
    buffer_load_dwordx4 v21, s[48:51], s45 offen offset:0 sc1 lds
    buffer_load_dwordx4 v21, s[48:51], s45 offen offset:1024 sc1 lds
    buffer_load_dwordx4 v21, s[48:51], s45 offen offset:2048 sc1 lds
    buffer_load_dwordx4 v21, s[48:51], s45 offen offset:3072 sc1 lds
    s_mov_b32 m0, 28672
    s_add_u32 s45, s57, 45056
    buffer_load_dwordx4 v21, s[48:51], s45 offen offset:0 sc1 lds
    buffer_load_dwordx4 v21, s[48:51], s45 offen offset:1024 sc1 lds
    buffer_load_dwordx4 v21, s[48:51], s45 offen offset:2048 sc1 lds
    buffer_load_dwordx4 v21, s[48:51], s45 offen offset:3072 sc1 lds
    s_mov_b32 m0, 32768
    s_add_u32 s45, s57, 16384
    buffer_load_dwordx4 v21, s[48:51], s45 offen offset:0 sc1 lds
    buffer_load_dwordx4 v21, s[48:51], s45 offen offset:1024 sc1 lds
    buffer_load_dwordx4 v21, s[48:51], s45 offen offset:2048 sc1 lds
    buffer_load_dwordx4 v21, s[48:51], s45 offen offset:3072 sc1 lds
    s_mov_b32 m0, 36864
    s_add_u32 s45, s57, 20480
    buffer_load_dwordx4 v21, s[48:51], s45 offen offset:0 sc1 lds
    buffer_load_dwordx4 v21, s[48:51], s45 offen offset:1024 sc1 lds
    buffer_load_dwordx4 v21, s[48:51], s45 offen offset:2048 sc1 lds
    buffer_load_dwordx4 v21, s[48:51], s45 offen offset:3072 sc1 lds
    s_mov_b32 m0, 40960
    s_add_u32 s45, s57, 49152
    buffer_load_dwordx4 v21, s[48:51], s45 offen offset:0 sc1 lds
    buffer_load_dwordx4 v21, s[48:51], s45 offen offset:1024 sc1 lds
    buffer_load_dwordx4 v21, s[48:51], s45 offen offset:2048 sc1 lds
    buffer_load_dwordx4 v21, s[48:51], s45 offen offset:3072 sc1 lds
    s_mov_b32 m0, 45056
    s_add_u32 s45, s57, 53248
    buffer_load_dwordx4 v21, s[48:51], s45 offen offset:0 sc1 lds
    buffer_load_dwordx4 v21, s[48:51], s45 offen offset:1024 sc1 lds
    buffer_load_dwordx4 v21, s[48:51], s45 offen offset:2048 sc1 lds
    buffer_load_dwordx4 v21, s[48:51], s45 offen offset:3072 sc1 lds
    s_waitcnt vmcnt(32)
    s_mov_b32 m0, 49152
    s_add_u32 s45, s57, 24576
    buffer_load_dwordx4 v21, s[48:51], s45 offen offset:0 sc1 lds
    buffer_load_dwordx4 v21, s[48:51], s45 offen offset:1024 sc1 lds
    buffer_load_dwordx4 v21, s[48:51], s45 offen offset:2048 sc1 lds
    buffer_load_dwordx4 v21, s[48:51], s45 offen offset:3072 sc1 lds
    s_mov_b32 m0, 53248
    s_add_u32 s45, s57, 28672
    buffer_load_dwordx4 v21, s[48:51], s45 offen offset:0 sc1 lds
    buffer_load_dwordx4 v21, s[48:51], s45 offen offset:1024 sc1 lds
    buffer_load_dwordx4 v21, s[48:51], s45 offen offset:2048 sc1 lds
    buffer_load_dwordx4 v21, s[48:51], s45 offen offset:3072 sc1 lds
    s_mov_b32 m0, 57344
    s_add_u32 s45, s57, 57344
    buffer_load_dwordx4 v21, s[48:51], s45 offen offset:0 sc1 lds
    buffer_load_dwordx4 v21, s[48:51], s45 offen offset:1024 sc1 lds
    buffer_load_dwordx4 v21, s[48:51], s45 offen offset:2048 sc1 lds
    buffer_load_dwordx4 v21, s[48:51], s45 offen offset:3072 sc1 lds
    s_mov_b32 m0, 61440
    s_add_u32 s45, s57, 61440
    buffer_load_dwordx4 v21, s[48:51], s45 offen offset:0 sc1 lds
    buffer_load_dwordx4 v21, s[48:51], s45 offen offset:1024 sc1 lds
    buffer_load_dwordx4 v21, s[48:51], s45 offen offset:2048 sc1 lds
    buffer_load_dwordx4 v21, s[48:51], s45 offen offset:3072 sc1 lds
    s_branch L_X_b24_25
L_X_sp_24:
    s_barrier
    s_mov_b32 s36, 20000
L_X_poll_30:
    buffer_load_dwordx2 v[26:27], v24, s[48:51], 0 offen sc1
    s_waitcnt vmcnt(0)
    s_mov_b32 exec_hi, 0
    v_xor_b32 v27, s10, v27
    s_mov_b32 exec_hi, -1
    v_cmp_eq_u64_e64 vcc, v[26:27], s[34:35]
    s_or_b32 s44, vcc_lo, vcc_hi
    s_cmp_eq_u32 s44, -1
    s_cbranch_scc1 L_X_polld_31
    s_sub_u32 s36, s36, 1
    s_cbranch_scc1 L_X_polld_31
    s_sleep 1
    s_branch L_X_poll_30
L_X_polld_31:
    s_mov_b32 m0, 0
    s_add_u32 s45, s57, 0
    buffer_load_dwordx4 v21, s[48:51], s45 offen offset:0 sc1 lds
    buffer_load_dwordx4 v21, s[48:51], s45 offen offset:1024 sc1 lds
    buffer_load_dwordx4 v21, s[48:51], s45 offen offset:2048 sc1 lds
    buffer_load_dwordx4 v21, s[48:51], s45 offen offset:3072 sc1 lds
    s_mov_b32 m0, 4096
    s_add_u32 s45, s57, 4096
    buffer_load_dwordx4 v21, s[48:51], s45 offen offset:0 sc1 lds
    buffer_load_dwordx4 v21, s[48:51], s45 offen offset:1024 sc1 lds
    buffer_load_dwordx4 v21, s[48:51], s45 offen offset:2048 sc1 lds
    buffer_load_dwordx4 v21, s[48:51], s45 offen offset:3072 sc1 lds
    s_mov_b32 m0, 8192
    s_add_u32 s45, s57, 32768
    buffer_load_dwordx4 v21, s[48:51], s45 offen offset:0 sc1 lds
    buffer_load_dwordx4 v21, s[48:51], s45 offen offset:1024 sc1 lds
    buffer_load_dwordx4 v21, s[48:51], s45 offen offset:2048 sc1 lds
    buffer_load_dwordx4 v21, s[48:51], s45 offen offset:3072 sc1 lds
    s_mov_b32 m0, 12288
    s_add_u32 s45, s57, 36864
    buffer_load_dwordx4 v21, s[48:51], s45 offen offset:0 sc1 lds
    buffer_load_dwordx4 v21, s[48:51], s45 offen offset:1024 sc1 lds
    buffer_load_dwordx4 v21, s[48:51], s45 offen offset:2048 sc1 lds
    buffer_load_dwordx4 v21, s[48:51], s45 offen offset:3072 sc1 lds
    s_mov_b32 m0, 16384
    s_add_u32 s45, s57, 8192
    buffer_load_dwordx4 v21, s[48:51], s45 offen offset:0 sc1 lds
    buffer_load_dwordx4 v21, s[48:51], s45 offen offset:1024 sc1 lds
    buffer_load_dwordx4 v21, s[48:51], s45 offen offset:2048 sc1 lds
    buffer_load_dwordx4 v21, s[48:51], s45 offen offset:3072 sc1 lds
    s_mov_b32 m0, 20480
    s_add_u32 s45, s57, 12288
    buffer_load_dwordx4 v21, s[48:51], s45 offen offset:0 sc1 lds
    buffer_load_dwordx4 v21, s[48:51], s45 offen offset:1024 sc1 lds
    buffer_load_dwordx4 v21, s[48:51], s45 offen offset:2048 sc1 lds
    buffer_load_dwordx4 v21, s[48:51], s45 offen offset:3072 sc1 lds
    s_mov_b32 m0, 24576
    s_add_u32 s45, s57, 40960
    buffer_load_dwordx4 v21, s[48:51], s45 offen offset:0 sc1 lds
    buffer_load_dwordx4 v21, s[48:51], s45 offen offset:1024 sc1 lds
    buffer_load_dwordx4 v21, s[48:51], s45 offen offset:2048 sc1 lds
    buffer_load_dwordx4 v21, s[48:51], s45 offen offset:3072 sc1 lds
    s_mov_b32 m0, 28672
    s_add_u32 s45, s57, 45056
    buffer_load_dwordx4 v21, s[48:51], s45 offen offset:0 sc1 lds
    buffer_load_dwordx4 v21, s[48:51], s45 offen offset:1024 sc1 lds
    buffer_load_dwordx4 v21, s[48:51], s45 offen offset:2048 sc1 lds
    buffer_load_dwordx4 v21, s[48:51], s45 offen offset:3072 sc1 lds
    s_mov_b32 m0, 32768
    s_add_u32 s45, s57, 16384
    buffer_load_dwordx4 v21, s[48:51], s45 offen offset:0 sc1 lds
    buffer_load_dwordx4 v21, s[48:51], s45 offen offset:1024 sc1 lds
    buffer_load_dwordx4 v21, s[48:51], s45 offen offset:2048 sc1 lds
    buffer_load_dwordx4 v21, s[48:51], s45 offen offset:3072 sc1 lds
    s_mov_b32 m0, 36864
    s_add_u32 s45, s57, 20480
    buffer_load_dwordx4 v21, s[48:51], s45 offen offset:0 sc1 lds
    buffer_load_dwordx4 v21, s[48:51], s45 offen offset:1024 sc1 lds
    buffer_load_dwordx4 v21, s[48:51], s45 offen offset:2048 sc1 lds
    buffer_load_dwordx4 v21, s[48:51], s45 offen offset:3072 sc1 lds
    s_mov_b32 m0, 40960
    s_add_u32 s45, s57, 49152
    buffer_load_dwordx4 v21, s[48:51], s45 offen offset:0 sc1 lds
    buffer_load_dwordx4 v21, s[48:51], s45 offen offset:1024 sc1 lds
    buffer_load_dwordx4 v21, s[48:51], s45 offen offset:2048 sc1 lds
    buffer_load_dwordx4 v21, s[48:51], s45 offen offset:3072 sc1 lds
    s_mov_b32 m0, 45056
    s_add_u32 s45, s57, 53248
    buffer_load_dwordx4 v21, s[48:51], s45 offen offset:0 sc1 lds
    buffer_load_dwordx4 v21, s[48:51], s45 offen offset:1024 sc1 lds
    buffer_load_dwordx4 v21, s[48:51], s45 offen offset:2048 sc1 lds
    buffer_load_dwordx4 v21, s[48:51], s45 offen offset:3072 sc1 lds
    s_waitcnt vmcnt(32)
    s_mov_b32 m0, 49152
    s_add_u32 s45, s57, 24576
    buffer_load_dwordx4 v21, s[48:51], s45 offen offset:0 sc1 lds
    buffer_load_dwordx4 v21, s[48:51], s45 offen offset:1024 sc1 lds
    buffer_load_dwordx4 v21, s[48:51], s45 offen offset:2048 sc1 lds
    buffer_load_dwordx4 v21, s[48:51], s45 offen offset:3072 sc1 lds
    s_mov_b32 m0, 53248
    s_add_u32 s45, s57, 28672
    buffer_load_dwordx4 v21, s[48:51], s45 offen offset:0 sc1 lds
    buffer_load_dwordx4 v21, s[48:51], s45 offen offset:1024 sc1 lds
    buffer_load_dwordx4 v21, s[48:51], s45 offen offset:2048 sc1 lds
    buffer_load_dwordx4 v21, s[48:51], s45 offen offset:3072 sc1 lds
    s_mov_b32 m0, 57344
    s_add_u32 s45, s57, 57344
    buffer_load_dwordx4 v21, s[48:51], s45 offen offset:0 sc1 lds
    buffer_load_dwordx4 v21, s[48:51], s45 offen offset:1024 sc1 lds
    buffer_load_dwordx4 v21, s[48:51], s45 offen offset:2048 sc1 lds
    buffer_load_dwordx4 v21, s[48:51], s45 offen offset:3072 sc1 lds
    s_mov_b32 m0, 61440
    s_add_u32 s45, s57, 61440
    buffer_load_dwordx4 v21, s[48:51], s45 offen offset:0 sc1 lds
    buffer_load_dwordx4 v21, s[48:51], s45 offen offset:1024 sc1 lds
    buffer_load_dwordx4 v21, s[48:51], s45 offen offset:2048 sc1 lds
    buffer_load_dwordx4 v21, s[48:51], s45 offen offset:3072 sc1 lds
L_X_b24_25:
    s_barrier
    s_waitcnt vmcnt(32)
    s_barrier
    s_waitcnt vmcnt(16)
    s_barrier
    s_waitcnt vmcnt(0)
    s_barrier
    s_mov_b32 s36, 20000
L_X_poll_32:
    buffer_load_dwordx2 v[26:27], v25, s[48:51], 0 offen sc1
    s_waitcnt vmcnt(0)
    s_mov_b32 exec_hi, 0
    v_xor_b32 v27, s10, v27
    s_mov_b32 exec_hi, -1
    v_cmp_eq_u64_e64 vcc, v[26:27], s[34:35]
    s_or_b32 s44, vcc_lo, vcc_hi
    s_cmp_eq_u32 s44, -1
    s_cbranch_scc1 L_X_polld_33
    s_sub_u32 s36, s36, 1
    s_cbranch_scc1 L_X_polld_33
    s_sleep 1
    s_branch L_X_poll_32
L_X_polld_33:
    s_mov_b32 m0, 0
    s_add_u32 s45, s58, 0
    buffer_load_dwordx4 v21, s[48:51], s45 offen offset:0 sc1 lds
    buffer_load_dwordx4 v21, s[48:51], s45 offen offset:1024 sc1 lds
    buffer_load_dwordx4 v21, s[48:51], s45 offen offset:2048 sc1 lds
    buffer_load_dwordx4 v21, s[48:51], s45 offen offset:3072 sc1 lds
    s_mov_b32 m0, 4096
    s_add_u32 s45, s58, 4096
    buffer_load_dwordx4 v21, s[48:51], s45 offen offset:0 sc1 lds
    buffer_load_dwordx4 v21, s[48:51], s45 offen offset:1024 sc1 lds
    buffer_load_dwordx4 v21, s[48:51], s45 offen offset:2048 sc1 lds
    buffer_load_dwordx4 v21, s[48:51], s45 offen offset:3072 sc1 lds
    s_mov_b32 m0, 8192
    s_add_u32 s45, s58, 114688
    buffer_load_dwordx4 v21, s[48:51], s45 offen offset:0 sc1 lds
    buffer_load_dwordx4 v21, s[48:51], s45 offen offset:1024 sc1 lds
    buffer_load_dwordx4 v21, s[48:51], s45 offen offset:2048 sc1 lds
    buffer_load_dwordx4 v21, s[48:51], s45 offen offset:3072 sc1 lds
    s_mov_b32 m0, 12288
    s_add_u32 s45, s58, 118784
    buffer_load_dwordx4 v21, s[48:51], s45 offen offset:0 sc1 lds
    buffer_load_dwordx4 v21, s[48:51], s45 offen offset:1024 sc1 lds
    buffer_load_dwordx4 v21, s[48:51], s45 offen offset:2048 sc1 lds
    buffer_load_dwordx4 v21, s[48:51], s45 offen offset:3072 sc1 lds
    s_mov_b32 m0, 16384
    s_add_u32 s45, s58, 8192
    buffer_load_dwordx4 v21, s[48:51], s45 offen offset:0 sc1 lds
    buffer_load_dwordx4 v21, s[48:51], s45 offen offset:1024 sc1 lds
    buffer_load_dwordx4 v21, s[48:51], s45 offen offset:2048 sc1 lds
    buffer_load_dwordx4 v21, s[48:51], s45 offen offset:3072 sc1 lds
    s_mov_b32 m0, 20480
    s_add_u32 s45, s58, 12288
    buffer_load_dwordx4 v21, s[48:51], s45 offen offset:0 sc1 lds
    buffer_load_dwordx4 v21, s[48:51], s45 offen offset:1024 sc1 lds
    buffer_load_dwordx4 v21, s[48:51], s45 offen offset:2048 sc1 lds
    buffer_load_dwordx4 v21, s[48:51], s45 offen offset:3072 sc1 lds
    s_mov_b32 m0, 24576
    s_add_u32 s45, s58, 122880
    buffer_load_dwordx4 v21, s[48:51], s45 offen offset:0 sc1 lds
    buffer_load_dwordx4 v21, s[48:51], s45 offen offset:1024 sc1 lds
    buffer_load_dwordx4 v21, s[48:51], s45 offen offset:2048 sc1 lds
    buffer_load_dwordx4 v21, s[48:51], s45 offen offset:3072 sc1 lds
    s_mov_b32 m0, 28672
    s_add_u32 s45, s58, 126976
    buffer_load_dwordx4 v21, s[48:51], s45 offen offset:0 sc1 lds
    buffer_load_dwordx4 v21, s[48:51], s45 offen offset:1024 sc1 lds
    buffer_load_dwordx4 v21, s[48:51], s45 offen offset:2048 sc1 lds
    buffer_load_dwordx4 v21, s[48:51], s45 offen offset:3072 sc1 lds
    s_mov_b32 m0, 32768
    s_add_u32 s45, s58, 16384
    buffer_load_dwordx4 v21, s[48:51], s45 offen offset:0 sc1 lds
    buffer_load_dwordx4 v21, s[48:51], s45 offen offset:1024 sc1 lds
    buffer_load_dwordx4 v21, s[48:51], s45 offen offset:2048 sc1 lds
    buffer_load_dwordx4 v21, s[48:51], s45 offen offset:3072 sc1 lds
    s_mov_b32 m0, 36864
    s_add_u32 s45, s58, 20480
    buffer_load_dwordx4 v21, s[48:51], s45 offen offset:0 sc1 lds
    buffer_load_dwordx4 v21, s[48:51], s45 offen offset:1024 sc1 lds
    buffer_load_dwordx4 v21, s[48:51], s45 offen offset:2048 sc1 lds
    buffer_load_dwordx4 v21, s[48:51], s45 offen offset:3072 sc1 lds
    s_mov_b32 m0, 40960
    s_add_u32 s45, s58, 131072
    buffer_load_dwordx4 v21, s[48:51], s45 offen offset:0 sc1 lds
    buffer_load_dwordx4 v21, s[48:51], s45 offen offset:1024 sc1 lds
    buffer_load_dwordx4 v21, s[48:51], s45 offen offset:2048 sc1 lds
    buffer_load_dwordx4 v21, s[48:51], s45 offen offset:3072 sc1 lds
    s_mov_b32 m0, 45056
    s_add_u32 s45, s58, 135168
    buffer_load_dwordx4 v21, s[48:51], s45 offen offset:0 sc1 lds
    buffer_load_dwordx4 v21, s[48:51], s45 offen offset:1024 sc1 lds
    buffer_load_dwordx4 v21, s[48:51], s45 offen offset:2048 sc1 lds
    buffer_load_dwordx4 v21, s[48:51], s45 offen offset:3072 sc1 lds
    s_waitcnt vmcnt(32)
    s_barrier
    s_mov_b32 m0, 49152
    s_add_u32 s45, s58, 24576
    buffer_load_dwordx4 v21, s[48:51], s45 offen offset:0 sc1 lds
    buffer_load_dwordx4 v21, s[48:51], s45 offen offset:1024 sc1 lds
    buffer_load_dwordx4 v21, s[48:51], s45 offen offset:2048 sc1 lds
    buffer_load_dwordx4 v21, s[48:51], s45 offen offset:3072 sc1 lds
    s_mov_b32 m0, 53248
    s_add_u32 s45, s58, 28672
    buffer_load_dwordx4 v21, s[48:51], s45 offen offset:0 sc1 lds
    buffer_load_dwordx4 v21, s[48:51], s45 offen offset:1024 sc1 lds
    buffer_load_dwordx4 v21, s[48:51], s45 offen offset:2048 sc1 lds
    buffer_load_dwordx4 v21, s[48:51], s45 offen offset:3072 sc1 lds
    s_mov_b32 m0, 57344
    s_add_u32 s45, s58, 139264
    buffer_load_dwordx4 v21, s[48:51], s45 offen offset:0 sc1 lds
    buffer_load_dwordx4 v21, s[48:51], s45 offen offset:1024 sc1 lds
    buffer_load_dwordx4 v21, s[48:51], s45 offen offset:2048 sc1 lds
    buffer_load_dwordx4 v21, s[48:51], s45 offen offset:3072 sc1 lds
    s_mov_b32 m0, 61440
    s_add_u32 s45, s58, 143360
    buffer_load_dwordx4 v21, s[48:51], s45 offen offset:0 sc1 lds
    buffer_load_dwordx4 v21, s[48:51], s45 offen offset:1024 sc1 lds
    buffer_load_dwordx4 v21, s[48:51], s45 offen offset:2048 sc1 lds
    buffer_load_dwordx4 v21, s[48:51], s45 offen offset:3072 sc1 lds
    s_waitcnt vmcnt(32)
    s_barrier
    s_mov_b32 m0, 0
    s_add_u32 s45, s58, 32768
    buffer_load_dwordx4 v21, s[48:51], s45 offen offset:0 sc1 lds
    buffer_load_dwordx4 v21, s[48:51], s45 offen offset:1024 sc1 lds
    buffer_load_dwordx4 v21, s[48:51], s45 offen offset:2048 sc1 lds
    buffer_load_dwordx4 v21, s[48:51], s45 offen offset:3072 sc1 lds
    s_mov_b32 m0, 4096
    s_add_u32 s45, s58, 36864
    buffer_load_dwordx4 v21, s[48:51], s45 offen offset:0 sc1 lds
    buffer_load_dwordx4 v21, s[48:51], s45 offen offset:1024 sc1 lds
    buffer_load_dwordx4 v21, s[48:51], s45 offen offset:2048 sc1 lds
    buffer_load_dwordx4 v21, s[48:51], s45 offen offset:3072 sc1 lds
    s_mov_b32 m0, 8192
    s_add_u32 s45, s58, 147456
    buffer_load_dwordx4 v21, s[48:51], s45 offen offset:0 sc1 lds
    buffer_load_dwordx4 v21, s[48:51], s45 offen offset:1024 sc1 lds
    buffer_load_dwordx4 v21, s[48:51], s45 offen offset:2048 sc1 lds
    buffer_load_dwordx4 v21, s[48:51], s45 offen offset:3072 sc1 lds
    s_mov_b32 m0, 12288
    s_add_u32 s45, s58, 151552
    buffer_load_dwordx4 v21, s[48:51], s45 offen offset:0 sc1 lds
    buffer_load_dwordx4 v21, s[48:51], s45 offen offset:1024 sc1 lds
    buffer_load_dwordx4 v21, s[48:51], s45 offen offset:2048 sc1 lds
    buffer_load_dwordx4 v21, s[48:51], s45 offen offset:3072 sc1 lds
    s_waitcnt vmcnt(32)
    s_barrier
    s_mov_b32 m0, 16384
    s_add_u32 s45, s58, 40960
    buffer_load_dwordx4 v21, s[48:51], s45 offen offset:0 sc1 lds
    buffer_load_dwordx4 v21, s[48:51], s45 offen offset:1024 sc1 lds
    buffer_load_dwordx4 v21, s[48:51], s45 offen offset:2048 sc1 lds
    buffer_load_dwordx4 v21, s[48:51], s45 offen offset:3072 sc1 lds
    s_mov_b32 m0, 20480
    s_add_u32 s45, s58, 45056
    buffer_load_dwordx4 v21, s[48:51], s45 offen offset:0 sc1 lds
    buffer_load_dwordx4 v21, s[48:51], s45 offen offset:1024 sc1 lds
    buffer_load_dwordx4 v21, s[48:51], s45 offen offset:2048 sc1 lds
    buffer_load_dwordx4 v21, s[48:51], s45 offen offset:3072 sc1 lds
    s_mov_b32 m0, 24576
    s_add_u32 s45, s58, 155648
    buffer_load_dwordx4 v21, s[48:51], s45 offen offset:0 sc1 lds
    buffer_load_dwordx4 v21, s[48:51], s45 offen offset:1024 sc1 lds
    buffer_load_dwordx4 v21, s[48:51], s45 offen offset:2048 sc1 lds
    buffer_load_dwordx4 v21, s[48:51], s45 offen offset:3072 sc1 lds
    s_mov_b32 m0, 28672
    s_add_u32 s45, s58, 159744
    buffer_load_dwordx4 v21, s[48:51], s45 offen offset:0 sc1 lds
    buffer_load_dwordx4 v21, s[48:51], s45 offen offset:1024 sc1 lds
    buffer_load_dwordx4 v21, s[48:51], s45 offen offset:2048 sc1 lds
    buffer_load_dwordx4 v21, s[48:51], s45 offen offset:3072 sc1 lds
    s_waitcnt vmcnt(32)
    s_barrier
    s_mov_b32 m0, 32768
    s_add_u32 s45, s58, 49152
    buffer_load_dwordx4 v21, s[48:51], s45 offen offset:0 sc1 lds
    buffer_load_dwordx4 v21, s[48:51], s45 offen offset:1024 sc1 lds
    buffer_load_dwordx4 v21, s[48:51], s45 offen offset:2048 sc1 lds
    buffer_load_dwordx4 v21, s[48:51], s45 offen offset:3072 sc1 lds
    s_mov_b32 m0, 36864
    s_add_u32 s45, s58, 53248
    buffer_load_dwordx4 v21, s[48:51], s45 offen offset:0 sc1 lds
    buffer_load_dwordx4 v21, s[48:51], s45 offen offset:1024 sc1 lds
    buffer_load_dwordx4 v21, s[48:51], s45 offen offset:2048 sc1 lds
    buffer_load_dwordx4 v21, s[48:51], s45 offen offset:3072 sc1 lds
    s_mov_b32 m0, 40960
    s_add_u32 s45, s58, 163840
    buffer_load_dwordx4 v21, s[48:51], s45 offen offset:0 sc1 lds
    buffer_load_dwordx4 v21, s[48:51], s45 offen offset:1024 sc1 lds
    buffer_load_dwordx4 v21, s[48:51], s45 offen offset:2048 sc1 lds
    buffer_load_dwordx4 v21, s[48:51], s45 offen offset:3072 sc1 lds
    s_mov_b32 m0, 45056
    s_add_u32 s45, s58, 167936
    buffer_load_dwordx4 v21, s[48:51], s45 offen offset:0 sc1 lds
    buffer_load_dwordx4 v21, s[48:51], s45 offen offset:1024 sc1 lds
    buffer_load_dwordx4 v21, s[48:51], s45 offen offset:2048 sc1 lds
    buffer_load_dwordx4 v21, s[48:51], s45 offen offset:3072 sc1 lds
    s_waitcnt vmcnt(32)
    s_barrier
    s_mov_b32 m0, 49152
    s_add_u32 s45, s58, 57344
    buffer_load_dwordx4 v21, s[48:51], s45 offen offset:0 sc1 lds
    buffer_load_dwordx4 v21, s[48:51], s45 offen offset:1024 sc1 lds
    buffer_load_dwordx4 v21, s[48:51], s45 offen offset:2048 sc1 lds
    buffer_load_dwordx4 v21, s[48:51], s45 offen offset:3072 sc1 lds
    s_mov_b32 m0, 53248
    s_add_u32 s45, s58, 61440
    buffer_load_dwordx4 v21, s[48:51], s45 offen offset:0 sc1 lds
    buffer_load_dwordx4 v21, s[48:51], s45 offen offset:1024 sc1 lds
    buffer_load_dwordx4 v21, s[48:51], s45 offen offset:2048 sc1 lds
    buffer_load_dwordx4 v21, s[48:51], s45 offen offset:3072 sc1 lds
    s_mov_b32 m0, 57344
    s_add_u32 s45, s58, 172032
    buffer_load_dwordx4 v21, s[48:51], s45 offen offset:0 sc1 lds
    buffer_load_dwordx4 v21, s[48:51], s45 offen offset:1024 sc1 lds
    buffer_load_dwordx4 v21, s[48:51], s45 offen offset:2048 sc1 lds
    buffer_load_dwordx4 v21, s[48:51], s45 offen offset:3072 sc1 lds
    s_mov_b32 m0, 61440
    s_add_u32 s45, s58, 176128
    buffer_load_dwordx4 v21, s[48:51], s45 offen offset:0 sc1 lds
    buffer_load_dwordx4 v21, s[48:51], s45 offen offset:1024 sc1 lds
    buffer_load_dwordx4 v21, s[48:51], s45 offen offset:2048 sc1 lds
    buffer_load_dwordx4 v21, s[48:51], s45 offen offset:3072 sc1 lds
    s_waitcnt vmcnt(32)
    s_barrier
    s_mov_b32 m0, 0
    s_add_u32 s45, s58, 65536
    buffer_load_dwordx4 v21, s[48:51], s45 offen offset:0 sc1 lds
    buffer_load_dwordx4 v21, s[48:51], s45 offen offset:1024 sc1 lds
    buffer_load_dwordx4 v21, s[48:51], s45 offen offset:2048 sc1 lds
    buffer_load_dwordx4 v21, s[48:51], s45 offen offset:3072 sc1 lds
    s_mov_b32 m0, 4096
    s_add_u32 s45, s58, 69632
    buffer_load_dwordx4 v21, s[48:51], s45 offen offset:0 sc1 lds
    buffer_load_dwordx4 v21, s[48:51], s45 offen offset:1024 sc1 lds
    buffer_load_dwordx4 v21, s[48:51], s45 offen offset:2048 sc1 lds
    buffer_load_dwordx4 v21, s[48:51], s45 offen offset:3072 sc1 lds
    s_mov_b32 m0, 8192
    s_add_u32 s45, s58, 180224
    buffer_load_dwordx4 v21, s[48:51], s45 offen offset:0 sc1 lds
    buffer_load_dwordx4 v21, s[48:51], s45 offen offset:1024 sc1 lds
    buffer_load_dwordx4 v21, s[48:51], s45 offen offset:2048 sc1 lds
    buffer_load_dwordx4 v21, s[48:51], s45 offen offset:3072 sc1 lds
    s_mov_b32 m0, 12288
    s_add_u32 s45, s58, 184320
    buffer_load_dwordx4 v21, s[48:51], s45 offen offset:0 sc1 lds
    buffer_load_dwordx4 v21, s[48:51], s45 offen offset:1024 sc1 lds
    buffer_load_dwordx4 v21, s[48:51], s45 offen offset:2048 sc1 lds
    buffer_load_dwordx4 v21, s[48:51], s45 offen offset:3072 sc1 lds
    s_waitcnt vmcnt(32)
    s_barrier
    s_mov_b32 m0, 16384
    s_add_u32 s45, s58, 73728
    buffer_load_dwordx4 v21, s[48:51], s45 offen offset:0 sc1 lds
    buffer_load_dwordx4 v21, s[48:51], s45 offen offset:1024 sc1 lds
    buffer_load_dwordx4 v21, s[48:51], s45 offen offset:2048 sc1 lds
    buffer_load_dwordx4 v21, s[48:51], s45 offen offset:3072 sc1 lds
    s_mov_b32 m0, 20480
    s_add_u32 s45, s58, 77824
    buffer_load_dwordx4 v21, s[48:51], s45 offen offset:0 sc1 lds
    buffer_load_dwordx4 v21, s[48:51], s45 offen offset:1024 sc1 lds
    buffer_load_dwordx4 v21, s[48:51], s45 offen offset:2048 sc1 lds
    buffer_load_dwordx4 v21, s[48:51], s45 offen offset:3072 sc1 lds
    s_mov_b32 m0, 24576
    s_add_u32 s45, s58, 188416
    buffer_load_dwordx4 v21, s[48:51], s45 offen offset:0 sc1 lds
    buffer_load_dwordx4 v21, s[48:51], s45 offen offset:1024 sc1 lds
    buffer_load_dwordx4 v21, s[48:51], s45 offen offset:2048 sc1 lds
    buffer_load_dwordx4 v21, s[48:51], s45 offen offset:3072 sc1 lds
    s_mov_b32 m0, 28672
    s_add_u32 s45, s58, 192512
    buffer_load_dwordx4 v21, s[48:51], s45 offen offset:0 sc1 lds
    buffer_load_dwordx4 v21, s[48:51], s45 offen offset:1024 sc1 lds
    buffer_load_dwordx4 v21, s[48:51], s45 offen offset:2048 sc1 lds
    buffer_load_dwordx4 v21, s[48:51], s45 offen offset:3072 sc1 lds
    s_waitcnt vmcnt(32)
    s_barrier
    s_mov_b32 m0, 32768
    s_add_u32 s45, s58, 81920
    buffer_load_dwordx4 v21, s[48:51], s45 offen offset:0 sc1 lds
    buffer_load_dwordx4 v21, s[48:51], s45 offen offset:1024 sc1 lds
    buffer_load_dwordx4 v21, s[48:51], s45 offen offset:2048 sc1 lds
    buffer_load_dwordx4 v21, s[48:51], s45 offen offset:3072 sc1 lds
    s_mov_b32 m0, 36864
    s_add_u32 s45, s58, 86016
    buffer_load_dwordx4 v21, s[48:51], s45 offen offset:0 sc1 lds
    buffer_load_dwordx4 v21, s[48:51], s45 offen offset:1024 sc1 lds
    buffer_load_dwordx4 v21, s[48:51], s45 offen offset:2048 sc1 lds
    buffer_load_dwordx4 v21, s[48:51], s45 offen offset:3072 sc1 lds
    s_mov_b32 m0, 40960
    s_add_u32 s45, s58, 196608
    buffer_load_dwordx4 v21, s[48:51], s45 offen offset:0 sc1 lds
    buffer_load_dwordx4 v21, s[48:51], s45 offen offset:1024 sc1 lds
    buffer_load_dwordx4 v21, s[48:51], s45 offen offset:2048 sc1 lds
    buffer_load_dwordx4 v21, s[48:51], s45 offen offset:3072 sc1 lds
    s_mov_b32 m0, 45056
    s_add_u32 s45, s58, 200704
    buffer_load_dwordx4 v21, s[48:51], s45 offen offset:0 sc1 lds
    buffer_load_dwordx4 v21, s[48:51], s45 offen offset:1024 sc1 lds
    buffer_load_dwordx4 v21, s[48:51], s45 offen offset:2048 sc1 lds
    buffer_load_dwordx4 v21, s[48:51], s45 offen offset:3072 sc1 lds
    s_waitcnt vmcnt(32)
    s_barrier
    s_mov_b32 m0, 49152
    s_add_u32 s45, s58, 90112
    buffer_load_dwordx4 v21, s[48:51], s45 offen offset:0 sc1 lds
    buffer_load_dwordx4 v21, s[48:51], s45 offen offset:1024 sc1 lds
    buffer_load_dwordx4 v21, s[48:51], s45 offen offset:2048 sc1 lds
    buffer_load_dwordx4 v21, s[48:51], s45 offen offset:3072 sc1 lds
    s_mov_b32 m0, 53248
    s_add_u32 s45, s58, 94208
    buffer_load_dwordx4 v21, s[48:51], s45 offen offset:0 sc1 lds
    buffer_load_dwordx4 v21, s[48:51], s45 offen offset:1024 sc1 lds
    buffer_load_dwordx4 v21, s[48:51], s45 offen offset:2048 sc1 lds
    buffer_load_dwordx4 v21, s[48:51], s45 offen offset:3072 sc1 lds
    s_mov_b32 m0, 57344
    s_add_u32 s45, s58, 204800
    buffer_load_dwordx4 v21, s[48:51], s45 offen offset:0 sc1 lds
    buffer_load_dwordx4 v21, s[48:51], s45 offen offset:1024 sc1 lds
    buffer_load_dwordx4 v21, s[48:51], s45 offen offset:2048 sc1 lds
    buffer_load_dwordx4 v21, s[48:51], s45 offen offset:3072 sc1 lds
    s_mov_b32 m0, 61440
    s_add_u32 s45, s58, 208896
    buffer_load_dwordx4 v21, s[48:51], s45 offen offset:0 sc1 lds
    buffer_load_dwordx4 v21, s[48:51], s45 offen offset:1024 sc1 lds
    buffer_load_dwordx4 v21, s[48:51], s45 offen offset:2048 sc1 lds
    buffer_load_dwordx4 v21, s[48:51], s45 offen offset:3072 sc1 lds
    s_waitcnt vmcnt(32)
    s_barrier
    s_mov_b32 m0, 0
    s_add_u32 s45, s58, 98304
    buffer_load_dwordx4 v21, s[48:51], s45 offen offset:0 sc1 lds
    buffer_load_dwordx4 v21, s[48:51], s45 offen offset:1024 sc1 lds
    buffer_load_dwordx4 v21, s[48:51], s45 offen offset:2048 sc1 lds
    buffer_load_dwordx4 v21, s[48:51], s45 offen offset:3072 sc1 lds
    s_mov_b32 m0, 4096
    s_add_u32 s45, s58, 102400
    buffer_load_dwordx4 v21, s[48:51], s45 offen offset:0 sc1 lds
    buffer_load_dwordx4 v21, s[48:51], s45 offen offset:1024 sc1 lds
    buffer_load_dwordx4 v21, s[48:51], s45 offen offset:2048 sc1 lds
    buffer_load_dwordx4 v21, s[48:51], s45 offen offset:3072 sc1 lds
    s_mov_b32 m0, 8192
    s_add_u32 s45, s58, 212992
    buffer_load_dwordx4 v21, s[48:51], s45 offen offset:0 sc1 lds
    buffer_load_dwordx4 v21, s[48:51], s45 offen offset:1024 sc1 lds
    buffer_load_dwordx4 v21, s[48:51], s45 offen offset:2048 sc1 lds
    buffer_load_dwordx4 v21, s[48:51], s45 offen offset:3072 sc1 lds
    s_mov_b32 m0, 12288
    s_add_u32 s45, s58, 217088
    buffer_load_dwordx4 v21, s[48:51], s45 offen offset:0 sc1 lds
    buffer_load_dwordx4 v21, s[48:51], s45 offen offset:1024 sc1 lds
    buffer_load_dwordx4 v21, s[48:51], s45 offen offset:2048 sc1 lds
    buffer_load_dwordx4 v21, s[48:51], s45 offen offset:3072 sc1 lds
    s_waitcnt vmcnt(32)
    s_barrier
    s_mov_b32 m0, 16384
    s_add_u32 s45, s58, 106496
    buffer_load_dwordx4 v21, s[48:51], s45 offen offset:0 sc1 lds
    buffer_load_dwordx4 v21, s[48:51], s45 offen offset:1024 sc1 lds
    buffer_load_dwordx4 v21, s[48:51], s45 offen offset:2048 sc1 lds
    buffer_load_dwordx4 v21, s[48:51], s45 offen offset:3072 sc1 lds
    s_mov_b32 m0, 20480
    s_add_u32 s45, s58, 110592
    buffer_load_dwordx4 v21, s[48:51], s45 offen offset:0 sc1 lds
    buffer_load_dwordx4 v21, s[48:51], s45 offen offset:1024 sc1 lds
    buffer_load_dwordx4 v21, s[48:51], s45 offen offset:2048 sc1 lds
    buffer_load_dwordx4 v21, s[48:51], s45 offen offset:3072 sc1 lds
    s_mov_b32 m0, 24576
    s_add_u32 s45, s58, 221184
    buffer_load_dwordx4 v21, s[48:51], s45 offen offset:0 sc1 lds
    buffer_load_dwordx4 v21, s[48:51], s45 offen offset:1024 sc1 lds
    buffer_load_dwordx4 v21, s[48:51], s45 offen offset:2048 sc1 lds
    buffer_load_dwordx4 v21, s[48:51], s45 offen offset:3072 sc1 lds
    s_mov_b32 m0, 28672
    s_add_u32 s45, s58, 225280
    buffer_load_dwordx4 v21, s[48:51], s45 offen offset:0 sc1 lds
    buffer_load_dwordx4 v21, s[48:51], s45 offen offset:1024 sc1 lds
    buffer_load_dwordx4 v21, s[48:51], s45 offen offset:2048 sc1 lds
    buffer_load_dwordx4 v21, s[48:51], s45 offen offset:3072 sc1 lds
    s_waitcnt vmcnt(32)
    s_barrier
    s_waitcnt vmcnt(16)
    s_barrier
    s_waitcnt vmcnt(0)
    s_barrier
    s_endpgm
L_RW:
    s_sub_u32 s42, s24, 4
    v_bfe_u32 v3, v1, 4, 1
    v_lshlrev_b32 v3, 2, v3
    v_and_b32 v4, 7, v1
    v_xor_b32 v3, v3, v4
    v_lshlrev_b32 v3, 4, v3
    v_lshrrev_b32 v4, 3, v1
    v_lshl_add_u32 v2, v4, 10, v3
    s_lshl_b32 s40, s28, 7
    v_add_u32 v2, s40, v2
    s_lshl_b32 s43, s42, 13
    s_add_u32 s43, s43, 65536
    s_lshl_b32 s44, s42, 16
    s_mov_b32 s36, s12
    s_mov_b32 s37, s13
    s_mov_b32 s38, 0x80000
    s_mov_b32 s39, 0x20000
    s_add_u32 m0, s43, 0
    s_add_u32 s41, s44, 0
    buffer_load_dwordx4 v2, s[36:39], s41 offen lds
    s_add_u32 m0, s43, 1024
    s_add_u32 s41, s44, 8192
    buffer_load_dwordx4 v2, s[36:39], s41 offen lds
    s_add_u32 m0, s43, 2048
    s_add_u32 s41, s44, 16384
    buffer_load_dwordx4 v2, s[36:39], s41 offen lds
    s_add_u32 m0, s43, 3072
    s_add_u32 s41, s44, 24576
    buffer_load_dwordx4 v2, s[36:39], s41 offen lds
    s_add_u32 m0, s43, 4096
    s_add_u32 s41, s44, 32768
    buffer_load_dwordx4 v2, s[36:39], s41 offen lds
    s_add_u32 m0, s43, 5120
    s_add_u32 s41, s44, 40960
    buffer_load_dwordx4 v2, s[36:39], s41 offen lds
    s_add_u32 m0, s43, 6144
    s_add_u32 s41, s44, 49152
    buffer_load_dwordx4 v2, s[36:39], s41 offen lds
    s_add_u32 m0, s43, 7168
    s_add_u32 s41, s44, 57344
    buffer_load_dwordx4 v2, s[36:39], s41 offen lds
    s_add_u32 m0, s43, 16384
    s_add_u32 s41, s44, 131072
    buffer_load_dwordx4 v2, s[36:39], s41 offen lds
    s_add_u32 m0, s43, 17408
    s_add_u32 s41, s44, 139264
    buffer_load_dwordx4 v2, s[36:39], s41 offen lds
    s_add_u32 m0, s43, 18432
    s_add_u32 s41, s44, 147456
    buffer_load_dwordx4 v2, s[36:39], s41 offen lds
    s_add_u32 m0, s43, 19456
    s_add_u32 s41, s44, 155648
    buffer_load_dwordx4 v2, s[36:39], s41 offen lds
    s_add_u32 m0, s43, 20480
    s_add_u32 s41, s44, 163840
    buffer_load_dwordx4 v2, s[36:39], s41 offen lds
    s_add_u32 m0, s43, 21504
    s_add_u32 s41, s44, 172032
    buffer_load_dwordx4 v2, s[36:39], s41 offen lds
    s_add_u32 m0, s43, 22528
    s_add_u32 s41, s44, 180224
    buffer_load_dwordx4 v2, s[36:39], s41 offen lds
    s_add_u32 m0, s43, 23552
    s_add_u32 s41, s44, 188416
    buffer_load_dwordx4 v2, s[36:39], s41 offen lds
    s_add_u32 m0, s43, 32768
    s_add_u32 s41, s44, 262144
    buffer_load_dwordx4 v2, s[36:39], s41 offen lds
    s_add_u32 m0, s43, 33792
    s_add_u32 s41, s44, 270336
    buffer_load_dwordx4 v2, s[36:39], s41 offen lds
    s_add_u32 m0, s43, 34816
    s_add_u32 s41, s44, 278528
    buffer_load_dwordx4 v2, s[36:39], s41 offen lds
    s_add_u32 m0, s43, 35840
    s_add_u32 s41, s44, 286720
    buffer_load_dwordx4 v2, s[36:39], s41 offen lds
    s_add_u32 m0, s43, 36864
    s_add_u32 s41, s44, 294912
    buffer_load_dwordx4 v2, s[36:39], s41 offen lds
    s_add_u32 m0, s43, 37888
    s_add_u32 s41, s44, 303104
    buffer_load_dwordx4 v2, s[36:39], s41 offen lds
    s_add_u32 m0, s43, 38912
    s_add_u32 s41, s44, 311296
    buffer_load_dwordx4 v2, s[36:39], s41 offen lds
    s_add_u32 m0, s43, 39936
    s_add_u32 s41, s44, 319488
    buffer_load_dwordx4 v2, s[36:39], s41 offen lds
    v_lshrrev_b32 v3, 2, v1
    v_mul_u32_u24 v5, 3072, v3
    v_and_b32 v3, 3, v1
    v_lshl_add_u32 v5, v3, 4, v5
    s_lshl_b32 s40, s30, 6
    v_add_u32 v5, s40, v5
    v_lshrrev_b32 v3, 4, v1
    v_mul_u32_u24 v6, 3584, v3
    v_lshlrev_b32 v3, 2, v3
    v_and_b32 v4, 15, v1
    v_xor_b32 v3, v3, v4
    v_lshl_add_u32 v6, v3, 4, v6
    s_lshl_b32 s40, s32, 8
    v_add_u32 v6, s40, v6
    s_mul_i32 s45, s42, 98304
    s_lshl_b32 s46, s42, 11
    s_add_u32 s46, s46, 65536
    s_mul_i32 s47, s42, 114688
    s_add_u32 s48, s22, 0x140000
    s_addc_u32 s49, s23, 0
    s_mov_b32 s50, 0x30000
    s_mov_b32 s51, 0x20000
    v_lshrrev_b32 v3, 2, v1
    v_mul_u32_u24 v7, 384, v3
    v_and_b32 v3, 3, v1
    v_lshl_add_u32 v7, v3, 4, v7
    s_and_b32 s40, s30, 1
    s_lshl_b32 s40, s40, 6
    v_add_u32 v7, s40, v7
    s_mul_i32 s52, s42, 12288
    s_mov_b64 s[54:55], 0
    s_waitcnt vmcnt(16)
    s_barrier
    s_add_u32 m0, s43, 49152
    s_add_u32 s41, s44, 393216
    buffer_load_dwordx4 v2, s[36:39], s41 offen lds
    s_add_u32 m0, s43, 50176
    s_add_u32 s41, s44, 401408
    buffer_load_dwordx4 v2, s[36:39], s41 offen lds
    s_add_u32 m0, s43, 51200
    s_add_u32 s41, s44, 409600
    buffer_load_dwordx4 v2, s[36:39], s41 offen lds
    s_add_u32 m0, s43, 52224
    s_add_u32 s41, s44, 417792
    buffer_load_dwordx4 v2, s[36:39], s41 offen lds
    s_add_u32 m0, s43, 53248
    s_add_u32 s41, s44, 425984
    buffer_load_dwordx4 v2, s[36:39], s41 offen lds
    s_add_u32 m0, s43, 54272
    s_add_u32 s41, s44, 434176
    buffer_load_dwordx4 v2, s[36:39], s41 offen lds
    s_add_u32 m0, s43, 55296
    s_add_u32 s41, s44, 442368
    buffer_load_dwordx4 v2, s[36:39], s41 offen lds
    s_add_u32 m0, s43, 56320
    s_add_u32 s41, s44, 450560
    buffer_load_dwordx4 v2, s[36:39], s41 offen lds
    s_waitcnt vmcnt(16)
    s_barrier
    s_mov_b32 s36, s6
    s_mov_b32 s37, s7
    s_mov_b32 s38, 0x180000
    s_mov_b32 s39, 0x20000
    s_bfe_u32 s41, s54, 0x80000
    s_cmp_eq_u32 s41, 0xff
    s_cbranch_scc1 L_W_wqa0_34
    s_add_u32 m0, s46, 0
    s_add_u32 s41, s45, 0
    buffer_load_dwordx4 v5, s[36:39], s41 offen lds
    s_add_u32 m0, s46, 1024
    s_add_u32 s41, s45, 49152
    buffer_load_dwordx4 v5, s[36:39], s41 offen lds
    s_add_u32 m0, s46, 4096
    s_add_u32 s41, s45, 1024
    buffer_load_dwordx4 v5, s[36:39], s41 offen lds
    s_add_u32 m0, s46, 5120
    s_add_u32 s41, s45, 50176
    buffer_load_dwordx4 v5, s[36:39], s41 offen lds
    s_add_u32 m0, s46, 8192
    s_add_u32 s41, s45, 2048
    buffer_load_dwordx4 v5, s[36:39], s41 offen lds
    s_add_u32 m0, s46, 9216
    s_add_u32 s41, s45, 51200
    buffer_load_dwordx4 v5, s[36:39], s41 offen lds
    s_branch L_W_wqb0_35
L_W_wqa0_34:
    s_add_u32 m0, s46, 0
    s_add_u32 s41, s52, 0
    buffer_load_dwordx4 v7, s[48:51], s41 offen sc1 lds
    s_add_u32 m0, s46, 1024
    s_add_u32 s41, s52, 6144
    buffer_load_dwordx4 v7, s[48:51], s41 offen sc1 lds
    s_add_u32 m0, s46, 4096
    s_add_u32 s41, s52, 128
    buffer_load_dwordx4 v7, s[48:51], s41 offen sc1 lds
    s_add_u32 m0, s46, 5120
    s_add_u32 s41, s52, 6272
    buffer_load_dwordx4 v7, s[48:51], s41 offen sc1 lds
    s_add_u32 m0, s46, 8192
    s_add_u32 s41, s52, 256
    buffer_load_dwordx4 v7, s[48:51], s41 offen sc1 lds
    s_add_u32 m0, s46, 9216
    s_add_u32 s41, s52, 6400
    buffer_load_dwordx4 v7, s[48:51], s41 offen sc1 lds
L_W_wqb0_35:
    s_waitcnt vmcnt(14)
    s_barrier
    s_lshr_b32 s40, s30, 1
    s_cmp_eq_u32 s40, 3
    s_cbranch_scc0 L_W_wqm0_36
    v_mov_b32 v3, 0x20f00
    ds_read_b64 v[8:9], v3
    s_waitcnt lgkmcnt(0)
    v_readfirstlane_b32 s54, v8
    v_readfirstlane_b32 s55, v9
L_W_wqm0_36:
    s_bfe_u32 s41, s54, 0x80008
    s_cmp_eq_u32 s41, 0xff
    s_cbranch_scc1 L_W_wqa1_37
    s_add_u32 m0, s46, 16384
    s_add_u32 s41, s45, 196608
    buffer_load_dwordx4 v5, s[36:39], s41 offen lds
    s_add_u32 m0, s46, 17408
    s_add_u32 s41, s45, 245760
    buffer_load_dwordx4 v5, s[36:39], s41 offen lds
    s_add_u32 m0, s46, 20480
    s_add_u32 s41, s45, 197632
    buffer_load_dwordx4 v5, s[36:39], s41 offen lds
    s_add_u32 m0, s46, 21504
    s_add_u32 s41, s45, 246784
    buffer_load_dwordx4 v5, s[36:39], s41 offen lds
    s_add_u32 m0, s46, 24576
    s_add_u32 s41, s45, 198656
    buffer_load_dwordx4 v5, s[36:39], s41 offen lds
    s_add_u32 m0, s46, 25600
    s_add_u32 s41, s45, 247808
    buffer_load_dwordx4 v5, s[36:39], s41 offen lds
    s_branch L_W_wqb1_38
L_W_wqa1_37:
    s_add_u32 m0, s46, 16384
    s_add_u32 s41, s52, 24576
    buffer_load_dwordx4 v7, s[48:51], s41 offen sc1 lds
    s_add_u32 m0, s46, 17408
    s_add_u32 s41, s52, 30720
    buffer_load_dwordx4 v7, s[48:51], s41 offen sc1 lds
    s_add_u32 m0, s46, 20480
    s_add_u32 s41, s52, 24704
    buffer_load_dwordx4 v7, s[48:51], s41 offen sc1 lds
    s_add_u32 m0, s46, 21504
    s_add_u32 s41, s52, 30848
    buffer_load_dwordx4 v7, s[48:51], s41 offen sc1 lds
    s_add_u32 m0, s46, 24576
    s_add_u32 s41, s52, 24832
    buffer_load_dwordx4 v7, s[48:51], s41 offen sc1 lds
    s_add_u32 m0, s46, 25600
    s_add_u32 s41, s52, 30976
    buffer_load_dwordx4 v7, s[48:51], s41 offen sc1 lds
L_W_wqb1_38:
    s_waitcnt vmcnt(12)
    s_barrier
    s_bfe_u32 s41, s54, 0x80010
    s_cmp_eq_u32 s41, 0xff
    s_cbranch_scc1 L_W_wqa2_39
    s_add_u32 m0, s46, 32768
    s_add_u32 s41, s45, 393216
    buffer_load_dwordx4 v5, s[36:39], s41 offen lds
    s_add_u32 m0, s46, 33792
    s_add_u32 s41, s45, 442368
    buffer_load_dwordx4 v5, s[36:39], s41 offen lds
    s_add_u32 m0, s46, 36864
    s_add_u32 s41, s45, 394240
    buffer_load_dwordx4 v5, s[36:39], s41 offen lds
    s_add_u32 m0, s46, 37888
    s_add_u32 s41, s45, 443392
    buffer_load_dwordx4 v5, s[36:39], s41 offen lds
    s_add_u32 m0, s46, 40960
    s_add_u32 s41, s45, 395264
    buffer_load_dwordx4 v5, s[36:39], s41 offen lds
    s_add_u32 m0, s46, 41984
    s_add_u32 s41, s45, 444416
    buffer_load_dwordx4 v5, s[36:39], s41 offen lds
    s_branch L_W_wqb2_40
L_W_wqa2_39:
    s_add_u32 m0, s46, 32768
    s_add_u32 s41, s52, 49152
    buffer_load_dwordx4 v7, s[48:51], s41 offen sc1 lds
    s_add_u32 m0, s46, 33792
    s_add_u32 s41, s52, 55296
    buffer_load_dwordx4 v7, s[48:51], s41 offen sc1 lds
    s_add_u32 m0, s46, 36864
    s_add_u32 s41, s52, 49280
    buffer_load_dwordx4 v7, s[48:51], s41 offen sc1 lds
    s_add_u32 m0, s46, 37888
    s_add_u32 s41, s52, 55424
    buffer_load_dwordx4 v7, s[48:51], s41 offen sc1 lds
    s_add_u32 m0, s46, 40960
    s_add_u32 s41, s52, 49408
    buffer_load_dwordx4 v7, s[48:51], s41 offen sc1 lds
    s_add_u32 m0, s46, 41984
    s_add_u32 s41, s52, 55552
    buffer_load_dwordx4 v7, s[48:51], s41 offen sc1 lds
L_W_wqb2_40:
    s_barrier
    s_bfe_u32 s41, s54, 0x80018
    s_cmp_eq_u32 s41, 0xff
    s_cbranch_scc1 L_W_wqa3_41
    s_add_u32 m0, s46, 49152
    s_add_u32 s41, s45, 589824
    buffer_load_dwordx4 v5, s[36:39], s41 offen lds
    s_add_u32 m0, s46, 50176
    s_add_u32 s41, s45, 638976
    buffer_load_dwordx4 v5, s[36:39], s41 offen lds
    s_add_u32 m0, s46, 53248
    s_add_u32 s41, s45, 590848
    buffer_load_dwordx4 v5, s[36:39], s41 offen lds
    s_add_u32 m0, s46, 54272
    s_add_u32 s41, s45, 640000
    buffer_load_dwordx4 v5, s[36:39], s41 offen lds
    s_add_u32 m0, s46, 57344
    s_add_u32 s41, s45, 591872
    buffer_load_dwordx4 v5, s[36:39], s41 offen lds
    s_add_u32 m0, s46, 58368
    s_add_u32 s41, s45, 641024
    buffer_load_dwordx4 v5, s[36:39], s41 offen lds
    s_branch L_W_wqb3_42
L_W_wqa3_41:
    s_add_u32 m0, s46, 49152
    s_add_u32 s41, s52, 73728
    buffer_load_dwordx4 v7, s[48:51], s41 offen sc1 lds
    s_add_u32 m0, s46, 50176
    s_add_u32 s41, s52, 79872
    buffer_load_dwordx4 v7, s[48:51], s41 offen sc1 lds
    s_add_u32 m0, s46, 53248
    s_add_u32 s41, s52, 73856
    buffer_load_dwordx4 v7, s[48:51], s41 offen sc1 lds
    s_add_u32 m0, s46, 54272
    s_add_u32 s41, s52, 80000
    buffer_load_dwordx4 v7, s[48:51], s41 offen sc1 lds
    s_add_u32 m0, s46, 57344
    s_add_u32 s41, s52, 73984
    buffer_load_dwordx4 v7, s[48:51], s41 offen sc1 lds
    s_add_u32 m0, s46, 58368
    s_add_u32 s41, s52, 80128
    buffer_load_dwordx4 v7, s[48:51], s41 offen sc1 lds
L_W_wqb3_42:
    s_waitcnt vmcnt(18)
    s_barrier
    s_waitcnt vmcnt(12)
    s_barrier
    s_bfe_u32 s41, s55, 0x80000
    s_cmp_eq_u32 s41, 0xff
    s_cbranch_scc1 L_W_wqa4_43
    s_add_u32 m0, s46, 0
    s_add_u32 s41, s45, 786432
    buffer_load_dwordx4 v5, s[36:39], s41 offen lds
    s_add_u32 m0, s46, 1024
    s_add_u32 s41, s45, 835584
    buffer_load_dwordx4 v5, s[36:39], s41 offen lds
    s_add_u32 m0, s46, 4096
    s_add_u32 s41, s45, 787456
    buffer_load_dwordx4 v5, s[36:39], s41 offen lds
    s_add_u32 m0, s46, 5120
    s_add_u32 s41, s45, 836608
    buffer_load_dwordx4 v5, s[36:39], s41 offen lds
    s_add_u32 m0, s46, 8192
    s_add_u32 s41, s45, 788480
    buffer_load_dwordx4 v5, s[36:39], s41 offen lds
    s_add_u32 m0, s46, 9216
    s_add_u32 s41, s45, 837632
    buffer_load_dwordx4 v5, s[36:39], s41 offen lds
    s_branch L_W_wqb4_44
L_W_wqa4_43:
    s_add_u32 m0, s46, 0
    s_add_u32 s41, s52, 98304
    buffer_load_dwordx4 v7, s[48:51], s41 offen sc1 lds
    s_add_u32 m0, s46, 1024
    s_add_u32 s41, s52, 104448
    buffer_load_dwordx4 v7, s[48:51], s41 offen sc1 lds
    s_add_u32 m0, s46, 4096
    s_add_u32 s41, s52, 98432
    buffer_load_dwordx4 v7, s[48:51], s41 offen sc1 lds
    s_add_u32 m0, s46, 5120
    s_add_u32 s41, s52, 104576
    buffer_load_dwordx4 v7, s[48:51], s41 offen sc1 lds
    s_add_u32 m0, s46, 8192
    s_add_u32 s41, s52, 98560
    buffer_load_dwordx4 v7, s[48:51], s41 offen sc1 lds
    s_add_u32 m0, s46, 9216
    s_add_u32 s41, s52, 104704
    buffer_load_dwordx4 v7, s[48:51], s41 offen sc1 lds
L_W_wqb4_44:
    s_waitcnt vmcnt(12)
    s_barrier
    s_bfe_u32 s41, s55, 0x80008
    s_cmp_eq_u32 s41, 0xff
    s_cbranch_scc1 L_W_wqa5_45
    s_add_u32 m0, s46, 16384
    s_add_u32 s41, s45, 983040
    buffer_load_dwordx4 v5, s[36:39], s41 offen lds
    s_add_u32 m0, s46, 17408
    s_add_u32 s41, s45, 1032192
    buffer_load_dwordx4 v5, s[36:39], s41 offen lds
    s_add_u32 m0, s46, 20480
    s_add_u32 s41, s45, 984064
    buffer_load_dwordx4 v5, s[36:39], s41 offen lds
    s_add_u32 m0, s46, 21504
    s_add_u32 s41, s45, 1033216
    buffer_load_dwordx4 v5, s[36:39], s41 offen lds
    s_add_u32 m0, s46, 24576
    s_add_u32 s41, s45, 985088
    buffer_load_dwordx4 v5, s[36:39], s41 offen lds
    s_add_u32 m0, s46, 25600
    s_add_u32 s41, s45, 1034240
    buffer_load_dwordx4 v5, s[36:39], s41 offen lds
    s_branch L_W_wqb5_46
L_W_wqa5_45:
    s_add_u32 m0, s46, 16384
    s_add_u32 s41, s52, 122880
    buffer_load_dwordx4 v7, s[48:51], s41 offen sc1 lds
    s_add_u32 m0, s46, 17408
    s_add_u32 s41, s52, 129024
    buffer_load_dwordx4 v7, s[48:51], s41 offen sc1 lds
    s_add_u32 m0, s46, 20480
    s_add_u32 s41, s52, 123008
    buffer_load_dwordx4 v7, s[48:51], s41 offen sc1 lds
    s_add_u32 m0, s46, 21504
    s_add_u32 s41, s52, 129152
    buffer_load_dwordx4 v7, s[48:51], s41 offen sc1 lds
    s_add_u32 m0, s46, 24576
    s_add_u32 s41, s52, 123136
    buffer_load_dwordx4 v7, s[48:51], s41 offen sc1 lds
    s_add_u32 m0, s46, 25600
    s_add_u32 s41, s52, 129280
    buffer_load_dwordx4 v7, s[48:51], s41 offen sc1 lds
L_W_wqb5_46:
    s_waitcnt vmcnt(12)
    s_barrier
    s_bfe_u32 s41, s55, 0x80010
    s_cmp_eq_u32 s41, 0xff
    s_cbranch_scc1 L_W_wqa6_47
    s_add_u32 m0, s46, 32768
    s_add_u32 s41, s45, 1179648
    buffer_load_dwordx4 v5, s[36:39], s41 offen lds
    s_add_u32 m0, s46, 33792
    s_add_u32 s41, s45, 1228800
    buffer_load_dwordx4 v5, s[36:39], s41 offen lds
    s_add_u32 m0, s46, 36864
    s_add_u32 s41, s45, 1180672
    buffer_load_dwordx4 v5, s[36:39], s41 offen lds
    s_add_u32 m0, s46, 37888
    s_add_u32 s41, s45, 1229824
    buffer_load_dwordx4 v5, s[36:39], s41 offen lds
    s_add_u32 m0, s46, 40960
    s_add_u32 s41, s45, 1181696
    buffer_load_dwordx4 v5, s[36:39], s41 offen lds
    s_add_u32 m0, s46, 41984
    s_add_u32 s41, s45, 1230848
    buffer_load_dwordx4 v5, s[36:39], s41 offen lds
    s_branch L_W_wqb6_48
L_W_wqa6_47:
    s_add_u32 m0, s46, 32768
    s_add_u32 s41, s52, 147456
    buffer_load_dwordx4 v7, s[48:51], s41 offen sc1 lds
    s_add_u32 m0, s46, 33792
    s_add_u32 s41, s52, 153600
    buffer_load_dwordx4 v7, s[48:51], s41 offen sc1 lds
    s_add_u32 m0, s46, 36864
    s_add_u32 s41, s52, 147584
    buffer_load_dwordx4 v7, s[48:51], s41 offen sc1 lds
    s_add_u32 m0, s46, 37888
    s_add_u32 s41, s52, 153728
    buffer_load_dwordx4 v7, s[48:51], s41 offen sc1 lds
    s_add_u32 m0, s46, 40960
    s_add_u32 s41, s52, 147712
    buffer_load_dwordx4 v7, s[48:51], s41 offen sc1 lds
    s_add_u32 m0, s46, 41984
    s_add_u32 s41, s52, 153856
    buffer_load_dwordx4 v7, s[48:51], s41 offen sc1 lds
L_W_wqb6_48:
    s_waitcnt vmcnt(12)
    s_barrier
    s_bfe_u32 s41, s55, 0x80018
    s_cmp_eq_u32 s41, 0xff
    s_cbranch_scc1 L_W_wqa7_49
    s_add_u32 m0, s46, 49152
    s_add_u32 s41, s45, 1376256
    buffer_load_dwordx4 v5, s[36:39], s41 offen lds
    s_add_u32 m0, s46, 50176
    s_add_u32 s41, s45, 1425408
    buffer_load_dwordx4 v5, s[36:39], s41 offen lds
    s_add_u32 m0, s46, 53248
    s_add_u32 s41, s45, 1377280
    buffer_load_dwordx4 v5, s[36:39], s41 offen lds
    s_add_u32 m0, s46, 54272
    s_add_u32 s41, s45, 1426432
    buffer_load_dwordx4 v5, s[36:39], s41 offen lds
    s_add_u32 m0, s46, 57344
    s_add_u32 s41, s45, 1378304
    buffer_load_dwordx4 v5, s[36:39], s41 offen lds
    s_add_u32 m0, s46, 58368
    s_add_u32 s41, s45, 1427456
    buffer_load_dwordx4 v5, s[36:39], s41 offen lds
    s_branch L_W_wqb7_50
L_W_wqa7_49:
    s_add_u32 m0, s46, 49152
    s_add_u32 s41, s52, 172032
    buffer_load_dwordx4 v7, s[48:51], s41 offen sc1 lds
    s_add_u32 m0, s46, 50176
    s_add_u32 s41, s52, 178176
    buffer_load_dwordx4 v7, s[48:51], s41 offen sc1 lds
    s_add_u32 m0, s46, 53248
    s_add_u32 s41, s52, 172160
    buffer_load_dwordx4 v7, s[48:51], s41 offen sc1 lds
    s_add_u32 m0, s46, 54272
    s_add_u32 s41, s52, 178304
    buffer_load_dwordx4 v7, s[48:51], s41 offen sc1 lds
    s_add_u32 m0, s46, 57344
    s_add_u32 s41, s52, 172288
    buffer_load_dwordx4 v7, s[48:51], s41 offen sc1 lds
    s_add_u32 m0, s46, 58368
    s_add_u32 s41, s52, 178432
    buffer_load_dwordx4 v7, s[48:51], s41 offen sc1 lds
L_W_wqb7_50:
    s_waitcnt vmcnt(12)
    s_barrier
    s_mov_b32 s36, s14
    s_mov_b32 s37, s15
    s_mov_b32 s38, 0x80000
    s_mov_b32 s39, 0x20000
    s_add_u32 m0, s43, 0
    s_add_u32 s41, s44, 0
    buffer_load_dwordx4 v2, s[36:39], s41 offen lds
    s_add_u32 m0, s43, 1024
    s_add_u32 s41, s44, 8192
    buffer_load_dwordx4 v2, s[36:39], s41 offen lds
    s_add_u32 m0, s43, 2048
    s_add_u32 s41, s44, 16384
    buffer_load_dwordx4 v2, s[36:39], s41 offen lds
    s_add_u32 m0, s43, 3072
    s_add_u32 s41, s44, 24576
    buffer_load_dwordx4 v2, s[36:39], s41 offen lds
    s_add_u32 m0, s43, 4096
    s_add_u32 s41, s44, 32768
    buffer_load_dwordx4 v2, s[36:39], s41 offen lds
    s_add_u32 m0, s43, 5120
    s_add_u32 s41, s44, 40960
    buffer_load_dwordx4 v2, s[36:39], s41 offen lds
    s_add_u32 m0, s43, 6144
    s_add_u32 s41, s44, 49152
    buffer_load_dwordx4 v2, s[36:39], s41 offen lds
    s_add_u32 m0, s43, 7168
    s_add_u32 s41, s44, 57344
    buffer_load_dwordx4 v2, s[36:39], s41 offen lds
    s_waitcnt vmcnt(14)
    s_barrier
    s_add_u32 m0, s43, 16384
    s_add_u32 s41, s44, 131072
    buffer_load_dwordx4 v2, s[36:39], s41 offen lds
    s_add_u32 m0, s43, 17408
    s_add_u32 s41, s44, 139264
    buffer_load_dwordx4 v2, s[36:39], s41 offen lds
    s_add_u32 m0, s43, 18432
    s_add_u32 s41, s44, 147456
    buffer_load_dwordx4 v2, s[36:39], s41 offen lds
    s_add_u32 m0, s43, 19456
    s_add_u32 s41, s44, 155648
    buffer_load_dwordx4 v2, s[36:39], s41 offen lds
    s_add_u32 m0, s43, 20480
    s_add_u32 s41, s44, 163840
    buffer_load_dwordx4 v2, s[36:39], s41 offen lds
    s_add_u32 m0, s43, 21504
    s_add_u32 s41, s44, 172032
    buffer_load_dwordx4 v2, s[36:39], s41 offen lds
    s_add_u32 m0, s43, 22528
    s_add_u32 s41, s44, 180224
    buffer_load_dwordx4 v2, s[36:39], s41 offen lds
    s_add_u32 m0, s43, 23552
    s_add_u32 s41, s44, 188416
    buffer_load_dwordx4 v2, s[36:39], s41 offen lds
    s_waitcnt vmcnt(16)
    s_barrier
    s_add_u32 m0, s43, 32768
    s_add_u32 s41, s44, 262144
    buffer_load_dwordx4 v2, s[36:39], s41 offen lds
    s_add_u32 m0, s43, 33792
    s_add_u32 s41, s44, 270336
    buffer_load_dwordx4 v2, s[36:39], s41 offen lds
    s_add_u32 m0, s43, 34816
    s_add_u32 s41, s44, 278528
    buffer_load_dwordx4 v2, s[36:39], s41 offen lds
    s_add_u32 m0, s43, 35840
    s_add_u32 s41, s44, 286720
    buffer_load_dwordx4 v2, s[36:39], s41 offen lds
    s_add_u32 m0, s43, 36864
    s_add_u32 s41, s44, 294912
    buffer_load_dwordx4 v2, s[36:39], s41 offen lds
    s_add_u32 m0, s43, 37888
    s_add_u32 s41, s44, 303104
    buffer_load_dwordx4 v2, s[36:39], s41 offen lds
    s_add_u32 m0, s43, 38912
    s_add_u32 s41, s44, 311296
    buffer_load_dwordx4 v2, s[36:39], s41 offen lds
    s_add_u32 m0, s43, 39936
    s_add_u32 s41, s44, 319488
    buffer_load_dwordx4 v2, s[36:39], s41 offen lds
    s_barrier
    s_add_u32 m0, s43, 49152
    s_add_u32 s41, s44, 393216
    buffer_load_dwordx4 v2, s[36:39], s41 offen lds
    s_add_u32 m0, s43, 50176
    s_add_u32 s41, s44, 401408
    buffer_load_dwordx4 v2, s[36:39], s41 offen lds
    s_add_u32 m0, s43, 51200
    s_add_u32 s41, s44, 409600
    buffer_load_dwordx4 v2, s[36:39], s41 offen lds
    s_add_u32 m0, s43, 52224
    s_add_u32 s41, s44, 417792
    buffer_load_dwordx4 v2, s[36:39], s41 offen lds
    s_add_u32 m0, s43, 53248
    s_add_u32 s41, s44, 425984
    buffer_load_dwordx4 v2, s[36:39], s41 offen lds
    s_add_u32 m0, s43, 54272
    s_add_u32 s41, s44, 434176
    buffer_load_dwordx4 v2, s[36:39], s41 offen lds
    s_add_u32 m0, s43, 55296
    s_add_u32 s41, s44, 442368
    buffer_load_dwordx4 v2, s[36:39], s41 offen lds
    s_add_u32 m0, s43, 56320
    s_add_u32 s41, s44, 450560
    buffer_load_dwordx4 v2, s[36:39], s41 offen lds
    s_waitcnt vmcnt(24)
    s_barrier
    s_cmp_lg_u32 s33, 0
    s_cbranch_scc1 L_W_sp_51
    s_waitcnt vmcnt(16)
    s_barrier
    s_mov_b32 s36, s16
    s_mov_b32 s37, s17
    s_mov_b32 s38, 0x1c0000
    s_mov_b32 s39, 0x20000
    s_add_u32 m0, s43, 0
    s_add_u32 s41, s47, 0
    buffer_load_dwordx4 v6, s[36:39], s41 offen lds
    s_add_u32 m0, s43, 1024
    s_add_u32 s41, s47, 14336
    buffer_load_dwordx4 v6, s[36:39], s41 offen lds
    s_add_u32 m0, s43, 2048
    s_add_u32 s41, s47, 28672
    buffer_load_dwordx4 v6, s[36:39], s41 offen lds
    s_add_u32 m0, s43, 3072
    s_add_u32 s41, s47, 43008
    buffer_load_dwordx4 v6, s[36:39], s41 offen lds
    s_add_u32 m0, s43, 4096
    s_add_u32 s41, s47, 57344
    buffer_load_dwordx4 v6, s[36:39], s41 offen lds
    s_add_u32 m0, s43, 5120
    s_add_u32 s41, s47, 71680
    buffer_load_dwordx4 v6, s[36:39], s41 offen lds
    s_add_u32 m0, s43, 6144
    s_add_u32 s41, s47, 86016
    buffer_load_dwordx4 v6, s[36:39], s41 offen lds
    s_add_u32 m0, s43, 7168
    s_add_u32 s41, s47, 100352
    buffer_load_dwordx4 v6, s[36:39], s41 offen lds
    s_waitcnt vmcnt(16)
    s_barrier
    s_add_u32 m0, s43, 16384
    s_add_u32 s41, s47, 229376
    buffer_load_dwordx4 v6, s[36:39], s41 offen lds
    s_add_u32 m0, s43, 17408
    s_add_u32 s41, s47, 243712
    buffer_load_dwordx4 v6, s[36:39], s41 offen lds
    s_add_u32 m0, s43, 18432
    s_add_u32 s41, s47, 258048
    buffer_load_dwordx4 v6, s[36:39], s41 offen lds
    s_add_u32 m0, s43, 19456
    s_add_u32 s41, s47, 272384
    buffer_load_dwordx4 v6, s[36:39], s41 offen lds
    s_add_u32 m0, s43, 20480
    s_add_u32 s41, s47, 286720
    buffer_load_dwordx4 v6, s[36:39], s41 offen lds
    s_add_u32 m0, s43, 21504
    s_add_u32 s41, s47, 301056
    buffer_load_dwordx4 v6, s[36:39], s41 offen lds
    s_add_u32 m0, s43, 22528
    s_add_u32 s41, s47, 315392
    buffer_load_dwordx4 v6, s[36:39], s41 offen lds
    s_add_u32 m0, s43, 23552
    s_add_u32 s41, s47, 329728
    buffer_load_dwordx4 v6, s[36:39], s41 offen lds
    s_waitcnt vmcnt(16)
    s_barrier
    s_add_u32 m0, s43, 32768
    s_add_u32 s41, s47, 458752
    buffer_load_dwordx4 v6, s[36:39], s41 offen lds
    s_add_u32 m0, s43, 33792
    s_add_u32 s41, s47, 473088
    buffer_load_dwordx4 v6, s[36:39], s41 offen lds
    s_add_u32 m0, s43, 34816
    s_add_u32 s41, s47, 487424
    buffer_load_dwordx4 v6, s[36:39], s41 offen lds
    s_add_u32 m0, s43, 35840
    s_add_u32 s41, s47, 501760
    buffer_load_dwordx4 v6, s[36:39], s41 offen lds
    s_add_u32 m0, s43, 36864
    s_add_u32 s41, s47, 516096
    buffer_load_dwordx4 v6, s[36:39], s41 offen lds
    s_add_u32 m0, s43, 37888
    s_add_u32 s41, s47, 530432
    buffer_load_dwordx4 v6, s[36:39], s41 offen lds
    s_add_u32 m0, s43, 38912
    s_add_u32 s41, s47, 544768
    buffer_load_dwordx4 v6, s[36:39], s41 offen lds
    s_add_u32 m0, s43, 39936
    s_add_u32 s41, s47, 559104
    buffer_load_dwordx4 v6, s[36:39], s41 offen lds
    s_barrier
    s_waitcnt vmcnt(16)
    s_barrier
    s_add_u32 m0, s43, 49152
    s_add_u32 s41, s47, 688128
    buffer_load_dwordx4 v6, s[36:39], s41 offen lds
    s_add_u32 m0, s43, 50176
    s_add_u32 s41, s47, 702464
    buffer_load_dwordx4 v6, s[36:39], s41 offen lds
    s_add_u32 m0, s43, 51200
    s_add_u32 s41, s47, 716800
    buffer_load_dwordx4 v6, s[36:39], s41 offen lds
    s_add_u32 m0, s43, 52224
    s_add_u32 s41, s47, 731136
    buffer_load_dwordx4 v6, s[36:39], s41 offen lds
    s_add_u32 m0, s43, 53248
    s_add_u32 s41, s47, 745472
    buffer_load_dwordx4 v6, s[36:39], s41 offen lds
    s_add_u32 m0, s43, 54272
    s_add_u32 s41, s47, 759808
    buffer_load_dwordx4 v6, s[36:39], s41 offen lds
    s_add_u32 m0, s43, 55296
    s_add_u32 s41, s47, 774144
    buffer_load_dwordx4 v6, s[36:39], s41 offen lds
    s_add_u32 m0, s43, 56320
    s_add_u32 s41, s47, 788480
    buffer_load_dwordx4 v6, s[36:39], s41 offen lds
    s_waitcnt vmcnt(16)
    s_barrier
    s_add_u32 m0, s43, 0
    s_add_u32 s41, s47, 917504
    buffer_load_dwordx4 v6, s[36:39], s41 offen lds
    s_add_u32 m0, s43, 1024
    s_add_u32 s41, s47, 931840
    buffer_load_dwordx4 v6, s[36:39], s41 offen lds
    s_add_u32 m0, s43, 2048
    s_add_u32 s41, s47, 946176
    buffer_load_dwordx4 v6, s[36:39], s41 offen lds
    s_add_u32 m0, s43, 3072
    s_add_u32 s41, s47, 960512
    buffer_load_dwordx4 v6, s[36:39], s41 offen lds
    s_add_u32 m0, s43, 4096
    s_add_u32 s41, s47, 974848
    buffer_load_dwordx4 v6, s[36:39], s41 offen lds
    s_add_u32 m0, s43, 5120
    s_add_u32 s41, s47, 989184
    buffer_load_dwordx4 v6, s[36:39], s41 offen lds
    s_add_u32 m0, s43, 6144
    s_add_u32 s41, s47, 1003520
    buffer_load_dwordx4 v6, s[36:39], s41 offen lds
    s_add_u32 m0, s43, 7168
    s_add_u32 s41, s47, 1017856
    buffer_load_dwordx4 v6, s[36:39], s41 offen lds
    s_waitcnt vmcnt(16)
    s_barrier
    s_add_u32 m0, s43, 16384
    s_add_u32 s41, s47, 1146880
    buffer_load_dwordx4 v6, s[36:39], s41 offen lds
    s_add_u32 m0, s43, 17408
    s_add_u32 s41, s47, 1161216
    buffer_load_dwordx4 v6, s[36:39], s41 offen lds
    s_add_u32 m0, s43, 18432
    s_add_u32 s41, s47, 1175552
    buffer_load_dwordx4 v6, s[36:39], s41 offen lds
    s_add_u32 m0, s43, 19456
    s_add_u32 s41, s47, 1189888
    buffer_load_dwordx4 v6, s[36:39], s41 offen lds
    s_add_u32 m0, s43, 20480
    s_add_u32 s41, s47, 1204224
    buffer_load_dwordx4 v6, s[36:39], s41 offen lds
    s_add_u32 m0, s43, 21504
    s_add_u32 s41, s47, 1218560
    buffer_load_dwordx4 v6, s[36:39], s41 offen lds
    s_add_u32 m0, s43, 22528
    s_add_u32 s41, s47, 1232896
    buffer_load_dwordx4 v6, s[36:39], s41 offen lds
    s_add_u32 m0, s43, 23552
    s_add_u32 s41, s47, 1247232
    buffer_load_dwordx4 v6, s[36:39], s41 offen lds
    s_waitcnt vmcnt(16)
    s_barrier
    s_add_u32 m0, s43, 32768
    s_add_u32 s41, s47, 1376256
    buffer_load_dwordx4 v6, s[36:39], s41 offen lds
    s_add_u32 m0, s43, 33792
    s_add_u32 s41, s47, 1390592
    buffer_load_dwordx4 v6, s[36:39], s41 offen lds
    s_add_u32 m0, s43, 34816
    s_add_u32 s41, s47, 1404928
    buffer_load_dwordx4 v6, s[36:39], s41 offen lds
    s_add_u32 m0, s43, 35840
    s_add_u32 s41, s47, 1419264
    buffer_load_dwordx4 v6, s[36:39], s41 offen lds
    s_add_u32 m0, s43, 36864
    s_add_u32 s41, s47, 1433600
    buffer_load_dwordx4 v6, s[36:39], s41 offen lds
    s_add_u32 m0, s43, 37888
    s_add_u32 s41, s47, 1447936
    buffer_load_dwordx4 v6, s[36:39], s41 offen lds
    s_add_u32 m0, s43, 38912
    s_add_u32 s41, s47, 1462272
    buffer_load_dwordx4 v6, s[36:39], s41 offen lds
    s_add_u32 m0, s43, 39936
    s_add_u32 s41, s47, 1476608
    buffer_load_dwordx4 v6, s[36:39], s41 offen lds
    s_waitcnt vmcnt(16)
    s_barrier
    s_add_u32 m0, s43, 49152
    s_add_u32 s41, s47, 1605632
    buffer_load_dwordx4 v6, s[36:39], s41 offen lds
    s_add_u32 m0, s43, 50176
    s_add_u32 s41, s47, 1619968
    buffer_load_dwordx4 v6, s[36:39], s41 offen lds
    s_add_u32 m0, s43, 51200
    s_add_u32 s41, s47, 1634304
    buffer_load_dwordx4 v6, s[36:39], s41 offen lds
    s_add_u32 m0, s43, 52224
    s_add_u32 s41, s47, 1648640
    buffer_load_dwordx4 v6, s[36:39], s41 offen lds
    s_add_u32 m0, s43, 53248
    s_add_u32 s41, s47, 1662976
    buffer_load_dwordx4 v6, s[36:39], s41 offen lds
    s_add_u32 m0, s43, 54272
    s_add_u32 s41, s47, 1677312
    buffer_load_dwordx4 v6, s[36:39], s41 offen lds
    s_add_u32 m0, s43, 55296
    s_add_u32 s41, s47, 1691648
    buffer_load_dwordx4 v6, s[36:39], s41 offen lds
    s_add_u32 m0, s43, 56320
    s_add_u32 s41, s47, 1705984
    buffer_load_dwordx4 v6, s[36:39], s41 offen lds
    s_waitcnt vmcnt(16)
    s_barrier
    s_mov_b32 s36, s8
    s_mov_b32 s37, s9
    s_mov_b32 s38, 0x80000
    s_mov_b32 s39, 0x20000
    s_add_u32 m0, s43, 0
    s_add_u32 s41, s44, 0
    buffer_load_dwordx4 v2, s[36:39], s41 offen lds
    s_add_u32 m0, s43, 1024
    s_add_u32 s41, s44, 8192
    buffer_load_dwordx4 v2, s[36:39], s41 offen lds
    s_add_u32 m0, s43, 2048
    s_add_u32 s41, s44, 16384
    buffer_load_dwordx4 v2, s[36:39], s41 offen lds
    s_add_u32 m0, s43, 3072
    s_add_u32 s41, s44, 24576
    buffer_load_dwordx4 v2, s[36:39], s41 offen lds
    s_add_u32 m0, s43, 4096
    s_add_u32 s41, s44, 32768
    buffer_load_dwordx4 v2, s[36:39], s41 offen lds
    s_add_u32 m0, s43, 5120
    s_add_u32 s41, s44, 40960
    buffer_load_dwordx4 v2, s[36:39], s41 offen lds
    s_add_u32 m0, s43, 6144
    s_add_u32 s41, s44, 49152
    buffer_load_dwordx4 v2, s[36:39], s41 offen lds
    s_add_u32 m0, s43, 7168
    s_add_u32 s41, s44, 57344
    buffer_load_dwordx4 v2, s[36:39], s41 offen lds
    s_waitcnt vmcnt(16)
    s_barrier
    s_add_u32 m0, s43, 16384
    s_add_u32 s41, s44, 131072
    buffer_load_dwordx4 v2, s[36:39], s41 offen lds
    s_add_u32 m0, s43, 17408
    s_add_u32 s41, s44, 139264
    buffer_load_dwordx4 v2, s[36:39], s41 offen lds
    s_add_u32 m0, s43, 18432
    s_add_u32 s41, s44, 147456
    buffer_load_dwordx4 v2, s[36:39], s41 offen lds
    s_add_u32 m0, s43, 19456
    s_add_u32 s41, s44, 155648
    buffer_load_dwordx4 v2, s[36:39], s41 offen lds
    s_add_u32 m0, s43, 20480
    s_add_u32 s41, s44, 163840
    buffer_load_dwordx4 v2, s[36:39], s41 offen lds
    s_add_u32 m0, s43, 21504
    s_add_u32 s41, s44, 172032
    buffer_load_dwordx4 v2, s[36:39], s41 offen lds
    s_add_u32 m0, s43, 22528
    s_add_u32 s41, s44, 180224
    buffer_load_dwordx4 v2, s[36:39], s41 offen lds
    s_add_u32 m0, s43, 23552
    s_add_u32 s41, s44, 188416
    buffer_load_dwordx4 v2, s[36:39], s41 offen lds
    s_waitcnt vmcnt(16)
    s_barrier
    s_add_u32 m0, s43, 32768
    s_add_u32 s41, s44, 262144
    buffer_load_dwordx4 v2, s[36:39], s41 offen lds
    s_add_u32 m0, s43, 33792
    s_add_u32 s41, s44, 270336
    buffer_load_dwordx4 v2, s[36:39], s41 offen lds
    s_add_u32 m0, s43, 34816
    s_add_u32 s41, s44, 278528
    buffer_load_dwordx4 v2, s[36:39], s41 offen lds
    s_add_u32 m0, s43, 35840
    s_add_u32 s41, s44, 286720
    buffer_load_dwordx4 v2, s[36:39], s41 offen lds
    s_add_u32 m0, s43, 36864
    s_add_u32 s41, s44, 294912
    buffer_load_dwordx4 v2, s[36:39], s41 offen lds
    s_add_u32 m0, s43, 37888
    s_add_u32 s41, s44, 303104
    buffer_load_dwordx4 v2, s[36:39], s41 offen lds
    s_add_u32 m0, s43, 38912
    s_add_u32 s41, s44, 311296
    buffer_load_dwordx4 v2, s[36:39], s41 offen lds
    s_add_u32 m0, s43, 39936
    s_add_u32 s41, s44, 319488
    buffer_load_dwordx4 v2, s[36:39], s41 offen lds
    s_barrier
    s_add_u32 m0, s43, 49152
    s_add_u32 s41, s44, 393216
    buffer_load_dwordx4 v2, s[36:39], s41 offen lds
    s_add_u32 m0, s43, 50176
    s_add_u32 s41, s44, 401408
    buffer_load_dwordx4 v2, s[36:39], s41 offen lds
    s_add_u32 m0, s43, 51200
    s_add_u32 s41, s44, 409600
    buffer_load_dwordx4 v2, s[36:39], s41 offen lds
    s_add_u32 m0, s43, 52224
    s_add_u32 s41, s44, 417792
    buffer_load_dwordx4 v2, s[36:39], s41 offen lds
    s_add_u32 m0, s43, 53248
    s_add_u32 s41, s44, 425984
    buffer_load_dwordx4 v2, s[36:39], s41 offen lds
    s_add_u32 m0, s43, 54272
    s_add_u32 s41, s44, 434176
    buffer_load_dwordx4 v2, s[36:39], s41 offen lds
    s_add_u32 m0, s43, 55296
    s_add_u32 s41, s44, 442368
    buffer_load_dwordx4 v2, s[36:39], s41 offen lds
    s_add_u32 m0, s43, 56320
    s_add_u32 s41, s44, 450560
    buffer_load_dwordx4 v2, s[36:39], s41 offen lds
    s_branch L_W_b24_52
L_W_sp_51:
    s_waitcnt vmcnt(16)
    s_barrier
    s_mov_b32 s36, s8
    s_mov_b32 s37, s9
    s_mov_b32 s38, 0x80000
    s_mov_b32 s39, 0x20000
    s_add_u32 m0, s43, 0
    s_add_u32 s41, s44, 0
    buffer_load_dwordx4 v2, s[36:39], s41 offen lds
    s_add_u32 m0, s43, 1024
    s_add_u32 s41, s44, 8192
    buffer_load_dwordx4 v2, s[36:39], s41 offen lds
    s_add_u32 m0, s43, 2048
    s_add_u32 s41, s44, 16384
    buffer_load_dwordx4 v2, s[36:39], s41 offen lds
    s_add_u32 m0, s43, 3072
    s_add_u32 s41, s44, 24576
    buffer_load_dwordx4 v2, s[36:39], s41 offen lds
    s_add_u32 m0, s43, 4096
    s_add_u32 s41, s44, 32768
    buffer_load_dwordx4 v2, s[36:39], s41 offen lds
    s_add_u32 m0, s43, 5120
    s_add_u32 s41, s44, 40960
    buffer_load_dwordx4 v2, s[36:39], s41 offen lds
    s_add_u32 m0, s43, 6144
    s_add_u32 s41, s44, 49152
    buffer_load_dwordx4 v2, s[36:39], s41 offen lds
    s_add_u32 m0, s43, 7168
    s_add_u32 s41, s44, 57344
    buffer_load_dwordx4 v2, s[36:39], s41 offen lds
    s_waitcnt vmcnt(16)
    s_barrier
    s_add_u32 m0, s43, 16384
    s_add_u32 s41, s44, 131072
    buffer_load_dwordx4 v2, s[36:39], s41 offen lds
    s_add_u32 m0, s43, 17408
    s_add_u32 s41, s44, 139264
    buffer_load_dwordx4 v2, s[36:39], s41 offen lds
    s_add_u32 m0, s43, 18432
    s_add_u32 s41, s44, 147456
    buffer_load_dwordx4 v2, s[36:39], s41 offen lds
    s_add_u32 m0, s43, 19456
    s_add_u32 s41, s44, 155648
    buffer_load_dwordx4 v2, s[36:39], s41 offen lds
    s_add_u32 m0, s43, 20480
    s_add_u32 s41, s44, 163840
    buffer_load_dwordx4 v2, s[36:39], s41 offen lds
    s_add_u32 m0, s43, 21504
    s_add_u32 s41, s44, 172032
    buffer_load_dwordx4 v2, s[36:39], s41 offen lds
    s_add_u32 m0, s43, 22528
    s_add_u32 s41, s44, 180224
    buffer_load_dwordx4 v2, s[36:39], s41 offen lds
    s_add_u32 m0, s43, 23552
    s_add_u32 s41, s44, 188416
    buffer_load_dwordx4 v2, s[36:39], s41 offen lds
    s_waitcnt vmcnt(16)
    s_barrier
    s_add_u32 m0, s43, 32768
    s_add_u32 s41, s44, 262144
    buffer_load_dwordx4 v2, s[36:39], s41 offen lds
    s_add_u32 m0, s43, 33792
    s_add_u32 s41, s44, 270336
    buffer_load_dwordx4 v2, s[36:39], s41 offen lds
    s_add_u32 m0, s43, 34816
    s_add_u32 s41, s44, 278528
    buffer_load_dwordx4 v2, s[36:39], s41 offen lds
    s_add_u32 m0, s43, 35840
    s_add_u32 s41, s44, 286720
    buffer_load_dwordx4 v2, s[36:39], s41 offen lds
    s_add_u32 m0, s43, 36864
    s_add_u32 s41, s44, 294912
    buffer_load_dwordx4 v2, s[36:39], s41 offen lds
    s_add_u32 m0, s43, 37888
    s_add_u32 s41, s44, 303104
    buffer_load_dwordx4 v2, s[36:39], s41 offen lds
    s_add_u32 m0, s43, 38912
    s_add_u32 s41, s44, 311296
    buffer_load_dwordx4 v2, s[36:39], s41 offen lds
    s_add_u32 m0, s43, 39936
    s_add_u32 s41, s44, 319488
    buffer_load_dwordx4 v2, s[36:39], s41 offen lds
    s_barrier
    s_add_u32 m0, s43, 49152
    s_add_u32 s41, s44, 393216
    buffer_load_dwordx4 v2, s[36:39], s41 offen lds
    s_add_u32 m0, s43, 50176
    s_add_u32 s41, s44, 401408
    buffer_load_dwordx4 v2, s[36:39], s41 offen lds
    s_add_u32 m0, s43, 51200
    s_add_u32 s41, s44, 409600
    buffer_load_dwordx4 v2, s[36:39], s41 offen lds
    s_add_u32 m0, s43, 52224
    s_add_u32 s41, s44, 417792
    buffer_load_dwordx4 v2, s[36:39], s41 offen lds
    s_add_u32 m0, s43, 53248
    s_add_u32 s41, s44, 425984
    buffer_load_dwordx4 v2, s[36:39], s41 offen lds
    s_add_u32 m0, s43, 54272
    s_add_u32 s41, s44, 434176
    buffer_load_dwordx4 v2, s[36:39], s41 offen lds
    s_add_u32 m0, s43, 55296
    s_add_u32 s41, s44, 442368
    buffer_load_dwordx4 v2, s[36:39], s41 offen lds
    s_add_u32 m0, s43, 56320
    s_add_u32 s41, s44, 450560
    buffer_load_dwordx4 v2, s[36:39], s41 offen lds
L_W_b24_52:
    s_cmp_eq_u32 s28, 3
    s_cbranch_scc1 L_W_w4c_53
    s_waitcnt vmcnt(24)
    s_barrier
    s_waitcnt vmcnt(16)
    s_barrier
    s_mov_b32 s36, s18
    s_mov_b32 s37, s19
    s_mov_b32 s38, 0x1c0000
    s_mov_b32 s39, 0x20000
    s_add_u32 m0, s43, 0
    s_add_u32 s41, s44, 0
    buffer_load_dwordx4 v2, s[36:39], s41 offen lds
    s_add_u32 m0, s43, 1024
    s_add_u32 s41, s44, 8192
    buffer_load_dwordx4 v2, s[36:39], s41 offen lds
    s_add_u32 m0, s43, 2048
    s_add_u32 s41, s44, 16384
    buffer_load_dwordx4 v2, s[36:39], s41 offen lds
    s_add_u32 m0, s43, 3072
    s_add_u32 s41, s44, 24576
    buffer_load_dwordx4 v2, s[36:39], s41 offen lds
    s_add_u32 m0, s43, 4096
    s_add_u32 s41, s44, 32768
    buffer_load_dwordx4 v2, s[36:39], s41 offen lds
    s_add_u32 m0, s43, 5120
    s_add_u32 s41, s44, 40960
    buffer_load_dwordx4 v2, s[36:39], s41 offen lds
    s_add_u32 m0, s43, 6144
    s_add_u32 s41, s44, 49152
    buffer_load_dwordx4 v2, s[36:39], s41 offen lds
    s_add_u32 m0, s43, 7168
    s_add_u32 s41, s44, 57344
    buffer_load_dwordx4 v2, s[36:39], s41 offen lds
    s_waitcnt vmcnt(16)
    s_barrier
    s_add_u32 m0, s43, 16384
    s_add_u32 s41, s44, 131072
    buffer_load_dwordx4 v2, s[36:39], s41 offen lds
    s_add_u32 m0, s43, 17408
    s_add_u32 s41, s44, 139264
    buffer_load_dwordx4 v2, s[36:39], s41 offen lds
    s_add_u32 m0, s43, 18432
    s_add_u32 s41, s44, 147456
    buffer_load_dwordx4 v2, s[36:39], s41 offen lds
    s_add_u32 m0, s43, 19456
    s_add_u32 s41, s44, 155648
    buffer_load_dwordx4 v2, s[36:39], s41 offen lds
    s_add_u32 m0, s43, 20480
    s_add_u32 s41, s44, 163840
    buffer_load_dwordx4 v2, s[36:39], s41 offen lds
    s_add_u32 m0, s43, 21504
    s_add_u32 s41, s44, 172032
    buffer_load_dwordx4 v2, s[36:39], s41 offen lds
    s_add_u32 m0, s43, 22528
    s_add_u32 s41, s44, 180224
    buffer_load_dwordx4 v2, s[36:39], s41 offen lds
    s_add_u32 m0, s43, 23552
    s_add_u32 s41, s44, 188416
    buffer_load_dwordx4 v2, s[36:39], s41 offen lds
    s_waitcnt vmcnt(16)
    s_barrier
    s_add_u32 m0, s43, 32768
    s_add_u32 s41, s44, 262144
    buffer_load_dwordx4 v2, s[36:39], s41 offen lds
    s_add_u32 m0, s43, 33792
    s_add_u32 s41, s44, 270336
    buffer_load_dwordx4 v2, s[36:39], s41 offen lds
    s_add_u32 m0, s43, 34816
    s_add_u32 s41, s44, 278528
    buffer_load_dwordx4 v2, s[36:39], s41 offen lds
    s_add_u32 m0, s43, 35840
    s_add_u32 s41, s44, 286720
    buffer_load_dwordx4 v2, s[36:39], s41 offen lds
    s_add_u32 m0, s43, 36864
    s_add_u32 s41, s44, 294912
    buffer_load_dwordx4 v2, s[36:39], s41 offen lds
    s_add_u32 m0, s43, 37888
    s_add_u32 s41, s44, 303104
    buffer_load_dwordx4 v2, s[36:39], s41 offen lds
    s_add_u32 m0, s43, 38912
    s_add_u32 s41, s44, 311296
    buffer_load_dwordx4 v2, s[36:39], s41 offen lds
    s_add_u32 m0, s43, 39936
    s_add_u32 s41, s44, 319488
    buffer_load_dwordx4 v2, s[36:39], s41 offen lds
    s_waitcnt vmcnt(16)
    s_barrier
    s_add_u32 m0, s43, 49152
    s_add_u32 s41, s44, 393216
    buffer_load_dwordx4 v2, s[36:39], s41 offen lds
    s_add_u32 m0, s43, 50176
    s_add_u32 s41, s44, 401408
    buffer_load_dwordx4 v2, s[36:39], s41 offen lds
    s_add_u32 m0, s43, 51200
    s_add_u32 s41, s44, 409600
    buffer_load_dwordx4 v2, s[36:39], s41 offen lds
    s_add_u32 m0, s43, 52224
    s_add_u32 s41, s44, 417792
    buffer_load_dwordx4 v2, s[36:39], s41 offen lds
    s_add_u32 m0, s43, 53248
    s_add_u32 s41, s44, 425984
    buffer_load_dwordx4 v2, s[36:39], s41 offen lds
    s_add_u32 m0, s43, 54272
    s_add_u32 s41, s44, 434176
    buffer_load_dwordx4 v2, s[36:39], s41 offen lds
    s_add_u32 m0, s43, 55296
    s_add_u32 s41, s44, 442368
    buffer_load_dwordx4 v2, s[36:39], s41 offen lds
    s_add_u32 m0, s43, 56320
    s_add_u32 s41, s44, 450560
    buffer_load_dwordx4 v2, s[36:39], s41 offen lds
    s_waitcnt vmcnt(16)
    s_barrier
    s_add_u32 m0, s43, 0
    s_add_u32 s41, s44, 524288
    buffer_load_dwordx4 v2, s[36:39], s41 offen lds
    s_add_u32 m0, s43, 1024
    s_add_u32 s41, s44, 532480
    buffer_load_dwordx4 v2, s[36:39], s41 offen lds
    s_add_u32 m0, s43, 2048
    s_add_u32 s41, s44, 540672
    buffer_load_dwordx4 v2, s[36:39], s41 offen lds
    s_add_u32 m0, s43, 3072
    s_add_u32 s41, s44, 548864
    buffer_load_dwordx4 v2, s[36:39], s41 offen lds
    s_add_u32 m0, s43, 4096
    s_add_u32 s41, s44, 557056
    buffer_load_dwordx4 v2, s[36:39], s41 offen lds
    s_add_u32 m0, s43, 5120
    s_add_u32 s41, s44, 565248
    buffer_load_dwordx4 v2, s[36:39], s41 offen lds
    s_add_u32 m0, s43, 6144
    s_add_u32 s41, s44, 573440
    buffer_load_dwordx4 v2, s[36:39], s41 offen lds
    s_add_u32 m0, s43, 7168
    s_add_u32 s41, s44, 581632
    buffer_load_dwordx4 v2, s[36:39], s41 offen lds
    s_waitcnt vmcnt(16)
    s_barrier
    s_add_u32 m0, s43, 16384
    s_add_u32 s41, s44, 655360
    buffer_load_dwordx4 v2, s[36:39], s41 offen lds
    s_add_u32 m0, s43, 17408
    s_add_u32 s41, s44, 663552
    buffer_load_dwordx4 v2, s[36:39], s41 offen lds
    s_add_u32 m0, s43, 18432
    s_add_u32 s41, s44, 671744
    buffer_load_dwordx4 v2, s[36:39], s41 offen lds
    s_add_u32 m0, s43, 19456
    s_add_u32 s41, s44, 679936
    buffer_load_dwordx4 v2, s[36:39], s41 offen lds
    s_add_u32 m0, s43, 20480
    s_add_u32 s41, s44, 688128
    buffer_load_dwordx4 v2, s[36:39], s41 offen lds
    s_add_u32 m0, s43, 21504
    s_add_u32 s41, s44, 696320
    buffer_load_dwordx4 v2, s[36:39], s41 offen lds
    s_add_u32 m0, s43, 22528
    s_add_u32 s41, s44, 704512
    buffer_load_dwordx4 v2, s[36:39], s41 offen lds
    s_add_u32 m0, s43, 23552
    s_add_u32 s41, s44, 712704
    buffer_load_dwordx4 v2, s[36:39], s41 offen lds
    s_waitcnt vmcnt(16)
    s_barrier
    s_add_u32 m0, s43, 32768
    s_add_u32 s41, s44, 786432
    buffer_load_dwordx4 v2, s[36:39], s41 offen lds
    s_add_u32 m0, s43, 33792
    s_add_u32 s41, s44, 794624
    buffer_load_dwordx4 v2, s[36:39], s41 offen lds
    s_add_u32 m0, s43, 34816
    s_add_u32 s41, s44, 802816
    buffer_load_dwordx4 v2, s[36:39], s41 offen lds
    s_add_u32 m0, s43, 35840
    s_add_u32 s41, s44, 811008
    buffer_load_dwordx4 v2, s[36:39], s41 offen lds
    s_add_u32 m0, s43, 36864
    s_add_u32 s41, s44, 819200
    buffer_load_dwordx4 v2, s[36:39], s41 offen lds
    s_add_u32 m0, s43, 37888
    s_add_u32 s41, s44, 827392
    buffer_load_dwordx4 v2, s[36:39], s41 offen lds
    s_add_u32 m0, s43, 38912
    s_add_u32 s41, s44, 835584
    buffer_load_dwordx4 v2, s[36:39], s41 offen lds
    s_add_u32 m0, s43, 39936
    s_add_u32 s41, s44, 843776
    buffer_load_dwordx4 v2, s[36:39], s41 offen lds
    s_waitcnt vmcnt(16)
    s_barrier
    s_add_u32 m0, s43, 49152
    s_add_u32 s41, s44, 917504
    buffer_load_dwordx4 v2, s[36:39], s41 offen lds
    s_add_u32 m0, s43, 50176
    s_add_u32 s41, s44, 925696
    buffer_load_dwordx4 v2, s[36:39], s41 offen lds
    s_add_u32 m0, s43, 51200
    s_add_u32 s41, s44, 933888
    buffer_load_dwordx4 v2, s[36:39], s41 offen lds
    s_add_u32 m0, s43, 52224
    s_add_u32 s41, s44, 942080
    buffer_load_dwordx4 v2, s[36:39], s41 offen lds
    s_add_u32 m0, s43, 53248
    s_add_u32 s41, s44, 950272
    buffer_load_dwordx4 v2, s[36:39], s41 offen lds
    s_add_u32 m0, s43, 54272
    s_add_u32 s41, s44, 958464
    buffer_load_dwordx4 v2, s[36:39], s41 offen lds
    s_add_u32 m0, s43, 55296
    s_add_u32 s41, s44, 966656
    buffer_load_dwordx4 v2, s[36:39], s41 offen lds
    s_add_u32 m0, s43, 56320
    s_add_u32 s41, s44, 974848
    buffer_load_dwordx4 v2, s[36:39], s41 offen lds
    s_waitcnt vmcnt(16)
    s_barrier
    s_add_u32 m0, s43, 0
    s_add_u32 s41, s44, 1048576
    buffer_load_dwordx4 v2, s[36:39], s41 offen lds
    s_add_u32 m0, s43, 1024
    s_add_u32 s41, s44, 1056768
    buffer_load_dwordx4 v2, s[36:39], s41 offen lds
    s_add_u32 m0, s43, 2048
    s_add_u32 s41, s44, 1064960
    buffer_load_dwordx4 v2, s[36:39], s41 offen lds
    s_add_u32 m0, s43, 3072
    s_add_u32 s41, s44, 1073152
    buffer_load_dwordx4 v2, s[36:39], s41 offen lds
    s_add_u32 m0, s43, 4096
    s_add_u32 s41, s44, 1081344
    buffer_load_dwordx4 v2, s[36:39], s41 offen lds
    s_add_u32 m0, s43, 5120
    s_add_u32 s41, s44, 1089536
    buffer_load_dwordx4 v2, s[36:39], s41 offen lds
    s_add_u32 m0, s43, 6144
    s_add_u32 s41, s44, 1097728
    buffer_load_dwordx4 v2, s[36:39], s41 offen lds
    s_add_u32 m0, s43, 7168
    s_add_u32 s41, s44, 1105920
    buffer_load_dwordx4 v2, s[36:39], s41 offen lds
    s_waitcnt vmcnt(16)
    s_barrier
    s_add_u32 m0, s43, 16384
    s_add_u32 s41, s44, 1179648
    buffer_load_dwordx4 v2, s[36:39], s41 offen lds
    s_add_u32 m0, s43, 17408
    s_add_u32 s41, s44, 1187840
    buffer_load_dwordx4 v2, s[36:39], s41 offen lds
    s_add_u32 m0, s43, 18432
    s_add_u32 s41, s44, 1196032
    buffer_load_dwordx4 v2, s[36:39], s41 offen lds
    s_add_u32 m0, s43, 19456
    s_add_u32 s41, s44, 1204224
    buffer_load_dwordx4 v2, s[36:39], s41 offen lds
    s_add_u32 m0, s43, 20480
    s_add_u32 s41, s44, 1212416
    buffer_load_dwordx4 v2, s[36:39], s41 offen lds
    s_add_u32 m0, s43, 21504
    s_add_u32 s41, s44, 1220608
    buffer_load_dwordx4 v2, s[36:39], s41 offen lds
    s_add_u32 m0, s43, 22528
    s_add_u32 s41, s44, 1228800
    buffer_load_dwordx4 v2, s[36:39], s41 offen lds
    s_add_u32 m0, s43, 23552
    s_add_u32 s41, s44, 1236992
    buffer_load_dwordx4 v2, s[36:39], s41 offen lds
    s_waitcnt vmcnt(16)
    s_barrier
    s_add_u32 m0, s43, 32768
    s_add_u32 s41, s44, 1310720
    buffer_load_dwordx4 v2, s[36:39], s41 offen lds
    s_add_u32 m0, s43, 33792
    s_add_u32 s41, s44, 1318912
    buffer_load_dwordx4 v2, s[36:39], s41 offen lds
    s_add_u32 m0, s43, 34816
    s_add_u32 s41, s44, 1327104
    buffer_load_dwordx4 v2, s[36:39], s41 offen lds
    s_add_u32 m0, s43, 35840
    s_add_u32 s41, s44, 1335296
    buffer_load_dwordx4 v2, s[36:39], s41 offen lds
    s_add_u32 m0, s43, 36864
    s_add_u32 s41, s44, 1343488
    buffer_load_dwordx4 v2, s[36:39], s41 offen lds
    s_add_u32 m0, s43, 37888
    s_add_u32 s41, s44, 1351680
    buffer_load_dwordx4 v2, s[36:39], s41 offen lds
    s_add_u32 m0, s43, 38912
    s_add_u32 s41, s44, 1359872
    buffer_load_dwordx4 v2, s[36:39], s41 offen lds
    s_add_u32 m0, s43, 39936
    s_add_u32 s41, s44, 1368064
    buffer_load_dwordx4 v2, s[36:39], s41 offen lds
    s_waitcnt vmcnt(16)
    s_barrier
    s_add_u32 m0, s43, 49152
    s_add_u32 s41, s44, 1441792
    buffer_load_dwordx4 v2, s[36:39], s41 offen lds
    s_add_u32 m0, s43, 50176
    s_add_u32 s41, s44, 1449984
    buffer_load_dwordx4 v2, s[36:39], s41 offen lds
    s_add_u32 m0, s43, 51200
    s_add_u32 s41, s44, 1458176
    buffer_load_dwordx4 v2, s[36:39], s41 offen lds
    s_add_u32 m0, s43, 52224
    s_add_u32 s41, s44, 1466368
    buffer_load_dwordx4 v2, s[36:39], s41 offen lds
    s_add_u32 m0, s43, 53248
    s_add_u32 s41, s44, 1474560
    buffer_load_dwordx4 v2, s[36:39], s41 offen lds
    s_add_u32 m0, s43, 54272
    s_add_u32 s41, s44, 1482752
    buffer_load_dwordx4 v2, s[36:39], s41 offen lds
    s_add_u32 m0, s43, 55296
    s_add_u32 s41, s44, 1490944
    buffer_load_dwordx4 v2, s[36:39], s41 offen lds
    s_add_u32 m0, s43, 56320
    s_add_u32 s41, s44, 1499136
    buffer_load_dwordx4 v2, s[36:39], s41 offen lds
    s_waitcnt vmcnt(16)
    s_barrier
    s_add_u32 m0, s43, 0
    s_add_u32 s41, s44, 1572864
    buffer_load_dwordx4 v2, s[36:39], s41 offen lds
    s_add_u32 m0, s43, 1024
    s_add_u32 s41, s44, 1581056
    buffer_load_dwordx4 v2, s[36:39], s41 offen lds
    s_add_u32 m0, s43, 2048
    s_add_u32 s41, s44, 1589248
    buffer_load_dwordx4 v2, s[36:39], s41 offen lds
    s_add_u32 m0, s43, 3072
    s_add_u32 s41, s44, 1597440
    buffer_load_dwordx4 v2, s[36:39], s41 offen lds
    s_add_u32 m0, s43, 4096
    s_add_u32 s41, s44, 1605632
    buffer_load_dwordx4 v2, s[36:39], s41 offen lds
    s_add_u32 m0, s43, 5120
    s_add_u32 s41, s44, 1613824
    buffer_load_dwordx4 v2, s[36:39], s41 offen lds
    s_add_u32 m0, s43, 6144
    s_add_u32 s41, s44, 1622016
    buffer_load_dwordx4 v2, s[36:39], s41 offen lds
    s_add_u32 m0, s43, 7168
    s_add_u32 s41, s44, 1630208
    buffer_load_dwordx4 v2, s[36:39], s41 offen lds
    s_waitcnt vmcnt(16)
    s_barrier
    s_add_u32 m0, s43, 16384
    s_add_u32 s41, s44, 1703936
    buffer_load_dwordx4 v2, s[36:39], s41 offen lds
    s_add_u32 m0, s43, 17408
    s_add_u32 s41, s44, 1712128
    buffer_load_dwordx4 v2, s[36:39], s41 offen lds
    s_add_u32 m0, s43, 18432
    s_add_u32 s41, s44, 1720320
    buffer_load_dwordx4 v2, s[36:39], s41 offen lds
    s_add_u32 m0, s43, 19456
    s_add_u32 s41, s44, 1728512
    buffer_load_dwordx4 v2, s[36:39], s41 offen lds
    s_add_u32 m0, s43, 20480
    s_add_u32 s41, s44, 1736704
    buffer_load_dwordx4 v2, s[36:39], s41 offen lds
    s_add_u32 m0, s43, 21504
    s_add_u32 s41, s44, 1744896
    buffer_load_dwordx4 v2, s[36:39], s41 offen lds
    s_add_u32 m0, s43, 22528
    s_add_u32 s41, s44, 1753088
    buffer_load_dwordx4 v2, s[36:39], s41 offen lds
    s_add_u32 m0, s43, 23552
    s_add_u32 s41, s44, 1761280
    buffer_load_dwordx4 v2, s[36:39], s41 offen lds
    s_waitcnt vmcnt(16)
    s_barrier
    s_waitcnt vmcnt(8)
    s_barrier
    s_waitcnt vmcnt(0)
    s_barrier
    s_endpgm
L_W_w4c_53:
    s_add_u32 s56, s22, 0x100000
    s_addc_u32 s57, s23, 0
    s_mov_b32 s58, 0x38000
    s_mov_b32 s59, 0x20000
    v_bfe_u32 v3, v1, 4, 1
    v_lshlrev_b32 v3, 2, v3
    v_and_b32 v4, 7, v1
    v_xor_b32 v3, v3, v4
    v_lshlrev_b32 v3, 4, v3
    v_lshrrev_b32 v4, 3, v1
    v_lshl_add_u32 v10, v4, 7, v3
    s_lshl_b32 s60, s42, 13
    s_waitcnt vmcnt(24)
    s_barrier
    s_waitcnt vmcnt(16)
    s_barrier
    s_add_u32 m0, s43, 0
    s_add_u32 s41, s60, 0
    buffer_load_dwordx4 v10, s[56:59], s41 offen sc1 lds
    s_add_u32 m0, s43, 1024
    s_add_u32 s41, s60, 1024
    buffer_load_dwordx4 v10, s[56:59], s41 offen sc1 lds
    s_add_u32 m0, s43, 2048
    s_add_u32 s41, s60, 2048
    buffer_load_dwordx4 v10, s[56:59], s41 offen sc1 lds
    s_add_u32 m0, s43, 3072
    s_add_u32 s41, s60, 3072
    buffer_load_dwordx4 v10, s[56:59], s41 offen sc1 lds
    s_add_u32 m0, s43, 4096
    s_add_u32 s41, s60, 4096
    buffer_load_dwordx4 v10, s[56:59], s41 offen sc1 lds
    s_add_u32 m0, s43, 5120
    s_add_u32 s41, s60, 5120
    buffer_load_dwordx4 v10, s[56:59], s41 offen sc1 lds
    s_add_u32 m0, s43, 6144
    s_add_u32 s41, s60, 6144
    buffer_load_dwordx4 v10, s[56:59], s41 offen sc1 lds
    s_add_u32 m0, s43, 7168
    s_add_u32 s41, s60, 7168
    buffer_load_dwordx4 v10, s[56:59], s41 offen sc1 lds
    s_waitcnt vmcnt(16)
    s_barrier
    s_add_u32 m0, s43, 16384
    s_add_u32 s41, s60, 16384
    buffer_load_dwordx4 v10, s[56:59], s41 offen sc1 lds
    s_add_u32 m0, s43, 17408
    s_add_u32 s41, s60, 17408
    buffer_load_dwordx4 v10, s[56:59], s41 offen sc1 lds
    s_add_u32 m0, s43, 18432
    s_add_u32 s41, s60, 18432
    buffer_load_dwordx4 v10, s[56:59], s41 offen sc1 lds
    s_add_u32 m0, s43, 19456
    s_add_u32 s41, s60, 19456
    buffer_load_dwordx4 v10, s[56:59], s41 offen sc1 lds
    s_add_u32 m0, s43, 20480
    s_add_u32 s41, s60, 20480
    buffer_load_dwordx4 v10, s[56:59], s41 offen sc1 lds
    s_add_u32 m0, s43, 21504
    s_add_u32 s41, s60, 21504
    buffer_load_dwordx4 v10, s[56:59], s41 offen sc1 lds
    s_add_u32 m0, s43, 22528
    s_add_u32 s41, s60, 22528
    buffer_load_dwordx4 v10, s[56:59], s41 offen sc1 lds
    s_add_u32 m0, s43, 23552
    s_add_u32 s41, s60, 23552
    buffer_load_dwordx4 v10, s[56:59], s41 offen sc1 lds
    s_waitcnt vmcnt(16)
    s_barrier
    s_add_u32 m0, s43, 32768
    s_add_u32 s41, s60, 32768
    buffer_load_dwordx4 v10, s[56:59], s41 offen sc1 lds
    s_add_u32 m0, s43, 33792
    s_add_u32 s41, s60, 33792
    buffer_load_dwordx4 v10, s[56:59], s41 offen sc1 lds
    s_add_u32 m0, s43, 34816
    s_add_u32 s41, s60, 34816
    buffer_load_dwordx4 v10, s[56:59], s41 offen sc1 lds
    s_add_u32 m0, s43, 35840
    s_add_u32 s41, s60, 35840
    buffer_load_dwordx4 v10, s[56:59], s41 offen sc1 lds
    s_add_u32 m0, s43, 36864
    s_add_u32 s41, s60, 36864
    buffer_load_dwordx4 v10, s[56:59], s41 offen sc1 lds
    s_add_u32 m0, s43, 37888
    s_add_u32 s41, s60, 37888
    buffer_load_dwordx4 v10, s[56:59], s41 offen sc1 lds
    s_add_u32 m0, s43, 38912
    s_add_u32 s41, s60, 38912
    buffer_load_dwordx4 v10, s[56:59], s41 offen sc1 lds
    s_add_u32 m0, s43, 39936
    s_add_u32 s41, s60, 39936
    buffer_load_dwordx4 v10, s[56:59], s41 offen sc1 lds
    s_waitcnt vmcnt(16)
    s_barrier
    s_add_u32 m0, s43, 49152
    s_add_u32 s41, s60, 49152
    buffer_load_dwordx4 v10, s[56:59], s41 offen sc1 lds
    s_add_u32 m0, s43, 50176
    s_add_u32 s41, s60, 50176
    buffer_load_dwordx4 v10, s[56:59], s41 offen sc1 lds
    s_add_u32 m0, s43, 51200
    s_add_u32 s41, s60, 51200
    buffer_load_dwordx4 v10, s[56:59], s41 offen sc1 lds
    s_add_u32 m0, s43, 52224
    s_add_u32 s41, s60, 52224
    buffer_load_dwordx4 v10, s[56:59], s41 offen sc1 lds
    s_add_u32 m0, s43, 53248
    s_add_u32 s41, s60, 53248
    buffer_load_dwordx4 v10, s[56:59], s41 offen sc1 lds
    s_add_u32 m0, s43, 54272
    s_add_u32 s41, s60, 54272
    buffer_load_dwordx4 v10, s[56:59], s41 offen sc1 lds
    s_add_u32 m0, s43, 55296
    s_add_u32 s41, s60, 55296
    buffer_load_dwordx4 v10, s[56:59], s41 offen sc1 lds
    s_add_u32 m0, s43, 56320
    s_add_u32 s41, s60, 56320
    buffer_load_dwordx4 v10, s[56:59], s41 offen sc1 lds
    s_waitcnt vmcnt(16)
    s_barrier
    s_add_u32 m0, s43, 0
    s_add_u32 s41, s60, 65536
    buffer_load_dwordx4 v10, s[56:59], s41 offen sc1 lds
    s_add_u32 m0, s43, 1024
    s_add_u32 s41, s60, 66560
    buffer_load_dwordx4 v10, s[56:59], s41 offen sc1 lds
    s_add_u32 m0, s43, 2048
    s_add_u32 s41, s60, 67584
    buffer_load_dwordx4 v10, s[56:59], s41 offen sc1 lds
    s_add_u32 m0, s43, 3072
    s_add_u32 s41, s60, 68608
    buffer_load_dwordx4 v10, s[56:59], s41 offen sc1 lds
    s_add_u32 m0, s43, 4096
    s_add_u32 s41, s60, 69632
    buffer_load_dwordx4 v10, s[56:59], s41 offen sc1 lds
    s_add_u32 m0, s43, 5120
    s_add_u32 s41, s60, 70656
    buffer_load_dwordx4 v10, s[56:59], s41 offen sc1 lds
    s_add_u32 m0, s43, 6144
    s_add_u32 s41, s60, 71680
    buffer_load_dwordx4 v10, s[56:59], s41 offen sc1 lds
    s_add_u32 m0, s43, 7168
    s_add_u32 s41, s60, 72704
    buffer_load_dwordx4 v10, s[56:59], s41 offen sc1 lds
    s_waitcnt vmcnt(16)
    s_barrier
    s_add_u32 m0, s43, 16384
    s_add_u32 s41, s60, 81920
    buffer_load_dwordx4 v10, s[56:59], s41 offen sc1 lds
    s_add_u32 m0, s43, 17408
    s_add_u32 s41, s60, 82944
    buffer_load_dwordx4 v10, s[56:59], s41 offen sc1 lds
    s_add_u32 m0, s43, 18432
    s_add_u32 s41, s60, 83968
    buffer_load_dwordx4 v10, s[56:59], s41 offen sc1 lds
    s_add_u32 m0, s43, 19456
    s_add_u32 s41, s60, 84992
    buffer_load_dwordx4 v10, s[56:59], s41 offen sc1 lds
    s_add_u32 m0, s43, 20480
    s_add_u32 s41, s60, 86016
    buffer_load_dwordx4 v10, s[56:59], s41 offen sc1 lds
    s_add_u32 m0, s43, 21504
    s_add_u32 s41, s60, 87040
    buffer_load_dwordx4 v10, s[56:59], s41 offen sc1 lds
    s_add_u32 m0, s43, 22528
    s_add_u32 s41, s60, 88064
    buffer_load_dwordx4 v10, s[56:59], s41 offen sc1 lds
    s_add_u32 m0, s43, 23552
    s_add_u32 s41, s60, 89088
    buffer_load_dwordx4 v10, s[56:59], s41 offen sc1 lds
    s_waitcnt vmcnt(16)
    s_barrier
    s_add_u32 m0, s43, 32768
    s_add_u32 s41, s60, 98304
    buffer_load_dwordx4 v10, s[56:59], s41 offen sc1 lds
    s_add_u32 m0, s43, 33792
    s_add_u32 s41, s60, 99328
    buffer_load_dwordx4 v10, s[56:59], s41 offen sc1 lds
    s_add_u32 m0, s43, 34816
    s_add_u32 s41, s60, 100352
    buffer_load_dwordx4 v10, s[56:59], s41 offen sc1 lds
    s_add_u32 m0, s43, 35840
    s_add_u32 s41, s60, 101376
    buffer_load_dwordx4 v10, s[56:59], s41 offen sc1 lds
    s_add_u32 m0, s43, 36864
    s_add_u32 s41, s60, 102400
    buffer_load_dwordx4 v10, s[56:59], s41 offen sc1 lds
    s_add_u32 m0, s43, 37888
    s_add_u32 s41, s60, 103424
    buffer_load_dwordx4 v10, s[56:59], s41 offen sc1 lds
    s_add_u32 m0, s43, 38912
    s_add_u32 s41, s60, 104448
    buffer_load_dwordx4 v10, s[56:59], s41 offen sc1 lds
    s_add_u32 m0, s43, 39936
    s_add_u32 s41, s60, 105472
    buffer_load_dwordx4 v10, s[56:59], s41 offen sc1 lds
    s_waitcnt vmcnt(16)
    s_barrier
    s_add_u32 m0, s43, 49152
    s_add_u32 s41, s60, 114688
    buffer_load_dwordx4 v10, s[56:59], s41 offen sc1 lds
    s_add_u32 m0, s43, 50176
    s_add_u32 s41, s60, 115712
    buffer_load_dwordx4 v10, s[56:59], s41 offen sc1 lds
    s_add_u32 m0, s43, 51200
    s_add_u32 s41, s60, 116736
    buffer_load_dwordx4 v10, s[56:59], s41 offen sc1 lds
    s_add_u32 m0, s43, 52224
    s_add_u32 s41, s60, 117760
    buffer_load_dwordx4 v10, s[56:59], s41 offen sc1 lds
    s_add_u32 m0, s43, 53248
    s_add_u32 s41, s60, 118784
    buffer_load_dwordx4 v10, s[56:59], s41 offen sc1 lds
    s_add_u32 m0, s43, 54272
    s_add_u32 s41, s60, 119808
    buffer_load_dwordx4 v10, s[56:59], s41 offen sc1 lds
    s_add_u32 m0, s43, 55296
    s_add_u32 s41, s60, 120832
    buffer_load_dwordx4 v10, s[56:59], s41 offen sc1 lds
    s_add_u32 m0, s43, 56320
    s_add_u32 s41, s60, 121856
    buffer_load_dwordx4 v10, s[56:59], s41 offen sc1 lds
    s_waitcnt vmcnt(16)
    s_barrier
    s_add_u32 m0, s43, 0
    s_add_u32 s41, s60, 131072
    buffer_load_dwordx4 v10, s[56:59], s41 offen sc1 lds
    s_add_u32 m0, s43, 1024
    s_add_u32 s41, s60, 132096
    buffer_load_dwordx4 v10, s[56:59], s41 offen sc1 lds
    s_add_u32 m0, s43, 2048
    s_add_u32 s41, s60, 133120
    buffer_load_dwordx4 v10, s[56:59], s41 offen sc1 lds
    s_add_u32 m0, s43, 3072
    s_add_u32 s41, s60, 134144
    buffer_load_dwordx4 v10, s[56:59], s41 offen sc1 lds
    s_add_u32 m0, s43, 4096
    s_add_u32 s41, s60, 135168
    buffer_load_dwordx4 v10, s[56:59], s41 offen sc1 lds
    s_add_u32 m0, s43, 5120
    s_add_u32 s41, s60, 136192
    buffer_load_dwordx4 v10, s[56:59], s41 offen sc1 lds
    s_add_u32 m0, s43, 6144
    s_add_u32 s41, s60, 137216
    buffer_load_dwordx4 v10, s[56:59], s41 offen sc1 lds
    s_add_u32 m0, s43, 7168
    s_add_u32 s41, s60, 138240
    buffer_load_dwordx4 v10, s[56:59], s41 offen sc1 lds
    s_waitcnt vmcnt(16)
    s_barrier
    s_add_u32 m0, s43, 16384
    s_add_u32 s41, s60, 147456
    buffer_load_dwordx4 v10, s[56:59], s41 offen sc1 lds
    s_add_u32 m0, s43, 17408
    s_add_u32 s41, s60, 148480
    buffer_load_dwordx4 v10, s[56:59], s41 offen sc1 lds
    s_add_u32 m0, s43, 18432
    s_add_u32 s41, s60, 149504
    buffer_load_dwordx4 v10, s[56:59], s41 offen sc1 lds
    s_add_u32 m0, s43, 19456
    s_add_u32 s41, s60, 150528
    buffer_load_dwordx4 v10, s[56:59], s41 offen sc1 lds
    s_add_u32 m0, s43, 20480
    s_add_u32 s41, s60, 151552
    buffer_load_dwordx4 v10, s[56:59], s41 offen sc1 lds
    s_add_u32 m0, s43, 21504
    s_add_u32 s41, s60, 152576
    buffer_load_dwordx4 v10, s[56:59], s41 offen sc1 lds
    s_add_u32 m0, s43, 22528
    s_add_u32 s41, s60, 153600
    buffer_load_dwordx4 v10, s[56:59], s41 offen sc1 lds
    s_add_u32 m0, s43, 23552
    s_add_u32 s41, s60, 154624
    buffer_load_dwordx4 v10, s[56:59], s41 offen sc1 lds
    s_waitcnt vmcnt(16)
    s_barrier
    s_add_u32 m0, s43, 32768
    s_add_u32 s41, s60, 163840
    buffer_load_dwordx4 v10, s[56:59], s41 offen sc1 lds
    s_add_u32 m0, s43, 33792
    s_add_u32 s41, s60, 164864
    buffer_load_dwordx4 v10, s[56:59], s41 offen sc1 lds
    s_add_u32 m0, s43, 34816
    s_add_u32 s41, s60, 165888
    buffer_load_dwordx4 v10, s[56:59], s41 offen sc1 lds
    s_add_u32 m0, s43, 35840
    s_add_u32 s41, s60, 166912
    buffer_load_dwordx4 v10, s[56:59], s41 offen sc1 lds
    s_add_u32 m0, s43, 36864
    s_add_u32 s41, s60, 167936
    buffer_load_dwordx4 v10, s[56:59], s41 offen sc1 lds
    s_add_u32 m0, s43, 37888
    s_add_u32 s41, s60, 168960
    buffer_load_dwordx4 v10, s[56:59], s41 offen sc1 lds
    s_add_u32 m0, s43, 38912
    s_add_u32 s41, s60, 169984
    buffer_load_dwordx4 v10, s[56:59], s41 offen sc1 lds
    s_add_u32 m0, s43, 39936
    s_add_u32 s41, s60, 171008
    buffer_load_dwordx4 v10, s[56:59], s41 offen sc1 lds
    s_waitcnt vmcnt(16)
    s_barrier
    s_add_u32 m0, s43, 49152
    s_add_u32 s41, s60, 180224
    buffer_load_dwordx4 v10, s[56:59], s41 offen sc1 lds
    s_add_u32 m0, s43, 50176
    s_add_u32 s41, s60, 181248
    buffer_load_dwordx4 v10, s[56:59], s41 offen sc1 lds
    s_add_u32 m0, s43, 51200
    s_add_u32 s41, s60, 182272
    buffer_load_dwordx4 v10, s[56:59], s41 offen sc1 lds
    s_add_u32 m0, s43, 52224
    s_add_u32 s41, s60, 183296
    buffer_load_dwordx4 v10, s[56:59], s41 offen sc1 lds
    s_add_u32 m0, s43, 53248
    s_add_u32 s41, s60, 184320
    buffer_load_dwordx4 v10, s[56:59], s41 offen sc1 lds
    s_add_u32 m0, s43, 54272
    s_add_u32 s41, s60, 185344
    buffer_load_dwordx4 v10, s[56:59], s41 offen sc1 lds
    s_add_u32 m0, s43, 55296
    s_add_u32 s41, s60, 186368
    buffer_load_dwordx4 v10, s[56:59], s41 offen sc1 lds
    s_add_u32 m0, s43, 56320
    s_add_u32 s41, s60, 187392
    buffer_load_dwordx4 v10, s[56:59], s41 offen sc1 lds
    s_waitcnt vmcnt(16)
    s_barrier
    s_add_u32 m0, s43, 0
    s_add_u32 s41, s60, 196608
    buffer_load_dwordx4 v10, s[56:59], s41 offen sc1 lds
    s_add_u32 m0, s43, 1024
    s_add_u32 s41, s60, 197632
    buffer_load_dwordx4 v10, s[56:59], s41 offen sc1 lds
    s_add_u32 m0, s43, 2048
    s_add_u32 s41, s60, 198656
    buffer_load_dwordx4 v10, s[56:59], s41 offen sc1 lds
    s_add_u32 m0, s43, 3072
    s_add_u32 s41, s60, 199680
    buffer_load_dwordx4 v10, s[56:59], s41 offen sc1 lds
    s_add_u32 m0, s43, 4096
    s_add_u32 s41, s60, 200704
    buffer_load_dwordx4 v10, s[56:59], s41 offen sc1 lds
    s_add_u32 m0, s43, 5120
    s_add_u32 s41, s60, 201728
    buffer_load_dwordx4 v10, s[56:59], s41 offen sc1 lds
    s_add_u32 m0, s43, 6144
    s_add_u32 s41, s60, 202752
    buffer_load_dwordx4 v10, s[56:59], s41 offen sc1 lds
    s_add_u32 m0, s43, 7168
    s_add_u32 s41, s60, 203776
    buffer_load_dwordx4 v10, s[56:59], s41 offen sc1 lds
    s_waitcnt vmcnt(16)
    s_barrier
    s_add_u32 m0, s43, 16384
    s_add_u32 s41, s60, 212992
    buffer_load_dwordx4 v10, s[56:59], s41 offen sc1 lds
    s_add_u32 m0, s43, 17408
    s_add_u32 s41, s60, 214016
    buffer_load_dwordx4 v10, s[56:59], s41 offen sc1 lds
    s_add_u32 m0, s43, 18432
    s_add_u32 s41, s60, 215040
    buffer_load_dwordx4 v10, s[56:59], s41 offen sc1 lds
    s_add_u32 m0, s43, 19456
    s_add_u32 s41, s60, 216064
    buffer_load_dwordx4 v10, s[56:59], s41 offen sc1 lds
    s_add_u32 m0, s43, 20480
    s_add_u32 s41, s60, 217088
    buffer_load_dwordx4 v10, s[56:59], s41 offen sc1 lds
    s_add_u32 m0, s43, 21504
    s_add_u32 s41, s60, 218112
    buffer_load_dwordx4 v10, s[56:59], s41 offen sc1 lds
    s_add_u32 m0, s43, 22528
    s_add_u32 s41, s60, 219136
    buffer_load_dwordx4 v10, s[56:59], s41 offen sc1 lds
    s_add_u32 m0, s43, 23552
    s_add_u32 s41, s60, 220160
    buffer_load_dwordx4 v10, s[56:59], s41 offen sc1 lds
    s_waitcnt vmcnt(16)
    s_barrier
    s_waitcnt vmcnt(8)
    s_barrier
    s_waitcnt vmcnt(0)
    s_barrier
    s_endpgm
L_RS:
    s_mov_b32 s40, s22
    s_mov_b32 s41, s23
    s_mov_b32 s42, 0xfe0000
    s_mov_b32 s43, 0x20000
    s_mul_i32 s56, s25, 26
    s_add_u32 s56, s56, s26
    s_cmp_lt_u32 s26, 26
    s_cselect_b32 s58, 1, 0
    s_cmp_ge_u32 s56, 96
    s_cselect_b32 s52, s16, s6
    s_cselect_b32 s53, s17, s7
    s_cselect_b32 s57, 512, 0
    s_cselect_b32 s44, 96, 0
    s_add_u32 s57, s57, 3072
    s_lshl_b32 s54, s57, 9
    s_mov_b32 s55, 0x20000
    s_sub_u32 s44, s56, s44
    s_lshl_b32 s44, s44, 5
    v_lshrrev_b32 v2, 1, v1
    v_mul_lo_u32 v2, v2, s57
    v_and_b32 v3, 1, v1
    v_lshl_add_u32 v2, v3, 4, v2
    v_add_u32 v6, s44, v2
    s_lshl_b32 s45, s57, 5
    s_mov_b32 s44, 0
    buffer_load_dwordx4 v[8:11], v6, s[52:55], s44 offen
    s_add_u32 s44, s44, s45
    buffer_load_dwordx4 v[12:15], v6, s[52:55], s44 offen
    s_add_u32 s44, s44, s45
    buffer_load_dwordx4 v[16:19], v6, s[52:55], s44 offen
    s_add_u32 s44, s44, s45
    buffer_load_dwordx4 v[20:23], v6, s[52:55], s44 offen
    s_add_u32 s44, s44, s45
    buffer_load_dwordx4 v[24:27], v6, s[52:55], s44 offen
    s_add_u32 s44, s44, s45
    buffer_load_dwordx4 v[28:31], v6, s[52:55], s44 offen
    s_add_u32 s44, s44, s45
    buffer_load_dwordx4 v[32:35], v6, s[52:55], s44 offen
    s_add_u32 s44, s44, s45
    buffer_load_dwordx4 v[36:39], v6, s[52:55], s44 offen
    s_add_u32 s44, s44, s45
    buffer_load_dwordx4 v[40:43], v6, s[52:55], s44 offen
    s_add_u32 s44, s44, s45
    buffer_load_dwordx4 v[44:47], v6, s[52:55], s44 offen
    s_add_u32 s44, s44, s45
    buffer_load_dwordx4 v[48:51], v6, s[52:55], s44 offen
    s_add_u32 s44, s44, s45
    buffer_load_dwordx4 v[52:55], v6, s[52:55], s44 offen
    s_add_u32 s44, s44, s45
    buffer_load_dwordx4 v[56:59], v6, s[52:55], s44 offen
    s_add_u32 s44, s44, s45
    buffer_load_dwordx4 v[60:63], v6, s[52:55], s44 offen
    s_add_u32 s44, s44, s45
    buffer_load_dwordx4 v[64:67], v6, s[52:55], s44 offen
    s_add_u32 s44, s44, s45
    buffer_load_dwordx4 v[68:71], v6, s[52:55], s44 offen
    v_mov_b32 v2, 0
    v_lshlrev_b32 v5, 2, v1
    v_add_u32 v5, 0x20000, v5
    ds_write_b32 v5, v2 offset:3584
    s_waitcnt lgkmcnt(0)
    s_add_u32 s34, s34, 1
    s_addc_u32 s35, s35, 0
    v_mov_b32 v152, s10
    v_mov_b32 v153, s10
    v_mov_b32 v154, s34
    v_mov_b32 v155, s35
    s_lshl_b32 s44, s25, 9
    s_add_u32 s44, s44, 0x8000
    v_and_b32 v156, 31, v1
    v_lshlrev_b32 v156, 4, v156
    v_add_u32 v156, s44, v156
    s_lshl_b32 s45, s26, 4
    s_add_u32 s44, s44, s45
    v_mov_b32 v2, s44
    s_mov_b64 exec, 1
    buffer_store_dwordx4 v[152:155], v2, s[40:43], 0 offen sc1
    s_mov_b64 exec, -1
    s_lshl_b32 s44, s29, 11
    s_add_u32 s44, s44, 0xf00000
    v_lshlrev_b32 v157, 4, v1
    v_add_u32 v157, s44, v157
    s_barrier
    s_barrier
    buffer_load_dwordx4 v[160:163], v157, s[40:43], 0 offen sc1
    buffer_load_dwordx4 v[164:167], v157, s[40:43], 0 offen offset:1024 sc1
    s_barrier
    s_barrier
    s_mov_b32 s36, 20000
L_S_rl_54:
    s_waitcnt vmcnt(0)
    v_cmp_ne_u64_e64 vcc, v[162:163], s[34:35]
    v_cmp_ne_u64_e64 s[48:49], v[166:167], s[34:35]
    s_or_b64 vcc, vcc, s[48:49]
    s_cmp_eq_u64 vcc, 0
    s_cbranch_scc1 L_S_rd_55
    s_sub_u32 s36, s36, 1
    s_cbranch_scc1 L_S_rd_55
    s_sleep 1
    buffer_load_dwordx4 v[160:163], v157, s[40:43], 0 offen sc1
    buffer_load_dwordx4 v[164:167], v157, s[40:43], 0 offen offset:1024 sc1
    s_branch L_S_rl_54
L_S_rd_55:
    v_cvt_pk_bf16_f32 v2, v160, v160
    v_lshlrev_b32 v168, 16, v2
    v_cvt_pk_bf16_f32 v2, v161, v161
    v_lshlrev_b32 v3, 16, v2
    v_add_f32 v3, 0x3727c5ac, v3
    v_cvt_pk_bf16_f32 v2, v3, v3
    v_lshlrev_b32 v3, 16, v2
    v_sqrt_f32 v3, v3
    s_nop 0
    v_cvt_pk_bf16_f32 v2, v3, v3
    v_lshlrev_b32 v169, 16, v2
    v_rcp_f32 v170, v169
    s_nop 0
    v_mul_f32 v4, v170, v170
    v_mul_f32 v4, v4, v161
    v_cvt_pk_bf16_f32 v2, v4, v4
    v_lshlrev_b32 v4, 16, v2
    v_add_f32 v4, 0x3727c5ac, v4
    v_cvt_pk_bf16_f32 v2, v4, v4
    v_lshlrev_b32 v4, 16, v2
    v_sqrt_f32 v4, v4
    s_nop 0
    v_cvt_pk_bf16_f32 v2, v4, v4
    v_lshlrev_b32 v4, 16, v2
    v_mul_f32 v172, v4, v169
    v_sub_f32 v4, v160, v168
    v_mul_f32 v4, v4, v170
    v_cvt_pk_bf16_f32 v2, v4, v4
    v_lshlrev_b32 v4, 16, v2
    v_fma_f32 v171, v4, v169, v168
    ds_write_b32 v5, v168 offset:0
    ds_write_b32 v5, v170 offset:512
    ds_write_b32 v5, v171 offset:1024
    ds_write_b32 v5, v172 offset:1536
    v_cvt_pk_bf16_f32 v2, v164, v164
    v_lshlrev_b32 v168, 16, v2
    v_cvt_pk_bf16_f32 v2, v165, v165
    v_lshlrev_b32 v3, 16, v2
    v_add_f32 v3, 0x3727c5ac, v3
    v_cvt_pk_bf16_f32 v2, v3, v3
    v_lshlrev_b32 v3, 16, v2
    v_sqrt_f32 v3, v3
    s_nop 0
    v_cvt_pk_bf16_f32 v2, v3, v3
    v_lshlrev_b32 v169, 16, v2
    v_rcp_f32 v170, v169
    s_nop 0
    v_mul_f32 v4, v170, v170
    v_mul_f32 v4, v4, v165
    v_cvt_pk_bf16_f32 v2, v4, v4
    v_lshlrev_b32 v4, 16, v2
    v_add_f32 v4, 0x3727c5ac, v4
    v_cvt_pk_bf16_f32 v2, v4, v4
    v_lshlrev_b32 v4, 16, v2
    v_sqrt_f32 v4, v4
    s_nop 0
    v_cvt_pk_bf16_f32 v2, v4, v4
    v_lshlrev_b32 v4, 16, v2
    v_mul_f32 v172, v4, v169
    v_sub_f32 v4, v164, v168
    v_mul_f32 v4, v4, v170
    v_cvt_pk_bf16_f32 v2, v4, v4
    v_lshlrev_b32 v4, 16, v2
    v_fma_f32 v171, v4, v169, v168
    ds_write_b32 v5, v168 offset:256
    ds_write_b32 v5, v170 offset:768
    ds_write_b32 v5, v171 offset:1280
    ds_write_b32 v5, v172 offset:1792
    s_waitcnt lgkmcnt(0)
    v_lshlrev_b32 v173, 6, v1
    s_mov_b32 s64, s14
    s_mov_b32 s65, s15
    s_mov_b32 s66, 0x80000
    s_mov_b32 s67, 0x20000
    s_mul_i32 s44, s2, 2048
    s_mov_b32 exec_hi, 0x0
    buffer_load_dword v174, v173, s[64:67], s44 offen
    s_mov_b64 exec, -1
    s_add_u32 s44, s44, 4096
    s_mov_b32 s64, s8
    s_mov_b32 s65, s9
    s_mov_b32 s66, 0x80000
    s_mov_b32 s67, 0x20000
    s_mul_i32 s44, s2, 2048
    s_mov_b32 exec_hi, 0x0
    buffer_load_dword v174, v173, s[64:67], s44 offen
    s_mov_b64 exec, -1
    s_add_u32 s44, s44, 4096
    s_mov_b32 s64, s18
    s_mov_b32 s65, s19
    s_mov_b32 s66, 0x1c0000
    s_mov_b32 s67, 0x20000
    s_mul_i32 s44, s2, 7168
    buffer_load_dword v174, v173, s[64:67], s44 offen
    s_mov_b64 exec, -1
    s_add_u32 s44, s44, 4096
    s_mov_b32 exec_hi, 0xffff
    buffer_load_dword v174, v173, s[64:67], s44 offen
    s_mov_b64 exec, -1
    s_add_u32 s44, s44, 4096
    s_mov_b32 s68, s18
    s_mov_b32 s69, s19
    s_mov_b32 s70, 0x1c0000
    s_mov_b32 s71, 0x20000
    s_mul_i32 s44, s2, 7
    v_lshrrev_b32 v181, 3, v1
    v_add_u32 v181, s44, v181
    v_and_b32 v2, 7, v1
    v_lshlrev_b32 v2, 4, v2
    v_lshl_add_u32 v180, v181, 10, v2
    v_add_u32 v180, 384, v180
    v_lshl_add_u32 v181, v181, 7, v2
    v_add_u32 v181, 0x100000, v181
    s_mov_b32 exec_hi, 0xffffff
    buffer_load_dwordx4 v[176:179], v180, s[68:71], 0 offen
    s_mov_b32 exec_hi, -1
    s_barrier
    s_mov_b32 s72, 0xffff0000
    v_mov_b32 v184, 0
    v_mov_b32 v185, 0
    v_mov_b32 v186, 0
    v_mov_b32 v187, 0
    v_mov_b32 v188, 0
    v_mov_b32 v189, 0
    v_mov_b32 v190, 0
    v_mov_b32 v191, 0
    v_lshlrev_b32 v192, 16, v8
    v_and_b32 v193, s72, v8
    v_pk_add_f32 v[184:185], v[184:185], v[192:193]
    v_lshlrev_b32 v194, 16, v9
    v_and_b32 v195, s72, v9
    v_pk_add_f32 v[186:187], v[186:187], v[194:195]
    v_lshlrev_b32 v192, 16, v10
    v_and_b32 v193, s72, v10
    v_pk_add_f32 v[188:189], v[188:189], v[192:193]
    v_lshlrev_b32 v194, 16, v11
    v_and_b32 v195, s72, v11
    v_pk_add_f32 v[190:191], v[190:191], v[194:195]
    v_lshlrev_b32 v192, 16, v12
    v_and_b32 v193, s72, v12
    v_pk_add_f32 v[184:185], v[184:185], v[192:193]
    v_lshlrev_b32 v194, 16, v13
    v_and_b32 v195, s72, v13
    v_pk_add_f32 v[186:187], v[186:187], v[194:195]
    v_lshlrev_b32 v192, 16, v14
    v_and_b32 v193, s72, v14
    v_pk_add_f32 v[188:189], v[188:189], v[192:193]
    v_lshlrev_b32 v194, 16, v15
    v_and_b32 v195, s72, v15
    v_pk_add_f32 v[190:191], v[190:191], v[194:195]
    v_lshlrev_b32 v192, 16, v16
    v_and_b32 v193, s72, v16
    v_pk_add_f32 v[184:185], v[184:185], v[192:193]
    v_lshlrev_b32 v194, 16, v17
    v_and_b32 v195, s72, v17
    v_pk_add_f32 v[186:187], v[186:187], v[194:195]
    v_lshlrev_b32 v192, 16, v18
    v_and_b32 v193, s72, v18
    v_pk_add_f32 v[188:189], v[188:189], v[192:193]
    v_lshlrev_b32 v194, 16, v19
    v_and_b32 v195, s72, v19
    v_pk_add_f32 v[190:191], v[190:191], v[194:195]
    v_lshlrev_b32 v192, 16, v20
    v_and_b32 v193, s72, v20
    v_pk_add_f32 v[184:185], v[184:185], v[192:193]
    v_lshlrev_b32 v194, 16, v21
    v_and_b32 v195, s72, v21
    v_pk_add_f32 v[186:187], v[186:187], v[194:195]
    v_lshlrev_b32 v192, 16, v22
    v_and_b32 v193, s72, v22
    v_pk_add_f32 v[188:189], v[188:189], v[192:193]
    v_lshlrev_b32 v194, 16, v23
    v_and_b32 v195, s72, v23
    v_pk_add_f32 v[190:191], v[190:191], v[194:195]
    v_lshlrev_b32 v192, 16, v24
    v_and_b32 v193, s72, v24
    v_pk_add_f32 v[184:185], v[184:185], v[192:193]
    v_lshlrev_b32 v194, 16, v25
    v_and_b32 v195, s72, v25
    v_pk_add_f32 v[186:187], v[186:187], v[194:195]
    v_lshlrev_b32 v192, 16, v26
    v_and_b32 v193, s72, v26
    v_pk_add_f32 v[188:189], v[188:189], v[192:193]
    v_lshlrev_b32 v194, 16, v27
    v_and_b32 v195, s72, v27
    v_pk_add_f32 v[190:191], v[190:191], v[194:195]
    v_lshlrev_b32 v192, 16, v28
    v_and_b32 v193, s72, v28
    v_pk_add_f32 v[184:185], v[184:185], v[192:193]
    v_lshlrev_b32 v194, 16, v29
    v_and_b32 v195, s72, v29
    v_pk_add_f32 v[186:187], v[186:187], v[194:195]
    v_lshlrev_b32 v192, 16, v30
    v_and_b32 v193, s72, v30
    v_pk_add_f32 v[188:189], v[188:189], v[192:193]
    v_lshlrev_b32 v194, 16, v31
    v_and_b32 v195, s72, v31
    v_pk_add_f32 v[190:191], v[190:191], v[194:195]
    v_lshlrev_b32 v192, 16, v32
    v_and_b32 v193, s72, v32
    v_pk_add_f32 v[184:185], v[184:185], v[192:193]
    v_lshlrev_b32 v194, 16, v33
    v_and_b32 v195, s72, v33
    v_pk_add_f32 v[186:187], v[186:187], v[194:195]
    v_lshlrev_b32 v192, 16, v34
    v_and_b32 v193, s72, v34
    v_pk_add_f32 v[188:189], v[188:189], v[192:193]
    v_lshlrev_b32 v194, 16, v35
    v_and_b32 v195, s72, v35
    v_pk_add_f32 v[190:191], v[190:191], v[194:195]
    v_lshlrev_b32 v192, 16, v36
    v_and_b32 v193, s72, v36
    v_pk_add_f32 v[184:185], v[184:185], v[192:193]
    v_lshlrev_b32 v194, 16, v37
    v_and_b32 v195, s72, v37
    v_pk_add_f32 v[186:187], v[186:187], v[194:195]
    v_lshlrev_b32 v192, 16, v38
    v_and_b32 v193, s72, v38
    v_pk_add_f32 v[188:189], v[188:189], v[192:193]
    v_lshlrev_b32 v194, 16, v39
    v_and_b32 v195, s72, v39
    v_pk_add_f32 v[190:191], v[190:191], v[194:195]
    v_lshlrev_b32 v192, 16, v40
    v_and_b32 v193, s72, v40
    v_pk_add_f32 v[184:185], v[184:185], v[192:193]
    v_lshlrev_b32 v194, 16, v41
    v_and_b32 v195, s72, v41
    v_pk_add_f32 v[186:187], v[186:187], v[194:195]
    v_lshlrev_b32 v192, 16, v42
    v_and_b32 v193, s72, v42
    v_pk_add_f32 v[188:189], v[188:189], v[192:193]
    v_lshlrev_b32 v194, 16, v43
    v_and_b32 v195, s72, v43
    v_pk_add_f32 v[190:191], v[190:191], v[194:195]
    v_lshlrev_b32 v192, 16, v44
    v_and_b32 v193, s72, v44
    v_pk_add_f32 v[184:185], v[184:185], v[192:193]
    v_lshlrev_b32 v194, 16, v45
    v_and_b32 v195, s72, v45
    v_pk_add_f32 v[186:187], v[186:187], v[194:195]
    v_lshlrev_b32 v192, 16, v46
    v_and_b32 v193, s72, v46
    v_pk_add_f32 v[188:189], v[188:189], v[192:193]
    v_lshlrev_b32 v194, 16, v47
    v_and_b32 v195, s72, v47
    v_pk_add_f32 v[190:191], v[190:191], v[194:195]
    v_lshlrev_b32 v192, 16, v48
    v_and_b32 v193, s72, v48
    v_pk_add_f32 v[184:185], v[184:185], v[192:193]
    v_lshlrev_b32 v194, 16, v49
    v_and_b32 v195, s72, v49
    v_pk_add_f32 v[186:187], v[186:187], v[194:195]
    v_lshlrev_b32 v192, 16, v50
    v_and_b32 v193, s72, v50
    v_pk_add_f32 v[188:189], v[188:189], v[192:193]
    v_lshlrev_b32 v194, 16, v51
    v_and_b32 v195, s72, v51
    v_pk_add_f32 v[190:191], v[190:191], v[194:195]
    v_lshlrev_b32 v192, 16, v52
    v_and_b32 v193, s72, v52
    v_pk_add_f32 v[184:185], v[184:185], v[192:193]
    v_lshlrev_b32 v194, 16, v53
    v_and_b32 v195, s72, v53
    v_pk_add_f32 v[186:187], v[186:187], v[194:195]
    v_lshlrev_b32 v192, 16, v54
    v_and_b32 v193, s72, v54
    v_pk_add_f32 v[188:189], v[188:189], v[192:193]
    v_lshlrev_b32 v194, 16, v55
    v_and_b32 v195, s72, v55
    v_pk_add_f32 v[190:191], v[190:191], v[194:195]
    v_lshlrev_b32 v192, 16, v56
    v_and_b32 v193, s72, v56
    v_pk_add_f32 v[184:185], v[184:185], v[192:193]
    v_lshlrev_b32 v194, 16, v57
    v_and_b32 v195, s72, v57
    v_pk_add_f32 v[186:187], v[186:187], v[194:195]
    v_lshlrev_b32 v192, 16, v58
    v_and_b32 v193, s72, v58
    v_pk_add_f32 v[188:189], v[188:189], v[192:193]
    v_lshlrev_b32 v194, 16, v59
    v_and_b32 v195, s72, v59
    v_pk_add_f32 v[190:191], v[190:191], v[194:195]
    v_lshlrev_b32 v192, 16, v60
    v_and_b32 v193, s72, v60
    v_pk_add_f32 v[184:185], v[184:185], v[192:193]
    v_lshlrev_b32 v194, 16, v61
    v_and_b32 v195, s72, v61
    v_pk_add_f32 v[186:187], v[186:187], v[194:195]
    v_lshlrev_b32 v192, 16, v62
    v_and_b32 v193, s72, v62
    v_pk_add_f32 v[188:189], v[188:189], v[192:193]
    v_lshlrev_b32 v194, 16, v63
    v_and_b32 v195, s72, v63
    v_pk_add_f32 v[190:191], v[190:191], v[194:195]
    v_lshlrev_b32 v192, 16, v64
    v_and_b32 v193, s72, v64
    v_pk_add_f32 v[184:185], v[184:185], v[192:193]
    v_lshlrev_b32 v194, 16, v65
    v_and_b32 v195, s72, v65
    v_pk_add_f32 v[186:187], v[186:187], v[194:195]
    v_lshlrev_b32 v192, 16, v66
    v_and_b32 v193, s72, v66
    v_pk_add_f32 v[188:189], v[188:189], v[192:193]
    v_lshlrev_b32 v194, 16, v67
    v_and_b32 v195, s72, v67
    v_pk_add_f32 v[190:191], v[190:191], v[194:195]
    v_lshlrev_b32 v192, 16, v68
    v_and_b32 v193, s72, v68
    v_pk_add_f32 v[184:185], v[184:185], v[192:193]
    v_lshlrev_b32 v194, 16, v69
    v_and_b32 v195, s72, v69
    v_pk_add_f32 v[186:187], v[186:187], v[194:195]
    v_lshlrev_b32 v192, 16, v70
    v_and_b32 v193, s72, v70
    v_pk_add_f32 v[188:189], v[188:189], v[192:193]
    v_lshlrev_b32 v194, 16, v71
    v_and_b32 v195, s72, v71
    v_pk_add_f32 v[190:191], v[190:191], v[194:195]
    s_barrier
    v_add_f32_dpp v184, v184, v184 row_ror:2 row_mask:0xf bank_mask:0xf
    v_add_f32_dpp v185, v185, v185 row_ror:2 row_mask:0xf bank_mask:0xf
    v_add_f32_dpp v186, v186, v186 row_ror:2 row_mask:0xf bank_mask:0xf
    v_add_f32_dpp v187, v187, v187 row_ror:2 row_mask:0xf bank_mask:0xf
    v_add_f32_dpp v188, v188, v188 row_ror:2 row_mask:0xf bank_mask:0xf
    v_add_f32_dpp v189, v189, v189 row_ror:2 row_mask:0xf bank_mask:0xf
    v_add_f32_dpp v190, v190, v190 row_ror:2 row_mask:0xf bank_mask:0xf
    v_add_f32_dpp v191, v191, v191 row_ror:2 row_mask:0xf bank_mask:0xf
    v_add_f32_dpp v184, v184, v184 row_ror:4 row_mask:0xf bank_mask:0xf
    v_add_f32_dpp v185, v185, v185 row_ror:4 row_mask:0xf bank_mask:0xf
    v_add_f32_dpp v186, v186, v186 row_ror:4 row_mask:0xf bank_mask:0xf
    v_add_f32_dpp v187, v187, v187 row_ror:4 row_mask:0xf bank_mask:0xf
    v_add_f32_dpp v188, v188, v188 row_ror:4 row_mask:0xf bank_mask:0xf
    v_add_f32_dpp v189, v189, v189 row_ror:4 row_mask:0xf bank_mask:0xf
    v_add_f32_dpp v190, v190, v190 row_ror:4 row_mask:0xf bank_mask:0xf
    v_add_f32_dpp v191, v191, v191 row_ror:4 row_mask:0xf bank_mask:0xf
    v_add_f32_dpp v184, v184, v184 row_ror:8 row_mask:0xf bank_mask:0xf
    v_add_f32_dpp v185, v185, v185 row_ror:8 row_mask:0xf bank_mask:0xf
    v_add_f32_dpp v186, v186, v186 row_ror:8 row_mask:0xf bank_mask:0xf
    v_add_f32_dpp v187, v187, v187 row_ror:8 row_mask:0xf bank_mask:0xf
    v_add_f32_dpp v188, v188, v188 row_ror:8 row_mask:0xf bank_mask:0xf
    v_add_f32_dpp v189, v189, v189 row_ror:8 row_mask:0xf bank_mask:0xf
    v_add_f32_dpp v190, v190, v190 row_ror:8 row_mask:0xf bank_mask:0xf
    v_add_f32_dpp v191, v191, v191 row_ror:8 row_mask:0xf bank_mask:0xf
    v_mov_b32 v192, v184
    s_nop 1
    v_permlane16_swap_b32 v184, v192
    v_add_f32 v184, v184, v192
    v_mov_b32 v194, v185
    s_nop 1
    v_permlane16_swap_b32 v185, v194
    v_add_f32 v185, v185, v194
    v_mov_b32 v192, v186
    s_nop 1
    v_permlane16_swap_b32 v186, v192
    v_add_f32 v186, v186, v192
    v_mov_b32 v194, v187
    s_nop 1
    v_permlane16_swap_b32 v187, v194
    v_add_f32 v187, v187, v194
    v_mov_b32 v192, v188
    s_nop 1
    v_permlane16_swap_b32 v188, v192
    v_add_f32 v188, v188, v192
    v_mov_b32 v194, v189
    s_nop 1
    v_permlane16_swap_b32 v189, v194
    v_add_f32 v189, v189, v194
    v_mov_b32 v192, v190
    s_nop 1
    v_permlane16_swap_b32 v190, v192
    v_add_f32 v190, v190, v192
    v_mov_b32 v194, v191
    s_nop 1
    v_permlane16_swap_b32 v191, v194
    v_add_f32 v191, v191, v194
    v_mov_b32 v192, v184
    s_nop 1
    v_permlane32_swap_b32 v184, v192
    v_add_f32 v184, v184, v192
    v_mov_b32 v194, v185
    s_nop 1
    v_permlane32_swap_b32 v185, v194
    v_add_f32 v185, v185, v194
    v_mov_b32 v192, v186
    s_nop 1
    v_permlane32_swap_b32 v186, v192
    v_add_f32 v186, v186, v192
    v_mov_b32 v194, v187
    s_nop 1
    v_permlane32_swap_b32 v187, v194
    v_add_f32 v187, v187, v194
    v_mov_b32 v192, v188
    s_nop 1
    v_permlane32_swap_b32 v188, v192
    v_add_f32 v188, v188, v192
    v_mov_b32 v194, v189
    s_nop 1
    v_permlane32_swap_b32 v189, v194
    v_add_f32 v189, v189, v194
    v_mov_b32 v192, v190
    s_nop 1
    v_permlane32_swap_b32 v190, v192
    v_add_f32 v190, v190, v192
    v_mov_b32 v194, v191
    s_nop 1
    v_permlane32_swap_b32 v191, v194
    v_add_f32 v191, v191, v194
    v_mov_b32 v72, v184
    v_mov_b32 v73, v185
    v_mov_b32 v74, s34
    v_mov_b32 v75, s35
    v_mov_b32 v76, v186
    v_mov_b32 v77, v187
    v_mov_b32 v78, s34
    v_mov_b32 v79, s35
    v_mov_b32 v80, v188
    v_mov_b32 v81, v189
    v_mov_b32 v82, s34
    v_mov_b32 v83, s35
    v_mov_b32 v84, v190
    v_mov_b32 v85, v191
    v_mov_b32 v86, s34
    v_mov_b32 v87, s35
    v_and_b32 v2, 1, v1
    v_lshlrev_b32 v2, 6, v2
    s_lshl_b32 s44, s56, 7
    s_add_u32 s44, s44, 0x10000
    s_cmp_eq_u32 s58, 0
    s_cbranch_scc1 L_S_nog_56
    s_mov_b64 exec, 3
    buffer_store_dwordx4 v[72:75], v2, s[40:43], s44 offen offset:0 sc1
    buffer_store_dwordx4 v[76:79], v2, s[40:43], s44 offen offset:16 sc1
    buffer_store_dwordx4 v[80:83], v2, s[40:43], s44 offen offset:32 sc1
    buffer_store_dwordx4 v[84:87], v2, s[40:43], s44 offen offset:48 sc1
    s_mov_b64 exec, -1
L_S_nog_56:
    v_min_u32 v198, 47, v1
    v_lshrrev_b32 v2, 4, v198
    v_lshlrev_b32 v196, 12, v2
    v_and_b32 v2, 15, v198
    v_lshl_add_u32 v196, v2, 4, v196
    s_lshl_b32 s44, s30, 8
    s_add_u32 s44, s44, 0x10000
    v_add_u32 v196, s44, v196
    s_min_u32 s44, s32, 13
    s_lshl_b32 s44, s44, 10
    s_add_u32 s44, s44, 0x13000
    v_lshlrev_b32 v197, 4, v1
    v_add_u32 v197, s44, v197
    v_lshlrev_b32 v198, 3, v198
    v_add_u32 v198, 0x20a00, v198
    s_barrier
    s_barrier
    s_barrier
    s_waitcnt vmcnt(0)
    s_mov_b32 exec_hi, 0xffffff
    buffer_store_dwordx4 v[176:179], v181, s[40:43], 0 offen sc1
    s_mov_b32 exec_hi, -1
    s_barrier
    s_barrier
    s_barrier
    buffer_load_dwordx4 v[152:155], v156, s[40:43], 0 offen sc1
    buffer_load_dwordx4 v[160:163], v196, s[40:43], 0 offen sc1
    buffer_load_dwordx4 v[164:167], v197, s[40:43], 0 offen offset:0 sc1
    s_barrier
    s_mov_b32 s36, 20000
L_S_rl_57:
    s_waitcnt vmcnt(0)
    v_cmp_ne_u64_e64 vcc, v[162:163], s[34:35]
    v_cmp_ne_u64_e64 s[48:49], v[166:167], s[34:35]
    s_or_b64 vcc, vcc, s[48:49]
    s_cmp_eq_u64 vcc, 0
    s_cbranch_scc1 L_S_rd_58
    s_sub_u32 s36, s36, 1
    s_cbranch_scc1 L_S_rd_58
    s_sleep 1
    buffer_load_dwordx4 v[160:163], v196, s[40:43], 0 offen sc1
    buffer_load_dwordx4 v[164:167], v197, s[40:43], 0 offen offset:0 sc1
    s_branch L_S_rl_57
L_S_rd_58:
    v_cmp_eq_u64_e64 s[48:49], v[154:155], s[34:35]
    v_cmp_eq_u32 vcc, s10, v152
    s_and_b64 vcc, vcc, s[48:49]
    s_cmp_eq_u64 vcc, -1
    s_cselect_b32 s44, 1, 0
    v_mov_b32 v152, s44
    v_mov_b32 v153, 0x20e20
    ds_write_b32 v153, v152
    ds_write_b64 v198, v[160:161]
    v_lshlrev_b32 v2, 3, v1
    v_add_u32 v2, 0x20c00, v2
    ds_write_b64 v2, v[164:165]
    s_waitcnt lgkmcnt(0)
    s_barrier
    v_mov_b32 v3, 0x20e10
    s_mov_b32 s36, 200000
L_S_kvw_59:
    ds_read_b32 v2, v3
    s_waitcnt lgkmcnt(0)
    v_readfirstlane_b32 s44, v2
    s_cmp_ge_u32 s44, 4
    s_cbranch_scc1 L_S_kvd_60
    s_sub_u32 s36, s36, 1
    s_cbranch_scc1 L_S_kvd_60
    s_sleep 1
    s_branch L_S_kvw_59
L_S_kvd_60:
    v_lshlrev_b32 v199, 4, v1
    v_add_u32 v199, 0x20000, v199
    ds_read_b128 v[8:11], v199 offset:4096
    ds_read_b128 v[12:15], v199 offset:5120
    ds_read_b32 v40, v5 offset:12288
    ds_read_b128 v[16:19], v199 offset:6144
    ds_read_b128 v[20:23], v199 offset:7168
    ds_read_b32 v41, v5 offset:12544
    ds_read_b128 v[24:27], v199 offset:8192
    ds_read_b128 v[28:31], v199 offset:9216
    ds_read_b32 v42, v5 offset:12800
    ds_read_b128 v[32:35], v199 offset:10240
    ds_read_b128 v[36:39], v199 offset:11264
    ds_read_b32 v43, v5 offset:13056
    s_lshl_b32 s44, s30, 4
    s_add_u32 s44, s44, s29
    s_mul_i32 s44, s44, 2176
    s_add_u32 s44, s44, 0xf10000
    v_lshlrev_b32 v6, 5, v1
    s_waitcnt lgkmcnt(0)
    v_pk_add_f32 v[8:9], v[8:9], v[16:17]
    v_pk_add_f32 v[24:25], v[24:25], v[32:33]
    v_pk_add_f32 v[8:9], v[8:9], v[24:25]
    v_pk_add_f32 v[10:11], v[10:11], v[18:19]
    v_pk_add_f32 v[26:27], v[26:27], v[34:35]
    v_pk_add_f32 v[10:11], v[10:11], v[26:27]
    v_pk_add_f32 v[12:13], v[12:13], v[20:21]
    v_pk_add_f32 v[28:29], v[28:29], v[36:37]
    v_pk_add_f32 v[12:13], v[12:13], v[28:29]
    v_pk_add_f32 v[14:15], v[14:15], v[22:23]
    v_pk_add_f32 v[30:31], v[30:31], v[38:39]
    v_pk_add_f32 v[14:15], v[14:15], v[30:31]
    v_add_f32 v40, v40, v41
    v_add_f32 v42, v42, v43
    v_add_f32 v40, v40, v42
    buffer_store_dwordx4 v[8:11], v6, s[40:43], s44 offen sc1
    buffer_store_dwordx4 v[12:15], v6, s[40:43], s44 offen offset:16 sc1
    v_mov_b32 v2, v40
    s_nop 1
    v_permlane32_swap_b32 v40, v2
    v_add_f32 v40, v40, v2
    v_lshlrev_b32 v3, 2, v1
    s_mov_b32 exec_hi, 0
    buffer_store_dword v40, v3, s[40:43], s44 offen offset:2048 sc1
    s_mov_b32 exec_hi, -1
    s_barrier
    s_barrier
    s_barrier
    v_mov_b32 v200, s34
    v_mov_b32 v201, s35
    s_lshl_b32 s44, s30, 4
    s_add_u32 s45, s44, s29
    s_lshl_b32 s45, s45, 3
    s_add_u32 s45, s45, 0x800
    v_mov_b32 v202, s45
    s_waitcnt vmcnt(0)
    s_mov_b64 exec, 1
    buffer_store_dwordx2 v[200:201], v202, s[40:43], 0 offen sc1
    s_mov_b64 exec, -1
    s_barrier
    s_lshl_b32 s44, s30, 4
    v_min_u32 v203, 15, v1
    v_add_u32 v203, s44, v203
    v_lshlrev_b32 v203, 3, v203
    v_add_u32 v203, 0x800, v203
    v_and_b32 v206, 31, v1
    v_lshlrev_b32 v206, 2, v206
    v_bfe_u32 v2, v1, 4, 1
    v_lshlrev_b32 v207, 10, v2
    v_and_b32 v2, 15, v1
    v_lshl_add_u32 v207, v2, 4, v207
    v_lshrrev_b32 v2, 5, v1
    v_lshl_add_u32 v207, v2, 9, v207
    v_add_u32 v207, 0x23400, v207
    v_bfe_u32 v2, v1, 4, 1
    v_lshlrev_b32 v208, 10, v2
    v_bfe_u32 v2, v1, 2, 1
    v_lshl_add_u32 v208, v2, 9, v208
    v_bfe_u32 v2, v1, 3, 1
    v_lshl_add_u32 v208, v2, 3, v208
    v_and_b32 v2, 3, v1
    v_lshl_add_u32 v208, v2, 1, v208
    v_add_u32 v208, 0x23500, v208
    s_mov_b32 s36, 20000
L_S_poll_61:
    buffer_load_dwordx2 v[204:205], v203, s[40:43], 0 offen sc1
    s_waitcnt vmcnt(0)
    v_cmp_ne_u64_e64 vcc, v[204:205], s[34:35]
    s_cmp_eq_u64 vcc, 0
    s_cbranch_scc1 L_S_polld_62
    s_sub_u32 s36, s36, 1
    s_cbranch_scc1 L_S_polld_62
    s_sleep 1
    s_branch L_S_poll_61
L_S_polld_62:
    s_lshl_b32 s44, s30, 4
    s_mul_i32 s44, s44, 2176
    s_add_u32 s44, s44, 0xf10000
    buffer_load_dwordx4 v[8:11], v6, s[40:43], s44 offen sc1
    buffer_load_dwordx4 v[12:15], v6, s[40:43], s44 offen offset:16 sc1
    buffer_load_dword v136, v206, s[40:43], s44 offen offset:2048 sc1
    s_add_u32 s44, s44, 2176
    buffer_load_dwordx4 v[16:19], v6, s[40:43], s44 offen sc1
    buffer_load_dwordx4 v[20:23], v6, s[40:43], s44 offen offset:16 sc1
    buffer_load_dword v137, v206, s[40:43], s44 offen offset:2048 sc1
    s_add_u32 s44, s44, 2176
    buffer_load_dwordx4 v[24:27], v6, s[40:43], s44 offen sc1
    buffer_load_dwordx4 v[28:31], v6, s[40:43], s44 offen offset:16 sc1
    buffer_load_dword v138, v206, s[40:43], s44 offen offset:2048 sc1
    s_add_u32 s44, s44, 2176
    buffer_load_dwordx4 v[32:35], v6, s[40:43], s44 offen sc1
    buffer_load_dwordx4 v[36:39], v6, s[40:43], s44 offen offset:16 sc1
    buffer_load_dword v139, v206, s[40:43], s44 offen offset:2048 sc1
    s_add_u32 s44, s44, 2176
    buffer_load_dwordx4 v[40:43], v6, s[40:43], s44 offen sc1
    buffer_load_dwordx4 v[44:47], v6, s[40:43], s44 offen offset:16 sc1
    buffer_load_dword v140, v206, s[40:43], s44 offen offset:2048 sc1
    s_add_u32 s44, s44, 2176
    buffer_load_dwordx4 v[48:51], v6, s[40:43], s44 offen sc1
    buffer_load_dwordx4 v[52:55], v6, s[40:43], s44 offen offset:16 sc1
    buffer_load_dword v141, v206, s[40:43], s44 offen offset:2048 sc1
    s_add_u32 s44, s44, 2176
    buffer_load_dwordx4 v[56:59], v6, s[40:43], s44 offen sc1
    buffer_load_dwordx4 v[60:63], v6, s[40:43], s44 offen offset:16 sc1
    buffer_load_dword v142, v206, s[40:43], s44 offen offset:2048 sc1
    s_add_u32 s44, s44, 2176
    buffer_load_dwordx4 v[64:67], v6, s[40:43], s44 offen sc1
    buffer_load_dwordx4 v[68:71], v6, s[40:43], s44 offen offset:16 sc1
    buffer_load_dword v143, v206, s[40:43], s44 offen offset:2048 sc1
    s_add_u32 s44, s44, 2176
    buffer_load_dwordx4 v[72:75], v6, s[40:43], s44 offen sc1
    buffer_load_dwordx4 v[76:79], v6, s[40:43], s44 offen offset:16 sc1
    buffer_load_dword v144, v206, s[40:43], s44 offen offset:2048 sc1
    s_add_u32 s44, s44, 2176
    buffer_load_dwordx4 v[80:83], v6, s[40:43], s44 offen sc1
    buffer_load_dwordx4 v[84:87], v6, s[40:43], s44 offen offset:16 sc1
    buffer_load_dword v145, v206, s[40:43], s44 offen offset:2048 sc1
    s_add_u32 s44, s44, 2176
    buffer_load_dwordx4 v[88:91], v6, s[40:43], s44 offen sc1
    buffer_load_dwordx4 v[92:95], v6, s[40:43], s44 offen offset:16 sc1
    buffer_load_dword v146, v206, s[40:43], s44 offen offset:2048 sc1
    s_add_u32 s44, s44, 2176
    buffer_load_dwordx4 v[96:99], v6, s[40:43], s44 offen sc1
    buffer_load_dwordx4 v[100:103], v6, s[40:43], s44 offen offset:16 sc1
    buffer_load_dword v147, v206, s[40:43], s44 offen offset:2048 sc1
    s_add_u32 s44, s44, 2176
    buffer_load_dwordx4 v[104:107], v6, s[40:43], s44 offen sc1
    buffer_load_dwordx4 v[108:111], v6, s[40:43], s44 offen offset:16 sc1
    buffer_load_dword v148, v206, s[40:43], s44 offen offset:2048 sc1
    s_add_u32 s44, s44, 2176
    buffer_load_dwordx4 v[112:115], v6, s[40:43], s44 offen sc1
    buffer_load_dwordx4 v[116:119], v6, s[40:43], s44 offen offset:16 sc1
    buffer_load_dword v149, v206, s[40:43], s44 offen offset:2048 sc1
    s_add_u32 s44, s44, 2176
    buffer_load_dwordx4 v[120:123], v6, s[40:43], s44 offen sc1
    buffer_load_dwordx4 v[124:127], v6, s[40:43], s44 offen offset:16 sc1
    buffer_load_dword v150, v206, s[40:43], s44 offen offset:2048 sc1
    s_add_u32 s44, s44, 2176
    buffer_load_dwordx4 v[128:131], v6, s[40:43], s44 offen sc1
    buffer_load_dwordx4 v[132:135], v6, s[40:43], s44 offen offset:16 sc1
    buffer_load_dword v151, v206, s[40:43], s44 offen offset:2048 sc1
    s_waitcnt vmcnt(42)
    v_pk_add_f32 v[8:9], v[8:9], v[16:17]
    v_pk_add_f32 v[10:11], v[10:11], v[18:19]
    v_pk_add_f32 v[12:13], v[12:13], v[20:21]
    v_pk_add_f32 v[14:15], v[14:15], v[22:23]
    v_add_f32 v136, v136, v137
    s_waitcnt vmcnt(36)
    v_pk_add_f32 v[24:25], v[24:25], v[32:33]
    v_pk_add_f32 v[26:27], v[26:27], v[34:35]
    v_pk_add_f32 v[28:29], v[28:29], v[36:37]
    v_pk_add_f32 v[30:31], v[30:31], v[38:39]
    v_add_f32 v138, v138, v139
    s_waitcnt vmcnt(30)
    v_pk_add_f32 v[40:41], v[40:41], v[48:49]
    v_pk_add_f32 v[42:43], v[42:43], v[50:51]
    v_pk_add_f32 v[44:45], v[44:45], v[52:53]
    v_pk_add_f32 v[46:47], v[46:47], v[54:55]
    v_add_f32 v140, v140, v141
    s_waitcnt vmcnt(24)
    v_pk_add_f32 v[56:57], v[56:57], v[64:65]
    v_pk_add_f32 v[58:59], v[58:59], v[66:67]
    v_pk_add_f32 v[60:61], v[60:61], v[68:69]
    v_pk_add_f32 v[62:63], v[62:63], v[70:71]
    v_add_f32 v142, v142, v143
    s_waitcnt vmcnt(18)
    v_pk_add_f32 v[72:73], v[72:73], v[80:81]
    v_pk_add_f32 v[74:75], v[74:75], v[82:83]
    v_pk_add_f32 v[76:77], v[76:77], v[84:85]
    v_pk_add_f32 v[78:79], v[78:79], v[86:87]
    v_add_f32 v144, v144, v145
    s_waitcnt vmcnt(12)
    v_pk_add_f32 v[88:89], v[88:89], v[96:97]
    v_pk_add_f32 v[90:91], v[90:91], v[98:99]
    v_pk_add_f32 v[92:93], v[92:93], v[100:101]
    v_pk_add_f32 v[94:95], v[94:95], v[102:103]
    v_add_f32 v146, v146, v147
    s_waitcnt vmcnt(6)
    v_pk_add_f32 v[104:105], v[104:105], v[112:113]
    v_pk_add_f32 v[106:107], v[106:107], v[114:115]
    v_pk_add_f32 v[108:109], v[108:109], v[116:117]
    v_pk_add_f32 v[110:111], v[110:111], v[118:119]
    v_add_f32 v148, v148, v149
    s_waitcnt vmcnt(0)
    v_pk_add_f32 v[120:121], v[120:121], v[128:129]
    v_pk_add_f32 v[122:123], v[122:123], v[130:131]
    v_pk_add_f32 v[124:125], v[124:125], v[132:133]
    v_pk_add_f32 v[126:127], v[126:127], v[134:135]
    v_add_f32 v150, v150, v151
    v_pk_add_f32 v[8:9], v[8:9], v[24:25]
    v_pk_add_f32 v[10:11], v[10:11], v[26:27]
    v_pk_add_f32 v[12:13], v[12:13], v[28:29]
    v_pk_add_f32 v[14:15], v[14:15], v[30:31]
    v_add_f32 v136, v136, v138
    v_pk_add_f32 v[40:41], v[40:41], v[56:57]
    v_pk_add_f32 v[42:43], v[42:43], v[58:59]
    v_pk_add_f32 v[44:45], v[44:45], v[60:61]
    v_pk_add_f32 v[46:47], v[46:47], v[62:63]
    v_add_f32 v140, v140, v142
    v_pk_add_f32 v[72:73], v[72:73], v[88:89]
    v_pk_add_f32 v[74:75], v[74:75], v[90:91]
    v_pk_add_f32 v[76:77], v[76:77], v[92:93]
    v_pk_add_f32 v[78:79], v[78:79], v[94:95]
    v_add_f32 v144, v144, v146
    v_pk_add_f32 v[104:105], v[104:105], v[120:121]
    v_pk_add_f32 v[106:107], v[106:107], v[122:123]
    v_pk_add_f32 v[108:109], v[108:109], v[124:125]
    v_pk_add_f32 v[110:111], v[110:111], v[126:127]
    v_add_f32 v148, v148, v150
    v_pk_add_f32 v[8:9], v[8:9], v[40:41]
    v_pk_add_f32 v[10:11], v[10:11], v[42:43]
    v_pk_add_f32 v[12:13], v[12:13], v[44:45]
    v_pk_add_f32 v[14:15], v[14:15], v[46:47]
    v_add_f32 v136, v136, v140
    v_pk_add_f32 v[72:73], v[72:73], v[104:105]
    v_pk_add_f32 v[74:75], v[74:75], v[106:107]
    v_pk_add_f32 v[76:77], v[76:77], v[108:109]
    v_pk_add_f32 v[78:79], v[78:79], v[110:111]
    v_add_f32 v144, v144, v148
    v_pk_add_f32 v[8:9], v[8:9], v[72:73]
    v_pk_add_f32 v[10:11], v[10:11], v[74:75]
    v_pk_add_f32 v[12:13], v[12:13], v[76:77]
    v_pk_add_f32 v[14:15], v[14:15], v[78:79]
    v_add_f32 v136, v136, v144
    v_cvt_pk_bf16_f32 v212, v8, v9
    v_cvt_pk_bf16_f32 v213, v10, v11
    v_cvt_pk_bf16_f32 v214, v12, v13
    v_cvt_pk_bf16_f32 v215, v14, v15
    ds_write_b128 v207, v[212:215]
    v_cvt_pk_bf16_f32 v2, v136, v136
    ds_write_b16 v208, v2
    ds_write_b16 v208, v2 offset:64
    s_waitcnt lgkmcnt(0)
    s_barrier
    s_cmp_lg_u32 s33, 0
    s_cbranch_scc1 L_S_b24_63
    s_lshl_b32 s44, s31, 14
    s_add_u32 s44, s44, 0xfa0000
    v_lshrrev_b32 v2, 5, v1
    v_lshlrev_b32 v6, 13, v2
    v_and_b32 v2, 31, v1
    v_lshl_add_u32 v6, v2, 4, v6
    s_barrier
    buffer_load_dwordx4 v[8:11], v6, s[40:43], s44 offen offset:0 sc1
    buffer_load_dwordx4 v[12:15], v6, s[40:43], s44 offen offset:512 sc1
    buffer_load_dwordx4 v[16:19], v6, s[40:43], s44 offen offset:1024 sc1
    buffer_load_dwordx4 v[20:23], v6, s[40:43], s44 offen offset:1536 sc1
    buffer_load_dwordx4 v[24:27], v6, s[40:43], s44 offen offset:2048 sc1
    buffer_load_dwordx4 v[28:31], v6, s[40:43], s44 offen offset:2560 sc1
    buffer_load_dwordx4 v[32:35], v6, s[40:43], s44 offen offset:3072 sc1
    buffer_load_dwordx4 v[36:39], v6, s[40:43], s44 offen offset:3584 sc1
    s_add_u32 s44, s44, 4096
    buffer_load_dwordx4 v[40:43], v6, s[40:43], s44 offen offset:0 sc1
    buffer_load_dwordx4 v[44:47], v6, s[40:43], s44 offen offset:512 sc1
    buffer_load_dwordx4 v[48:51], v6, s[40:43], s44 offen offset:1024 sc1
    buffer_load_dwordx4 v[52:55], v6, s[40:43], s44 offen offset:1536 sc1
    buffer_load_dwordx4 v[56:59], v6, s[40:43], s44 offen offset:2048 sc1
    buffer_load_dwordx4 v[60:63], v6, s[40:43], s44 offen offset:2560 sc1
    buffer_load_dwordx4 v[64:67], v6, s[40:43], s44 offen offset:3072 sc1
    buffer_load_dwordx4 v[68:71], v6, s[40:43], s44 offen offset:3584 sc1
    s_barrier
    s_barrier
    s_barrier
    s_waitcnt vmcnt(0)
    v_pk_add_f32 v[8:9], v[8:9], v[40:41]
    v_pk_add_f32 v[10:11], v[10:11], v[42:43]
    v_pk_add_f32 v[12:13], v[12:13], v[44:45]
    v_pk_add_f32 v[14:15], v[14:15], v[46:47]
    v_pk_add_f32 v[16:17], v[16:17], v[48:49]
    v_pk_add_f32 v[18:19], v[18:19], v[50:51]
    v_pk_add_f32 v[20:21], v[20:21], v[52:53]
    v_pk_add_f32 v[22:23], v[22:23], v[54:55]
    v_pk_add_f32 v[24:25], v[24:25], v[56:57]
    v_pk_add_f32 v[26:27], v[26:27], v[58:59]
    v_pk_add_f32 v[28:29], v[28:29], v[60:61]
    v_pk_add_f32 v[30:31], v[30:31], v[62:63]
    v_pk_add_f32 v[32:33], v[32:33], v[64:65]
    v_pk_add_f32 v[34:35], v[34:35], v[66:67]
    v_pk_add_f32 v[36:37], v[36:37], v[68:69]
    v_pk_add_f32 v[38:39], v[38:39], v[70:71]
    v_pk_add_f32 v[8:9], v[8:9], v[24:25]
    v_pk_add_f32 v[10:11], v[10:11], v[26:27]
    v_pk_add_f32 v[12:13], v[12:13], v[28:29]
    v_pk_add_f32 v[14:15], v[14:15], v[30:31]
    v_pk_add_f32 v[16:17], v[16:17], v[32:33]
    v_pk_add_f32 v[18:19], v[18:19], v[34:35]
    v_pk_add_f32 v[20:21], v[20:21], v[36:37]
    v_pk_add_f32 v[22:23], v[22:23], v[38:39]
    v_pk_add_f32 v[8:9], v[8:9], v[16:17]
    v_pk_add_f32 v[10:11], v[10:11], v[18:19]
    v_pk_add_f32 v[12:13], v[12:13], v[20:21]
    v_pk_add_f32 v[14:15], v[14:15], v[22:23]
    v_pk_add_f32 v[8:9], v[8:9], v[12:13]
    v_pk_add_f32 v[10:11], v[10:11], v[14:15]
    v_lshlrev_b32 v5, 3, v1
    v_add_u32 v5, 0x20000, v5
    v_mul_f32 v8, 0x3b000000, v8
    v_mul_f32 v9, 0x3b000000, v9
    v_fma_f32 v9, -v8, v8, v9
    v_max_f32 v9, 0, v9
    v_cvt_pk_bf16_f32 v2, v8, v8
    v_lshlrev_b32 v168, 16, v2
    v_cvt_pk_bf16_f32 v2, v9, v9
    v_lshlrev_b32 v3, 16, v2
    v_add_f32 v3, 0x3727c5ac, v3
    v_cvt_pk_bf16_f32 v2, v3, v3
    v_lshlrev_b32 v3, 16, v2
    v_sqrt_f32 v3, v3
    s_nop 0
    v_cvt_pk_bf16_f32 v2, v3, v3
    v_lshlrev_b32 v169, 16, v2
    v_rcp_f32 v170, v169
    ds_write_b32 v5, v168 offset:15360
    ds_write_b32 v5, v169 offset:15872
    v_mul_f32 v10, 0x3b000000, v10
    v_mul_f32 v11, 0x3b000000, v11
    v_fma_f32 v11, -v10, v10, v11
    v_max_f32 v11, 0, v11
    v_cvt_pk_bf16_f32 v2, v10, v10
    v_lshlrev_b32 v168, 16, v2
    v_cvt_pk_bf16_f32 v2, v11, v11
    v_lshlrev_b32 v3, 16, v2
    v_add_f32 v3, 0x3727c5ac, v3
    v_cvt_pk_bf16_f32 v2, v3, v3
    v_lshlrev_b32 v3, 16, v2
    v_sqrt_f32 v3, v3
    s_nop 0
    v_cvt_pk_bf16_f32 v2, v3, v3
    v_lshlrev_b32 v169, 16, v2
    v_rcp_f32 v170, v169
    ds_write_b32 v5, v168 offset:15364
    ds_write_b32 v5, v169 offset:15876
    s_waitcnt lgkmcnt(0)
    s_barrier
    s_barrier
    s_barrier
    s_barrier
    s_barrier
L_S_b24_63:
    s_barrier
    s_barrier
    s_barrier
    s_barrier
    s_barrier
    s_barrier
    s_barrier
    s_barrier
    s_barrier
    s_barrier
    s_barrier
    s_barrier
    s_barrier
    s_barrier
    s_barrier
    s_barrier
    s_barrier
    s_barrier
    s_cmp_lg_u32 s2, 0
    s_cbranch_scc1 L_S_e_64
    v_lshlrev_b32 v6, 5, v1
    v_add_u32 v6, 0x800, v6
    s_mov_b32 s36, 20000
L_S_el_65:
    buffer_load_dwordx4 v[8:11], v6, s[40:43], 0 offen sc1
    buffer_load_dwordx4 v[12:15], v6, s[40:43], 0 offen offset:16 sc1
    s_waitcnt vmcnt(0)
    v_cmp_ne_u64_e64 vcc, v[8:9], s[34:35]
    v_cmp_ne_u64_e64 s[48:49], v[10:11], s[34:35]
    s_or_b64 vcc, vcc, s[48:49]
    v_cmp_ne_u64_e64 s[48:49], v[12:13], s[34:35]
    s_or_b64 vcc, vcc, s[48:49]
    v_cmp_ne_u64_e64 s[48:49], v[14:15], s[34:35]
    s_or_b64 vcc, vcc, s[48:49]
    s_cmp_eq_u64 vcc, 0
    s_cbranch_scc1 L_S_ed_66
    s_sub_u32 s36, s36, 1
    s_cbranch_scc1 L_S_ed_66
    s_sleep 1
    s_branch L_S_el_65
L_S_ed_66:
    v_mov_b32 v202, 0x3000
    s_mov_b64 exec, 1
    buffer_store_dwordx2 v[200:201], v202, s[40:43], 0 offen sc1
    s_mov_b64 exec, -1
L_S_e_64:
    s_endpgm
L_END:
    s_endpgm
.section .rodata,"a"
.p2align 6
.amdhsa_kernel recurrent_scan__linear_attn_block__mixer_s_mlp__prompt_kernel
  .amdhsa_next_free_vgpr 256
  .amdhsa_next_free_sgpr 100
  .amdhsa_accum_offset 256
  .amdhsa_group_segment_fixed_size 0
  .amdhsa_kernarg_size 88
  .amdhsa_user_sgpr_count 2
  .amdhsa_user_sgpr_kernarg_segment_ptr 1
  .amdhsa_system_sgpr_workgroup_id_x 1
.end_amdhsa_kernel
```
